```python
import torch

def _softmax(x, axis=-1):
    return torch.softmax(x, dim=axis)
def _gelu(x):
    return torch.nn.functional.gelu(x, approximate="tanh")
def _silu(x):
    return torch.nn.functional.silu(x)
def _sigmoid(x):
    return torch.sigmoid(x)
def _layernorm(x, axis=-1, eps=1e-5):
    m = x.mean(dim=axis, keepdim=True)
    v = x.var(dim=axis, keepdim=True, unbiased=False)
    return (x - m) / torch.sqrt(v + eps)
def _scatter_add(tgt, idx, src, axis=0):
    return tgt.clone().index_add_(axis, idx, src)
def _segment_sum(src, seg, n):
    out = torch.zeros((n,) + src.shape[1:], dtype=src.dtype)
    return out.index_add_(0, seg, src)
def _pad(x, pw):
    flat = tuple(v for pair in reversed(pw) for v in pair)
    return torch.nn.functional.pad(x, flat)

kernel_name = 'interleave_layers__sliding_local_dilated__sliding_block__prompt'

def setup_inputs():

    _w = (lambda a: (lambda t: t.to(torch.bfloat16) if t.is_floating_point() else t)(torch.as_tensor(a)))
    def _A_setup():
        B, S, D = 1, 2048, 640
        return {
            "x": _w((lambda *s: torch.randn(*s, dtype=torch.bfloat16) * 0.05)(B, S, D)),
            "wqkv": _w((lambda *s: torch.randn(*s, dtype=torch.bfloat16) * 0.05)(D, 3 * D)),
            "wo": _w((lambda *s: torch.randn(*s, dtype=torch.bfloat16) * 0.05)(D, D)),
        }
    _A_in = _A_setup()

    def _B_setup():
        B, S, D = 1, 2048, 640
        return {
            "x": _w((lambda *s: torch.randn(*s, dtype=torch.bfloat16) * 0.05)(B, S, D)),
            "wqkv": _w((lambda *s: torch.randn(*s, dtype=torch.bfloat16) * 0.05)(D, 3 * D)),
            "wo": _w((lambda *s: torch.randn(*s, dtype=torch.bfloat16) * 0.05)(D, D)),
        }
    _B_in = _B_setup()

    return {
        "A_x": _A_in["x"],
        "A_wqkv": _A_in["wqkv"],
        "A_wo": _A_in["wo"],
        "B_x": _B_in["x"],
        "B_wqkv": _B_in["wqkv"],
        "B_wo": _B_in["wo"],
    }

def reference(A_x, A_wqkv, A_wo, B_x, B_wqkv, B_wo):
    def _A_ref(x, wqkv, wo):
        B, S, D = x.shape
        H = 32; Dh = D // H
        W, dil = 8, 2
        qkv = (lambda x, *d: x.permute(*d))((x @ wqkv).reshape(B, S, 3, H, Dh), 2, 0, 3, 1, 4)
        q, k, v = qkv[0], qkv[1], qkv[2]
        scale = Dh ** -0.5
        pos = torch.arange(S)
        off = torch.arange(W) * dil
        idx = pos[:, None] - off[None, :]
        mask = idx >= 0
        idx_c = torch.where(mask, idx, 0).reshape(-1)
        kg = k[:, :, idx_c, :].reshape(B, H, S, W, Dh)
        vg = v[:, :, idx_c, :].reshape(B, H, S, W, Dh)
        logits = torch.einsum("bhsd,bhswd->bhsw", q, kg) * scale
        logits = torch.where(mask[None, None, :, :], logits, -1e9)
        attn = _softmax(logits, axis=-1)
        o = torch.einsum("bhsw,bhswd->bhsd", attn, vg)
        return (lambda x, *d: x.permute(*d))(o, 0, 2, 1, 3).reshape(B, S, D) @ wo

    def _B_ref(x, wqkv, wo):
        B, S, D = x.shape
        H = 32; Dh = D // H; W = 256
        qkv = (lambda x, *d: x.permute(*d))((x @ wqkv).reshape(B, S, 3, H, Dh), 2, 0, 3, 1, 4)
        q, k, v = qkv[0], qkv[1], qkv[2]
        scores = torch.einsum("bhqd,bhkd->bhqk", q, k) * (Dh ** -0.5)
        idx = torch.arange(S)
        mask = (idx[:, None] - idx[None, :] >= 0) & (idx[:, None] - idx[None, :] < W)
        scores = torch.where(mask[None, None], scores, -1e9)
        p = _softmax(scores, axis=-1)
        o = torch.einsum("bhqk,bhkd->bhqd", p, v)
        return (lambda x, *d: x.permute(*d))(o, 0, 2, 1, 3).reshape(B, S, D) @ wo

    x = A_x
    x = x + _A_ref(_layernorm(x, axis=-1), A_wqkv, A_wo)
    x = x + _B_ref(_layernorm(x, axis=-1), B_wqkv, B_wo)
    x = x + _A_ref(_layernorm(x, axis=-1), A_wqkv, A_wo)
    x = x + _B_ref(_layernorm(x, axis=-1), B_wqkv, B_wo)
    return x
```

```asm
; @launch kernel=prep_kernel grid=(368,1,1) block=(256,1,1) lds=32768
; @launch kernel=interleave_layers__sliding_local_dilated__sliding_block__prompt_kernel grid=(256,1,1) block=(256,1,1) lds=163840
.amdgcn_target "amdgcn-amd-amdhsa--gfx950"
.text
.globl interleave_layers__sliding_local_dilated__sliding_block__prompt_kernel
.p2align 8
.type interleave_layers__sliding_local_dilated__sliding_block__prompt_kernel,@function
interleave_layers__sliding_local_dilated__sliding_block__prompt_kernel:
  s_cmp_ge_u32 s2, 256
  s_cbranch_scc1 L_end
  s_load_dwordx4 s[28:31], s[0:1], 0
  s_load_dwordx2 s[32:33], s[0:1], 16
  s_load_dwordx4 s[36:39], s[0:1], 32
  s_load_dwordx4 s[40:43], s[0:1], 48
  s_load_dwordx2 s[44:45], s[0:1], 64
  s_getreg_b32 s98, hwreg(HW_REG_XCC_ID)
  v_and_b32 v1, 63, v0
  v_lshrrev_b32 v78, 6, v0
  v_lshlrev_b32 v2, 4, v1
  v_readfirstlane_b32 s24, v78
  v_and_b32 v3, 15, v1
  v_lshrrev_b32 v4, 4, v1
  s_and_b32 s34, s2, 7
  s_lshr_b32 s35, s2, 3
  s_lshr_b32 s58, s35, 4
  s_lshl_b32 s25, s34, 1
  s_add_u32 s25, s25, s58
  s_and_b32 s26, s35, 15
  s_and_b32 s98, s98, 7
  s_getpc_b64 s[60:61]
L_pc:
  s_sub_u32 s60, s60, L_pc-interleave_layers__sliding_local_dilated__sliding_block__prompt_kernel
  s_subb_u32 s61, s61, 0
  s_lshl_b32 s56, s35, 2
  s_add_u32 s56, s56, s24
  s_lshl_b32 s56, s56, 9
  v_lshlrev_b32 v84, 7, v1
  v_add_u32 v84, s56, v84
  v_min_u32 v84, L_code_end-interleave_layers__sliding_local_dilated__sliding_block__prompt_kernel-4, v84
  s_mov_b64 exec, 15
  global_load_dword v249, v84, s[60:61]
  s_mov_b64 exec, -1
  s_waitcnt lgkmcnt(0)
  s_mov_b32 s4, s44
  s_mov_b32 s5, s45
  s_mov_b32 s6, 0x10000000
  s_mov_b32 s7, 0x20000
  s_mov_b32 s12, s40
  s_mov_b32 s13, s41
  s_mov_b32 s14, 0x280000
  s_mov_b32 s15, 0x20000
  s_mov_b32 s16, s42
  s_mov_b32 s17, s43
  s_mov_b32 s18, 0x100
  s_mov_b32 s19, 0x20000
  s_cmp_lg_u32 s24, 0
  s_cbranch_scc1 L_xca_1
  s_mul_i32 s56, s98, s98
  s_lshl_b32 s56, s56, 16
  s_lshl_b32 s63, s98, 8
  s_add_u32 s56, s56, s63
  s_add_u32 s56, s56, 1
  v_mov_b32 v78, s56
  s_lshl_b32 s56, s34, 5
  v_mov_b32 v79, s56
  s_mov_b64 exec, 1
  buffer_atomic_add v78, v79, s[16:19], 0 offen sc1
  s_mov_b64 exec, -1
L_xca_1:
  s_mov_b32 s27, 1
  s_and_b32 s89, s27, 1
  s_xor_b32 s89, s89, 1
  s_mov_b32 s82, 0x0
  s_mov_b32 s83, 0x3100000
  s_mov_b32 s84, 0x1000000
  s_mov_b32 s87, 0x0
  s_mov_b32 s86, 0x4600000
  s_and_b32 s56, s26, 7
  s_mul_i32 s56, s56, 102400
  s_add_u32 s86, s86, s56
  s_mul_i32 s56, s24, 18432
  s_add_u32 s94, s86, s56
  s_add_u32 s100, s56, 87552
  s_cmp_eq_u32 s27, 2
  s_cselect_b32 s56, 1, 0
  s_cmp_eq_u32 s24, 3
  s_cselect_b32 s56, s56, 0
  s_cmp_ge_u32 s26, 8
  s_cselect_b32 s93, s56, 0
  s_add_u32 s8, s44, 0x4800000
  s_addc_u32 s9, s45, 0
  s_mov_b32 s10, 0x280000
  s_mov_b32 s11, 0x20000
  v_mov_b32 v5, v2
  v_add_u32 v6, 1024, v2
  s_lshl_b32 s56, s25, 13
  s_add_u32 s54, s56, 0x3000000
  s_max_u32 s56, s56, 1024
  s_sub_u32 s56, s56, 1024
  s_add_u32 s55, s56, 0x3000000
  s_lshl_b32 s56, s25, 3
  s_max_u32 s56, s56, 1
  s_sub_u32 s56, s56, 1
  s_mul_i32 s53, s56, 20480
  s_add_u32 s53, s53, 0x4800000
  s_lshl_b32 s56, s25, 3
  s_lshl_b32 s57, s24, 1
  s_add_u32 s57, s57, s56
  s_mul_i32 s46, s57, 20480
  s_add_u32 s48, s46, 20480
  s_lshl_b32 s52, s24, 12
  s_lshl_b32 s56, s26, 3
  s_lshl_b32 s57, s24, 1
  s_add_u32 s56, s56, s57
  s_mul_i32 s56, s56, 20480
  s_add_u32 s85, s56, 0x4000000
  s_add_u32 s91, s85, 20480
  s_lshl_b32 s56, s24, 10
  s_add_u32 s56, s56, 0
  s_add_u32 s56, s56, s54
  buffer_load_dwordx4 v[152:155], v2, s[4:7], s56 offen sc1
  s_lshl_b32 s56, s24, 10
  s_add_u32 s56, s56, 4096
  s_add_u32 s56, s56, s54
  buffer_load_dwordx4 v[156:159], v2, s[4:7], s56 offen sc1
  buffer_load_dwordx4 a[0:3], v2, s[4:7], s85 offen
  buffer_load_dwordx4 a[4:7], v2, s[4:7], s85 offen offset:1024
  s_add_u32 s85, s85, 2048
  s_add_u32 m0, s52, 0
  s_nop 0
  buffer_load_dwordx4 v2, s[8:11], s46 offen sc1 lds
  buffer_load_dwordx4 v2, s[8:11], s46 offen offset:1024 sc1 lds
  s_add_u32 s46, s46, 2048
  buffer_load_dwordx4 a[80:83], v2, s[4:7], s91 offen
  buffer_load_dwordx4 a[84:87], v2, s[4:7], s91 offen offset:1024
  s_add_u32 s91, s91, 2048
  s_add_u32 m0, s52, 2048
  s_nop 0
  buffer_load_dwordx4 v2, s[8:11], s48 offen sc1 lds
  buffer_load_dwordx4 v2, s[8:11], s48 offen offset:1024 sc1 lds
  s_add_u32 s48, s48, 2048
  buffer_load_dwordx4 a[8:11], v2, s[4:7], s85 offen
  buffer_load_dwordx4 a[12:15], v2, s[4:7], s85 offen offset:1024
  s_add_u32 s85, s85, 2048
  s_add_u32 m0, s52, 16384
  s_nop 0
  buffer_load_dwordx4 v2, s[8:11], s46 offen sc1 lds
  buffer_load_dwordx4 v2, s[8:11], s46 offen offset:1024 sc1 lds
  s_add_u32 s46, s46, 2048
  buffer_load_dwordx4 a[88:91], v2, s[4:7], s91 offen
  buffer_load_dwordx4 a[92:95], v2, s[4:7], s91 offen offset:1024
  s_add_u32 s91, s91, 2048
  s_add_u32 m0, s52, 18432
  s_nop 0
  buffer_load_dwordx4 v2, s[8:11], s48 offen sc1 lds
  buffer_load_dwordx4 v2, s[8:11], s48 offen offset:1024 sc1 lds
  s_add_u32 s48, s48, 2048
  buffer_load_dwordx4 a[16:19], v2, s[4:7], s85 offen
  buffer_load_dwordx4 a[20:23], v2, s[4:7], s85 offen offset:1024
  s_add_u32 s85, s85, 2048
  s_add_u32 m0, s52, 32768
  s_nop 0
  buffer_load_dwordx4 v2, s[8:11], s46 offen sc1 lds
  buffer_load_dwordx4 v2, s[8:11], s46 offen offset:1024 sc1 lds
  s_add_u32 s46, s46, 2048
  buffer_load_dwordx4 a[96:99], v2, s[4:7], s91 offen
  buffer_load_dwordx4 a[100:103], v2, s[4:7], s91 offen offset:1024
  s_add_u32 s91, s91, 2048
  s_add_u32 m0, s52, 34816
  s_nop 0
  buffer_load_dwordx4 v2, s[8:11], s48 offen sc1 lds
  buffer_load_dwordx4 v2, s[8:11], s48 offen offset:1024 sc1 lds
  s_add_u32 s48, s48, 2048
  s_lshl_b32 s56, s24, 3
  s_add_u32 s56, s56, 0
  v_add_u32 v88, s56, v4
  v_mul_u32_u24 v89, 13108, v88
  v_lshrrev_b32 v89, 16, v89
  v_mul_u32_u24 v90, 5, v89
  v_sub_u32 v90, v88, v90
  v_lshlrev_b32 v90, 3, v90
  v_mul_u32_u24 v91, 6912, v89
  v_add_u32 v91, 73728, v91
  v_subrev_u32 v92, 2, v89
  v_mul_u32_u24 v92, 18432, v92
  v_add_u32 v92, 11520, v92
  v_cmp_gt_u32 vcc, 2, v89
  s_nop 1
  v_cndmask_b32 v91, v92, v91, vcc
  v_add_u32 v91, v91, v90
  v_subrev_u32 v92, 28, v88
  v_mul_u32_u24 v92, 18432, v92
  v_add_u32 v92, 11560, v92
  v_mov_b32 v94, 0x3ea52b5c
  v_cmp_gt_u32 vcc, 2, v89
  s_nop 1
  v_cndmask_b32 v10, 1.0, v94, vcc
  v_cmp_le_u32 vcc, 30, v88
  s_nop 1
  v_cndmask_b32 v91, v91, v92, vcc
  v_cndmask_b32 v93, 0, 1.0, vcc
  v_cndmask_b32 v10, v10, 0, vcc
  v_mul_u32_u24 v92, 48, v3
  v_add_u32 v8, v91, v92
  s_lshl_b32 s56, s24, 3
  s_add_u32 s56, s56, 4
  v_add_u32 v88, s56, v4
  v_mul_u32_u24 v89, 13108, v88
  v_lshrrev_b32 v89, 16, v89
  v_mul_u32_u24 v90, 5, v89
  v_sub_u32 v90, v88, v90
  v_lshlrev_b32 v90, 3, v90
  v_mul_u32_u24 v91, 6912, v89
  v_add_u32 v91, 73728, v91
  v_subrev_u32 v92, 2, v89
  v_mul_u32_u24 v92, 18432, v92
  v_add_u32 v92, 11520, v92
  v_cmp_gt_u32 vcc, 2, v89
  s_nop 1
  v_cndmask_b32 v91, v92, v91, vcc
  v_add_u32 v91, v91, v90
  v_subrev_u32 v92, 28, v88
  v_mul_u32_u24 v92, 18432, v92
  v_add_u32 v92, 11560, v92
  v_mov_b32 v94, 0x3ea52b5c
  v_cmp_gt_u32 vcc, 2, v89
  s_nop 1
  v_cndmask_b32 v11, 1.0, v94, vcc
  v_cmp_le_u32 vcc, 30, v88
  s_nop 1
  v_cndmask_b32 v91, v91, v92, vcc
  v_cndmask_b32 v93, 0, 1.0, vcc
  v_cndmask_b32 v11, v11, 0, vcc
  v_mul_u32_u24 v92, 48, v3
  v_add_u32 v9, v91, v92
  v_mov_b32 v12, v93
  v_mov_b32 v13, v93
  v_bfe_u32 v88, v1, 2, 2
  v_lshl_add_u32 v88, v4, 2, v88
  v_mul_u32_u24 v88, 48, v88
  v_and_b32 v89, 3, v1
  v_lshl_add_u32 v88, v89, 3, v88
  s_mul_i32 s56, s24, 1536
  v_add_u32 v88, s56, v88
  v_add_u32 v48, 48384, v88
  v_mul_u32_u24 v89, 48, v3
  v_lshl_add_u32 v89, v4, 3, v89
  v_add_u32 v89, s56, v89
  v_add_u32 v60, 74496, v89
  v_add_u32 v88, 0, v1
  v_mul_u32_u24 v89, 820, v88
  v_lshrrev_b32 v89, 16, v89
  v_mul_u32_u24 v90, 80, v89
  v_sub_u32 v90, v88, v90
  v_lshrrev_b32 v91, 4, v90
  v_and_b32 v90, 15, v90
  v_lshl_add_u32 v92, v89, 4, v90
  s_lshl_b32 s56, s24, 5
  s_add_u32 s56, s56, 16
  v_add_u32 v92, s56, v92
  v_mul_u32_u24 v92, 48, v92
  v_lshlrev_b32 v93, 1, v91
  v_lshlrev_b32 v94, 3, v93
  v_add_u32 v95, 80600, v94
  v_add_u32 v94, 73728, v94
  v_cmp_gt_u32 vcc, 5, v93
  s_nop 1
  v_cndmask_b32 v94, v95, v94, vcc
  v_add_u32 v93, 1, v93
  v_lshlrev_b32 v95, 3, v93
  v_add_u32 v96, 80600, v95
  v_add_u32 v95, 73728, v95
  v_cmp_gt_u32 vcc, 5, v93
  s_nop 1
  v_cndmask_b32 v95, v96, v95, vcc
  v_add_u32 v50, v94, v92
  v_add_u32 v53, v95, v92
  v_mul_u32_u24 v93, 20480, v89
  v_lshlrev_b32 v91, 8, v91
  v_add_u32 v93, v93, v91
  v_lshl_add_u32 v56, v90, 4, v93
  v_add_u32 v88, 64, v1
  v_mul_u32_u24 v89, 820, v88
  v_lshrrev_b32 v89, 16, v89
  v_mul_u32_u24 v90, 80, v89
  v_sub_u32 v90, v88, v90
  v_lshrrev_b32 v91, 4, v90
  v_and_b32 v90, 15, v90
  v_lshl_add_u32 v92, v89, 4, v90
  s_lshl_b32 s56, s24, 5
  s_add_u32 s56, s56, 16
  v_add_u32 v92, s56, v92
  v_mul_u32_u24 v92, 48, v92
  v_lshlrev_b32 v93, 1, v91
  v_lshlrev_b32 v94, 3, v93
  v_add_u32 v95, 80600, v94
  v_add_u32 v94, 73728, v94
  v_cmp_gt_u32 vcc, 5, v93
  s_nop 1
  v_cndmask_b32 v94, v95, v94, vcc
  v_add_u32 v93, 1, v93
  v_lshlrev_b32 v95, 3, v93
  v_add_u32 v96, 80600, v95
  v_add_u32 v95, 73728, v95
  v_cmp_gt_u32 vcc, 5, v93
  s_nop 1
  v_cndmask_b32 v95, v96, v95, vcc
  v_add_u32 v51, v94, v92
  v_add_u32 v54, v95, v92
  v_mul_u32_u24 v93, 20480, v89
  v_lshlrev_b32 v91, 8, v91
  v_add_u32 v93, v93, v91
  v_lshl_add_u32 v57, v90, 4, v93
  v_add_u32 v88, 128, v1
  v_mul_u32_u24 v89, 820, v88
  v_lshrrev_b32 v89, 16, v89
  v_mul_u32_u24 v90, 80, v89
  v_sub_u32 v90, v88, v90
  v_lshrrev_b32 v91, 4, v90
  v_and_b32 v90, 15, v90
  v_lshl_add_u32 v92, v89, 4, v90
  s_lshl_b32 s56, s24, 5
  s_add_u32 s56, s56, 16
  v_add_u32 v92, s56, v92
  v_mul_u32_u24 v92, 48, v92
  v_lshlrev_b32 v93, 1, v91
  v_lshlrev_b32 v94, 3, v93
  v_add_u32 v95, 80600, v94
  v_add_u32 v94, 73728, v94
  v_cmp_gt_u32 vcc, 5, v93
  s_nop 1
  v_cndmask_b32 v94, v95, v94, vcc
  v_add_u32 v93, 1, v93
  v_lshlrev_b32 v95, 3, v93
  v_add_u32 v96, 80600, v95
  v_add_u32 v95, 73728, v95
  v_cmp_gt_u32 vcc, 5, v93
  s_nop 1
  v_cndmask_b32 v95, v96, v95, vcc
  v_add_u32 v52, v94, v92
  v_add_u32 v55, v95, v92
  v_mul_u32_u24 v93, 20480, v89
  v_lshlrev_b32 v91, 8, v91
  v_add_u32 v93, v93, v91
  v_lshl_add_u32 v58, v90, 4, v93
  v_lshlrev_b32 v59, 3, v3
  v_add_u32 v59, 162688, v59
  v_cmp_le_u32 vcc, 10, v1
  s_nop 1
  v_cndmask_b32 v88, 0, 1, vcc
  v_mul_u32_u24 v89, 10, v88
  v_sub_u32 v89, v1, v89
  v_mul_u32_u24 v88, 20480, v88
  v_lshl_add_u32 v63, v89, 7, v88
  s_lshr_b32 s56, s26, 3
  s_lshl_b32 s56, s56, 2
  s_lshl_b32 s57, s25, 3
  s_add_u32 s56, s56, s57
  s_add_u32 s90, s56, s24
  s_and_b32 s56, s26, 7
  s_mul_i32 s57, s56, 10
  v_lshrrev_b32 v88, 1, v4
  v_add_u32 v88, s57, v88
  v_lshlrev_b32 v88, 8, v88
  v_lshl_add_u32 v88, v3, 4, v88
  v_and_b32 v89, 1, v4
  v_lshl_add_u32 v66, v89, 3, v88
  v_lshlrev_b32 v88, 6, v3
  s_lshl_b32 s57, s56, 3
  v_add_u32 v68, s57, v88
  v_lshlrev_b32 v104, 2, v4
  v_mov_b32 v107, 0xf149f2ca
  v_add_u32 v105, 0, v104
  v_sub_u32 v106, v105, v3
  v_and_b32 v108, 1, v106
  v_cmp_eq_u32 vcc, 0, v108
  v_cmp_le_i32 s[56:57], 2, v106
  s_nop 2
  s_and_b64 s[56:57], s[56:57], vcc
  v_cndmask_b32 v32, v107, 0, s[56:57]
  v_cmp_ge_i32 s[56:57], 0, v106
  s_nop 2
  s_and_b64 s[56:57], s[56:57], vcc
  v_cndmask_b32 v36, v107, 0, s[56:57]
  v_add_u32 v105, 1, v104
  v_sub_u32 v106, v105, v3
  v_and_b32 v108, 1, v106
  v_cmp_eq_u32 vcc, 0, v108
  v_cmp_le_i32 s[56:57], 2, v106
  s_nop 2
  s_and_b64 s[56:57], s[56:57], vcc
  v_cndmask_b32 v33, v107, 0, s[56:57]
  v_cmp_ge_i32 s[56:57], 0, v106
  s_nop 2
  s_and_b64 s[56:57], s[56:57], vcc
  v_cndmask_b32 v37, v107, 0, s[56:57]
  v_add_u32 v105, 2, v104
  v_sub_u32 v106, v105, v3
  v_and_b32 v108, 1, v106
  v_cmp_eq_u32 vcc, 0, v108
  v_cmp_le_i32 s[56:57], 2, v106
  s_nop 2
  s_and_b64 s[56:57], s[56:57], vcc
  v_cndmask_b32 v34, v107, 0, s[56:57]
  v_cmp_ge_i32 s[56:57], 0, v106
  s_nop 2
  s_and_b64 s[56:57], s[56:57], vcc
  v_cndmask_b32 v38, v107, 0, s[56:57]
  v_add_u32 v105, 3, v104
  v_sub_u32 v106, v105, v3
  v_and_b32 v108, 1, v106
  v_cmp_eq_u32 vcc, 0, v108
  v_cmp_le_i32 s[56:57], 2, v106
  s_nop 2
  s_and_b64 s[56:57], s[56:57], vcc
  v_cndmask_b32 v35, v107, 0, s[56:57]
  v_cmp_ge_i32 s[56:57], 0, v106
  s_nop 2
  s_and_b64 s[56:57], s[56:57], vcc
  v_cndmask_b32 v39, v107, 0, s[56:57]
  s_or_b32 s56, s25, s24
  s_cmp_eq_u32 s56, 0
  s_cselect_b64 vcc, -1, 0
  v_cndmask_b32 v40, v32, v107, vcc
  v_cndmask_b32 v41, v33, v107, vcc
  v_cndmask_b32 v42, v34, v107, vcc
  v_cndmask_b32 v43, v35, v107, vcc
  v_cmp_gt_u32 vcc, 2, v4
  s_nop 1
  v_cndmask_b32 v44, 0, -1, vcc
  v_cmp_gt_u32 vcc, 3, v4
  s_nop 1
  v_cndmask_b32 v45, 0, -1, vcc
  v_min_u32 v104, 2, v4
  v_lshlrev_b32 v104, 4, v104
  v_mul_u32_u24 v105, 48, v3
  v_add_u32 v104, v104, v105
  s_mul_i32 s56, s24, 1536
  v_add_u32 v104, s56, v104
  v_add_u32 v46, 74496, v104
  v_add_u32 v47, 11520, v104
  s_waitcnt vmcnt(24)
  v_add_f32 v152, v152, v154
  v_add_f32 v156, v156, v158
  v_add_f32 v153, v153, v155
  v_add_f32 v157, v157, v159
  v_add_f32_dpp v152, v152, v152 quad_perm:[1,0,3,2] row_mask:0xf bank_mask:0xf
  v_add_f32_dpp v156, v156, v156 quad_perm:[1,0,3,2] row_mask:0xf bank_mask:0xf
  v_add_f32_dpp v153, v153, v153 quad_perm:[1,0,3,2] row_mask:0xf bank_mask:0xf
  v_add_f32_dpp v157, v157, v157 quad_perm:[1,0,3,2] row_mask:0xf bank_mask:0xf
  v_add_f32_dpp v152, v152, v152 quad_perm:[2,3,0,1] row_mask:0xf bank_mask:0xf
  v_add_f32_dpp v156, v156, v156 quad_perm:[2,3,0,1] row_mask:0xf bank_mask:0xf
  v_add_f32_dpp v153, v153, v153 quad_perm:[2,3,0,1] row_mask:0xf bank_mask:0xf
  v_add_f32_dpp v157, v157, v157 quad_perm:[2,3,0,1] row_mask:0xf bank_mask:0xf
  v_mul_f32 v152, 0x3acccccd, v152
  v_mul_f32 v156, 0x3acccccd, v156
  v_mul_f32 v153, 0x3acccccd, v153
  v_mul_f32 v157, 0x3acccccd, v157
  v_fma_f32 v153, -v152, v152, v153
  v_fma_f32 v157, -v156, v156, v157
  v_max_f32 v153, 0, v153
  v_max_f32 v157, 0, v157
  v_add_f32 v153, 0x3727c5ac, v153
  v_add_f32 v157, 0x3727c5ac, v157
  v_rsq_f32 v153, v153
  v_rsq_f32 v157, v157
  v_lshrrev_b32 v164, 2, v1
  v_lshlrev_b32 v164, 3, v164
  s_lshl_b32 s56, s24, 7
  s_add_u32 s56, s56, 162816
  v_add_u32 v154, s56, v164
  ds_write_b64 v154, v[152:153] offset:0
  v_add_u32 v158, s56, v164
  ds_write_b64 v158, v[156:157] offset:512
  v_mov_b32 v82, 0x3f803f80
  v_mov_b32 v83, 0x3f803f80
  v_mov_b32 v84, 0x3f803f80
  v_mov_b32 v85, 0x3f803f80
  s_waitcnt vmcnt(16)
  s_barrier
  ds_read_b128 v[152:155], v5 offset:0
  ds_read_b128 v[156:159], v5 offset:2048
  ds_read_b128 v[160:163], v5 offset:4096
  ds_read_b128 v[164:167], v5 offset:6144
  ds_read_b128 v[168:171], v5 offset:8192
  ds_read_b128 v[172:175], v5 offset:10240
  ds_read_b128 v[176:179], v5 offset:12288
  ds_read_b128 v[180:183], v5 offset:14336
  s_waitcnt lgkmcnt(6)
  v_mfma_f32_16x16x32_bf16 v[88:91], a[0:3], v[152:155], 0
  ds_read_b128 v[184:187], v6 offset:0
  v_mfma_f32_16x16x32_bf16 v[92:95], a[80:83], v[152:155], 0
  v_mfma_f32_16x16x32_bf16 v[96:99], a[0:3], v[156:159], 0
  ds_read_b128 v[188:191], v6 offset:2048
  v_mfma_f32_16x16x32_bf16 v[100:103], a[80:83], v[156:159], 0
  buffer_load_dwordx4 a[24:27], v2, s[4:7], s85 offen
  buffer_load_dwordx4 a[28:31], v2, s[4:7], s85 offen offset:1024
  s_add_u32 s85, s85, 2048
  s_waitcnt lgkmcnt(6)
  v_mfma_f32_16x16x32_bf16 v[104:107], a[0:3], v[160:163], 0
  ds_read_b128 v[152:155], v6 offset:4096
  v_mfma_f32_16x16x32_bf16 v[108:111], a[80:83], v[160:163], 0
  v_mfma_f32_16x16x32_bf16 v[112:115], a[0:3], v[164:167], 0
  ds_read_b128 v[156:159], v6 offset:6144
  s_add_u32 m0, s52, 49152
  v_mfma_f32_16x16x32_bf16 v[116:119], a[80:83], v[164:167], 0
  buffer_load_dwordx4 v2, s[8:11], s46 offen sc1 lds
  buffer_load_dwordx4 v2, s[8:11], s46 offen offset:1024 sc1 lds
  s_add_u32 s46, s46, 2048
  s_waitcnt lgkmcnt(6)
  v_mfma_f32_16x16x32_bf16 v[120:123], a[0:3], v[168:171], 0
  ds_read_b128 v[160:163], v6 offset:8192
  v_mfma_f32_16x16x32_bf16 v[124:127], a[80:83], v[168:171], 0
  v_mfma_f32_16x16x32_bf16 v[128:131], a[0:3], v[172:175], 0
  ds_read_b128 v[164:167], v6 offset:10240
  v_mfma_f32_16x16x32_bf16 v[132:135], a[80:83], v[172:175], 0
  s_waitcnt lgkmcnt(6)
  v_mfma_f32_16x16x32_bf16 v[136:139], a[0:3], v[176:179], 0
  ds_read_b128 v[168:171], v6 offset:12288
  v_mfma_f32_16x16x32_bf16 v[140:143], a[80:83], v[176:179], 0
  v_mfma_f32_16x16x32_bf16 v[144:147], a[0:3], v[180:183], 0
  ds_read_b128 v[172:175], v6 offset:14336
  v_mfma_f32_16x16x32_bf16 v[148:151], a[80:83], v[180:183], 0
  v_mfma_f32_16x16x32_bf16 v[14:17], a[0:3], v[82:85], 0
  v_mfma_f32_16x16x32_bf16 v[18:21], a[80:83], v[82:85], 0
  s_waitcnt vmcnt(12) lgkmcnt(0)
  s_barrier
  v_mfma_f32_16x16x32_bf16 v[88:91], a[4:7], v[184:187], v[88:91]
  ds_read_b128 v[176:179], v5 offset:16384
  v_mfma_f32_16x16x32_bf16 v[92:95], a[84:87], v[184:187], v[92:95]
  v_mfma_f32_16x16x32_bf16 v[96:99], a[4:7], v[188:191], v[96:99]
  ds_read_b128 v[180:183], v5 offset:18432
  v_mfma_f32_16x16x32_bf16 v[100:103], a[84:87], v[188:191], v[100:103]
  buffer_load_dwordx4 a[104:107], v2, s[4:7], s91 offen
  buffer_load_dwordx4 a[108:111], v2, s[4:7], s91 offen offset:1024
  s_add_u32 s91, s91, 2048
  v_mfma_f32_16x16x32_bf16 v[104:107], a[4:7], v[152:155], v[104:107]
  ds_read_b128 v[184:187], v5 offset:20480
  v_mfma_f32_16x16x32_bf16 v[108:111], a[84:87], v[152:155], v[108:111]
  v_mfma_f32_16x16x32_bf16 v[112:115], a[4:7], v[156:159], v[112:115]
  ds_read_b128 v[188:191], v5 offset:22528
  s_add_u32 m0, s52, 51200
  v_mfma_f32_16x16x32_bf16 v[116:119], a[84:87], v[156:159], v[116:119]
  buffer_load_dwordx4 v2, s[8:11], s48 offen sc1 lds
  buffer_load_dwordx4 v2, s[8:11], s48 offen offset:1024 sc1 lds
  s_add_u32 s48, s48, 2048
  v_mfma_f32_16x16x32_bf16 v[120:123], a[4:7], v[160:163], v[120:123]
  ds_read_b128 v[152:155], v5 offset:24576
  v_mfma_f32_16x16x32_bf16 v[124:127], a[84:87], v[160:163], v[124:127]
  v_mfma_f32_16x16x32_bf16 v[128:131], a[4:7], v[164:167], v[128:131]
  ds_read_b128 v[156:159], v5 offset:26624
  v_mfma_f32_16x16x32_bf16 v[132:135], a[84:87], v[164:167], v[132:135]
  v_mfma_f32_16x16x32_bf16 v[136:139], a[4:7], v[168:171], v[136:139]
  ds_read_b128 v[160:163], v5 offset:28672
  v_mfma_f32_16x16x32_bf16 v[140:143], a[84:87], v[168:171], v[140:143]
  v_mfma_f32_16x16x32_bf16 v[144:147], a[4:7], v[172:175], v[144:147]
  ds_read_b128 v[164:167], v5 offset:30720
  v_mfma_f32_16x16x32_bf16 v[148:151], a[84:87], v[172:175], v[148:151]
  v_mfma_f32_16x16x32_bf16 v[14:17], a[4:7], v[82:85], v[14:17]
  v_mfma_f32_16x16x32_bf16 v[18:21], a[84:87], v[82:85], v[18:21]
  s_waitcnt lgkmcnt(6)
  v_mfma_f32_16x16x32_bf16 v[88:91], a[8:11], v[176:179], v[88:91]
  ds_read_b128 v[168:171], v6 offset:16384
  v_mfma_f32_16x16x32_bf16 v[92:95], a[88:91], v[176:179], v[92:95]
  v_mfma_f32_16x16x32_bf16 v[96:99], a[8:11], v[180:183], v[96:99]
  ds_read_b128 v[172:175], v6 offset:18432
  v_mfma_f32_16x16x32_bf16 v[100:103], a[88:91], v[180:183], v[100:103]
  buffer_load_dwordx4 a[32:35], v2, s[4:7], s85 offen
  buffer_load_dwordx4 a[36:39], v2, s[4:7], s85 offen offset:1024
  s_add_u32 s85, s85, 2048
  s_waitcnt lgkmcnt(6)
  v_mfma_f32_16x16x32_bf16 v[104:107], a[8:11], v[184:187], v[104:107]
  ds_read_b128 v[176:179], v6 offset:20480
  v_mfma_f32_16x16x32_bf16 v[108:111], a[88:91], v[184:187], v[108:111]
  v_mfma_f32_16x16x32_bf16 v[112:115], a[8:11], v[188:191], v[112:115]
  ds_read_b128 v[180:183], v6 offset:22528
  s_add_u32 m0, s52, 0
  v_mfma_f32_16x16x32_bf16 v[116:119], a[88:91], v[188:191], v[116:119]
  buffer_load_dwordx4 v2, s[8:11], s46 offen sc1 lds
  buffer_load_dwordx4 v2, s[8:11], s46 offen offset:1024 sc1 lds
  s_add_u32 s46, s46, 2048
  s_waitcnt lgkmcnt(6)
  v_mfma_f32_16x16x32_bf16 v[120:123], a[8:11], v[152:155], v[120:123]
  ds_read_b128 v[184:187], v6 offset:24576
  v_mfma_f32_16x16x32_bf16 v[124:127], a[88:91], v[152:155], v[124:127]
  v_mfma_f32_16x16x32_bf16 v[128:131], a[8:11], v[156:159], v[128:131]
  ds_read_b128 v[188:191], v6 offset:26624
  v_mfma_f32_16x16x32_bf16 v[132:135], a[88:91], v[156:159], v[132:135]
  s_waitcnt lgkmcnt(6)
  v_mfma_f32_16x16x32_bf16 v[136:139], a[8:11], v[160:163], v[136:139]
  ds_read_b128 v[152:155], v6 offset:28672
  v_mfma_f32_16x16x32_bf16 v[140:143], a[88:91], v[160:163], v[140:143]
  v_mfma_f32_16x16x32_bf16 v[144:147], a[8:11], v[164:167], v[144:147]
  ds_read_b128 v[156:159], v6 offset:30720
  v_mfma_f32_16x16x32_bf16 v[148:151], a[88:91], v[164:167], v[148:151]
  v_mfma_f32_16x16x32_bf16 v[14:17], a[8:11], v[82:85], v[14:17]
  v_mfma_f32_16x16x32_bf16 v[18:21], a[88:91], v[82:85], v[18:21]
  s_waitcnt vmcnt(12) lgkmcnt(0)
  s_barrier
  v_mfma_f32_16x16x32_bf16 v[88:91], a[12:15], v[168:171], v[88:91]
  ds_read_b128 v[160:163], v5 offset:32768
  v_mfma_f32_16x16x32_bf16 v[92:95], a[92:95], v[168:171], v[92:95]
  v_mfma_f32_16x16x32_bf16 v[96:99], a[12:15], v[172:175], v[96:99]
  ds_read_b128 v[164:167], v5 offset:34816
  v_mfma_f32_16x16x32_bf16 v[100:103], a[92:95], v[172:175], v[100:103]
  buffer_load_dwordx4 a[112:115], v2, s[4:7], s91 offen
  buffer_load_dwordx4 a[116:119], v2, s[4:7], s91 offen offset:1024
  s_add_u32 s91, s91, 2048
  v_mfma_f32_16x16x32_bf16 v[104:107], a[12:15], v[176:179], v[104:107]
  ds_read_b128 v[168:171], v5 offset:36864
  v_mfma_f32_16x16x32_bf16 v[108:111], a[92:95], v[176:179], v[108:111]
  v_mfma_f32_16x16x32_bf16 v[112:115], a[12:15], v[180:183], v[112:115]
  ds_read_b128 v[172:175], v5 offset:38912
  s_add_u32 m0, s52, 2048
  v_mfma_f32_16x16x32_bf16 v[116:119], a[92:95], v[180:183], v[116:119]
  buffer_load_dwordx4 v2, s[8:11], s48 offen sc1 lds
  buffer_load_dwordx4 v2, s[8:11], s48 offen offset:1024 sc1 lds
  s_add_u32 s48, s48, 2048
  v_mfma_f32_16x16x32_bf16 v[120:123], a[12:15], v[184:187], v[120:123]
  ds_read_b128 v[176:179], v5 offset:40960
  v_mfma_f32_16x16x32_bf16 v[124:127], a[92:95], v[184:187], v[124:127]
  v_mfma_f32_16x16x32_bf16 v[128:131], a[12:15], v[188:191], v[128:131]
  ds_read_b128 v[180:183], v5 offset:43008
  v_mfma_f32_16x16x32_bf16 v[132:135], a[92:95], v[188:191], v[132:135]
  v_mfma_f32_16x16x32_bf16 v[136:139], a[12:15], v[152:155], v[136:139]
  ds_read_b128 v[184:187], v5 offset:45056
  v_mfma_f32_16x16x32_bf16 v[140:143], a[92:95], v[152:155], v[140:143]
  v_mfma_f32_16x16x32_bf16 v[144:147], a[12:15], v[156:159], v[144:147]
  ds_read_b128 v[188:191], v5 offset:47104
  v_mfma_f32_16x16x32_bf16 v[148:151], a[92:95], v[156:159], v[148:151]
  v_mfma_f32_16x16x32_bf16 v[14:17], a[12:15], v[82:85], v[14:17]
  v_mfma_f32_16x16x32_bf16 v[18:21], a[92:95], v[82:85], v[18:21]
  s_waitcnt lgkmcnt(6)
  v_mfma_f32_16x16x32_bf16 v[88:91], a[16:19], v[160:163], v[88:91]
  ds_read_b128 v[152:155], v6 offset:32768
  v_mfma_f32_16x16x32_bf16 v[92:95], a[96:99], v[160:163], v[92:95]
  v_mfma_f32_16x16x32_bf16 v[96:99], a[16:19], v[164:167], v[96:99]
  ds_read_b128 v[156:159], v6 offset:34816
  v_mfma_f32_16x16x32_bf16 v[100:103], a[96:99], v[164:167], v[100:103]
  buffer_load_dwordx4 a[40:43], v2, s[4:7], s85 offen
  buffer_load_dwordx4 a[44:47], v2, s[4:7], s85 offen offset:1024
  s_add_u32 s85, s85, 2048
  s_waitcnt lgkmcnt(6)
  v_mfma_f32_16x16x32_bf16 v[104:107], a[16:19], v[168:171], v[104:107]
  ds_read_b128 v[160:163], v6 offset:36864
  v_mfma_f32_16x16x32_bf16 v[108:111], a[96:99], v[168:171], v[108:111]
  v_mfma_f32_16x16x32_bf16 v[112:115], a[16:19], v[172:175], v[112:115]
  ds_read_b128 v[164:167], v6 offset:38912
  s_add_u32 m0, s52, 16384
  v_mfma_f32_16x16x32_bf16 v[116:119], a[96:99], v[172:175], v[116:119]
  buffer_load_dwordx4 v2, s[8:11], s46 offen sc1 lds
  buffer_load_dwordx4 v2, s[8:11], s46 offen offset:1024 sc1 lds
  s_add_u32 s46, s46, 2048
  s_waitcnt lgkmcnt(6)
  v_mfma_f32_16x16x32_bf16 v[120:123], a[16:19], v[176:179], v[120:123]
  ds_read_b128 v[168:171], v6 offset:40960
  v_mfma_f32_16x16x32_bf16 v[124:127], a[96:99], v[176:179], v[124:127]
  v_mfma_f32_16x16x32_bf16 v[128:131], a[16:19], v[180:183], v[128:131]
  ds_read_b128 v[172:175], v6 offset:43008
  v_mfma_f32_16x16x32_bf16 v[132:135], a[96:99], v[180:183], v[132:135]
  s_waitcnt lgkmcnt(6)
  v_mfma_f32_16x16x32_bf16 v[136:139], a[16:19], v[184:187], v[136:139]
  ds_read_b128 v[176:179], v6 offset:45056
  v_mfma_f32_16x16x32_bf16 v[140:143], a[96:99], v[184:187], v[140:143]
  v_mfma_f32_16x16x32_bf16 v[144:147], a[16:19], v[188:191], v[144:147]
  ds_read_b128 v[180:183], v6 offset:47104
  v_mfma_f32_16x16x32_bf16 v[148:151], a[96:99], v[188:191], v[148:151]
  v_mfma_f32_16x16x32_bf16 v[14:17], a[16:19], v[82:85], v[14:17]
  v_mfma_f32_16x16x32_bf16 v[18:21], a[96:99], v[82:85], v[18:21]
  s_waitcnt vmcnt(12) lgkmcnt(0)
  s_barrier
  v_mfma_f32_16x16x32_bf16 v[88:91], a[20:23], v[152:155], v[88:91]
  ds_read_b128 v[184:187], v5 offset:49152
  v_mfma_f32_16x16x32_bf16 v[92:95], a[100:103], v[152:155], v[92:95]
  v_mfma_f32_16x16x32_bf16 v[96:99], a[20:23], v[156:159], v[96:99]
  ds_read_b128 v[188:191], v5 offset:51200
  v_mfma_f32_16x16x32_bf16 v[100:103], a[100:103], v[156:159], v[100:103]
  buffer_load_dwordx4 a[120:123], v2, s[4:7], s91 offen
  buffer_load_dwordx4 a[124:127], v2, s[4:7], s91 offen offset:1024
  s_add_u32 s91, s91, 2048
  v_mfma_f32_16x16x32_bf16 v[104:107], a[20:23], v[160:163], v[104:107]
  ds_read_b128 v[152:155], v5 offset:53248
  v_mfma_f32_16x16x32_bf16 v[108:111], a[100:103], v[160:163], v[108:111]
  v_mfma_f32_16x16x32_bf16 v[112:115], a[20:23], v[164:167], v[112:115]
  ds_read_b128 v[156:159], v5 offset:55296
  s_add_u32 m0, s52, 18432
  v_mfma_f32_16x16x32_bf16 v[116:119], a[100:103], v[164:167], v[116:119]
  buffer_load_dwordx4 v2, s[8:11], s48 offen sc1 lds
  buffer_load_dwordx4 v2, s[8:11], s48 offen offset:1024 sc1 lds
  s_add_u32 s48, s48, 2048
  v_mfma_f32_16x16x32_bf16 v[120:123], a[20:23], v[168:171], v[120:123]
  ds_read_b128 v[160:163], v5 offset:57344
  v_mfma_f32_16x16x32_bf16 v[124:127], a[100:103], v[168:171], v[124:127]
  v_mfma_f32_16x16x32_bf16 v[128:131], a[20:23], v[172:175], v[128:131]
  ds_read_b128 v[164:167], v5 offset:59392
  v_mfma_f32_16x16x32_bf16 v[132:135], a[100:103], v[172:175], v[132:135]
  v_mfma_f32_16x16x32_bf16 v[136:139], a[20:23], v[176:179], v[136:139]
  ds_read_b128 v[168:171], v5 offset:61440
  v_mfma_f32_16x16x32_bf16 v[140:143], a[100:103], v[176:179], v[140:143]
  v_mfma_f32_16x16x32_bf16 v[144:147], a[20:23], v[180:183], v[144:147]
  ds_read_b128 v[172:175], v5 offset:63488
  v_mfma_f32_16x16x32_bf16 v[148:151], a[100:103], v[180:183], v[148:151]
  v_mfma_f32_16x16x32_bf16 v[14:17], a[20:23], v[82:85], v[14:17]
  v_mfma_f32_16x16x32_bf16 v[18:21], a[100:103], v[82:85], v[18:21]
  s_waitcnt lgkmcnt(6)
  v_mfma_f32_16x16x32_bf16 v[88:91], a[24:27], v[184:187], v[88:91]
  ds_read_b128 v[176:179], v6 offset:49152
  v_mfma_f32_16x16x32_bf16 v[92:95], a[104:107], v[184:187], v[92:95]
  v_mfma_f32_16x16x32_bf16 v[96:99], a[24:27], v[188:191], v[96:99]
  ds_read_b128 v[180:183], v6 offset:51200
  v_mfma_f32_16x16x32_bf16 v[100:103], a[104:107], v[188:191], v[100:103]
  buffer_load_dwordx4 a[48:51], v2, s[4:7], s85 offen
  buffer_load_dwordx4 a[52:55], v2, s[4:7], s85 offen offset:1024
  s_add_u32 s85, s85, 2048
  s_waitcnt lgkmcnt(6)
  v_mfma_f32_16x16x32_bf16 v[104:107], a[24:27], v[152:155], v[104:107]
  ds_read_b128 v[184:187], v6 offset:53248
  v_mfma_f32_16x16x32_bf16 v[108:111], a[104:107], v[152:155], v[108:111]
  v_mfma_f32_16x16x32_bf16 v[112:115], a[24:27], v[156:159], v[112:115]
  ds_read_b128 v[188:191], v6 offset:55296
  s_add_u32 m0, s52, 32768
  v_mfma_f32_16x16x32_bf16 v[116:119], a[104:107], v[156:159], v[116:119]
  buffer_load_dwordx4 v2, s[8:11], s46 offen sc1 lds
  buffer_load_dwordx4 v2, s[8:11], s46 offen offset:1024 sc1 lds
  s_add_u32 s46, s46, 2048
  s_waitcnt lgkmcnt(6)
  v_mfma_f32_16x16x32_bf16 v[120:123], a[24:27], v[160:163], v[120:123]
  ds_read_b128 v[152:155], v6 offset:57344
  v_mfma_f32_16x16x32_bf16 v[124:127], a[104:107], v[160:163], v[124:127]
  v_mfma_f32_16x16x32_bf16 v[128:131], a[24:27], v[164:167], v[128:131]
  ds_read_b128 v[156:159], v6 offset:59392
  v_mfma_f32_16x16x32_bf16 v[132:135], a[104:107], v[164:167], v[132:135]
  s_waitcnt lgkmcnt(6)
  v_mfma_f32_16x16x32_bf16 v[136:139], a[24:27], v[168:171], v[136:139]
  ds_read_b128 v[160:163], v6 offset:61440
  v_mfma_f32_16x16x32_bf16 v[140:143], a[104:107], v[168:171], v[140:143]
  v_mfma_f32_16x16x32_bf16 v[144:147], a[24:27], v[172:175], v[144:147]
  ds_read_b128 v[164:167], v6 offset:63488
  v_mfma_f32_16x16x32_bf16 v[148:151], a[104:107], v[172:175], v[148:151]
  v_mfma_f32_16x16x32_bf16 v[14:17], a[24:27], v[82:85], v[14:17]
  v_mfma_f32_16x16x32_bf16 v[18:21], a[104:107], v[82:85], v[18:21]
  s_waitcnt vmcnt(12) lgkmcnt(0)
  s_barrier
  v_mfma_f32_16x16x32_bf16 v[88:91], a[28:31], v[176:179], v[88:91]
  ds_read_b128 v[168:171], v5 offset:0
  v_mfma_f32_16x16x32_bf16 v[92:95], a[108:111], v[176:179], v[92:95]
  v_mfma_f32_16x16x32_bf16 v[96:99], a[28:31], v[180:183], v[96:99]
  ds_read_b128 v[172:175], v5 offset:2048
  v_mfma_f32_16x16x32_bf16 v[100:103], a[108:111], v[180:183], v[100:103]
  buffer_load_dwordx4 a[128:131], v2, s[4:7], s91 offen
  buffer_load_dwordx4 a[132:135], v2, s[4:7], s91 offen offset:1024
  s_add_u32 s91, s91, 2048
  v_mfma_f32_16x16x32_bf16 v[104:107], a[28:31], v[184:187], v[104:107]
  ds_read_b128 v[176:179], v5 offset:4096
  v_mfma_f32_16x16x32_bf16 v[108:111], a[108:111], v[184:187], v[108:111]
  v_mfma_f32_16x16x32_bf16 v[112:115], a[28:31], v[188:191], v[112:115]
  ds_read_b128 v[180:183], v5 offset:6144
  s_add_u32 m0, s52, 34816
  v_mfma_f32_16x16x32_bf16 v[116:119], a[108:111], v[188:191], v[116:119]
  buffer_load_dwordx4 v2, s[8:11], s48 offen sc1 lds
  buffer_load_dwordx4 v2, s[8:11], s48 offen offset:1024 sc1 lds
  s_add_u32 s48, s48, 2048
  v_mfma_f32_16x16x32_bf16 v[120:123], a[28:31], v[152:155], v[120:123]
  ds_read_b128 v[184:187], v5 offset:8192
  v_mfma_f32_16x16x32_bf16 v[124:127], a[108:111], v[152:155], v[124:127]
  v_mfma_f32_16x16x32_bf16 v[128:131], a[28:31], v[156:159], v[128:131]
  ds_read_b128 v[188:191], v5 offset:10240
  v_mfma_f32_16x16x32_bf16 v[132:135], a[108:111], v[156:159], v[132:135]
  v_mfma_f32_16x16x32_bf16 v[136:139], a[28:31], v[160:163], v[136:139]
  ds_read_b128 v[152:155], v5 offset:12288
  v_mfma_f32_16x16x32_bf16 v[140:143], a[108:111], v[160:163], v[140:143]
  v_mfma_f32_16x16x32_bf16 v[144:147], a[28:31], v[164:167], v[144:147]
  ds_read_b128 v[156:159], v5 offset:14336
  v_mfma_f32_16x16x32_bf16 v[148:151], a[108:111], v[164:167], v[148:151]
  v_mfma_f32_16x16x32_bf16 v[14:17], a[28:31], v[82:85], v[14:17]
  v_mfma_f32_16x16x32_bf16 v[18:21], a[108:111], v[82:85], v[18:21]
  s_waitcnt lgkmcnt(6)
  v_mfma_f32_16x16x32_bf16 v[88:91], a[32:35], v[168:171], v[88:91]
  ds_read_b128 v[160:163], v6 offset:0
  v_mfma_f32_16x16x32_bf16 v[92:95], a[112:115], v[168:171], v[92:95]
  v_mfma_f32_16x16x32_bf16 v[96:99], a[32:35], v[172:175], v[96:99]
  ds_read_b128 v[164:167], v6 offset:2048
  v_mfma_f32_16x16x32_bf16 v[100:103], a[112:115], v[172:175], v[100:103]
  buffer_load_dwordx4 a[56:59], v2, s[4:7], s85 offen
  buffer_load_dwordx4 a[60:63], v2, s[4:7], s85 offen offset:1024
  s_add_u32 s85, s85, 2048
  s_waitcnt lgkmcnt(6)
  v_mfma_f32_16x16x32_bf16 v[104:107], a[32:35], v[176:179], v[104:107]
  ds_read_b128 v[168:171], v6 offset:4096
  v_mfma_f32_16x16x32_bf16 v[108:111], a[112:115], v[176:179], v[108:111]
  v_mfma_f32_16x16x32_bf16 v[112:115], a[32:35], v[180:183], v[112:115]
  ds_read_b128 v[172:175], v6 offset:6144
  s_add_u32 m0, s52, 49152
  v_mfma_f32_16x16x32_bf16 v[116:119], a[112:115], v[180:183], v[116:119]
  buffer_load_dwordx4 v2, s[8:11], s46 offen sc1 lds
  buffer_load_dwordx4 v2, s[8:11], s46 offen offset:1024 sc1 lds
  s_add_u32 s46, s46, 2048
  s_waitcnt lgkmcnt(6)
  v_mfma_f32_16x16x32_bf16 v[120:123], a[32:35], v[184:187], v[120:123]
  ds_read_b128 v[176:179], v6 offset:8192
  v_mfma_f32_16x16x32_bf16 v[124:127], a[112:115], v[184:187], v[124:127]
  v_mfma_f32_16x16x32_bf16 v[128:131], a[32:35], v[188:191], v[128:131]
  ds_read_b128 v[180:183], v6 offset:10240
  v_mfma_f32_16x16x32_bf16 v[132:135], a[112:115], v[188:191], v[132:135]
  s_waitcnt lgkmcnt(6)
  v_mfma_f32_16x16x32_bf16 v[136:139], a[32:35], v[152:155], v[136:139]
  ds_read_b128 v[184:187], v6 offset:12288
  v_mfma_f32_16x16x32_bf16 v[140:143], a[112:115], v[152:155], v[140:143]
  v_mfma_f32_16x16x32_bf16 v[144:147], a[32:35], v[156:159], v[144:147]
  ds_read_b128 v[188:191], v6 offset:14336
  v_mfma_f32_16x16x32_bf16 v[148:151], a[112:115], v[156:159], v[148:151]
  v_mfma_f32_16x16x32_bf16 v[14:17], a[32:35], v[82:85], v[14:17]
  v_mfma_f32_16x16x32_bf16 v[18:21], a[112:115], v[82:85], v[18:21]
  s_waitcnt vmcnt(12) lgkmcnt(0)
  s_barrier
  v_mfma_f32_16x16x32_bf16 v[88:91], a[36:39], v[160:163], v[88:91]
  ds_read_b128 v[152:155], v5 offset:16384
  v_mfma_f32_16x16x32_bf16 v[92:95], a[116:119], v[160:163], v[92:95]
  v_mfma_f32_16x16x32_bf16 v[96:99], a[36:39], v[164:167], v[96:99]
  ds_read_b128 v[156:159], v5 offset:18432
  v_mfma_f32_16x16x32_bf16 v[100:103], a[116:119], v[164:167], v[100:103]
  buffer_load_dwordx4 a[136:139], v2, s[4:7], s91 offen
  buffer_load_dwordx4 a[140:143], v2, s[4:7], s91 offen offset:1024
  s_add_u32 s91, s91, 2048
  v_mfma_f32_16x16x32_bf16 v[104:107], a[36:39], v[168:171], v[104:107]
  ds_read_b128 v[160:163], v5 offset:20480
  v_mfma_f32_16x16x32_bf16 v[108:111], a[116:119], v[168:171], v[108:111]
  v_mfma_f32_16x16x32_bf16 v[112:115], a[36:39], v[172:175], v[112:115]
  ds_read_b128 v[164:167], v5 offset:22528
  s_add_u32 m0, s52, 51200
  v_mfma_f32_16x16x32_bf16 v[116:119], a[116:119], v[172:175], v[116:119]
  buffer_load_dwordx4 v2, s[8:11], s48 offen sc1 lds
  buffer_load_dwordx4 v2, s[8:11], s48 offen offset:1024 sc1 lds
  s_add_u32 s48, s48, 2048
  v_mfma_f32_16x16x32_bf16 v[120:123], a[36:39], v[176:179], v[120:123]
  ds_read_b128 v[168:171], v5 offset:24576
  v_mfma_f32_16x16x32_bf16 v[124:127], a[116:119], v[176:179], v[124:127]
  v_mfma_f32_16x16x32_bf16 v[128:131], a[36:39], v[180:183], v[128:131]
  ds_read_b128 v[172:175], v5 offset:26624
  v_mfma_f32_16x16x32_bf16 v[132:135], a[116:119], v[180:183], v[132:135]
  v_mfma_f32_16x16x32_bf16 v[136:139], a[36:39], v[184:187], v[136:139]
  ds_read_b128 v[176:179], v5 offset:28672
  v_mfma_f32_16x16x32_bf16 v[140:143], a[116:119], v[184:187], v[140:143]
  v_mfma_f32_16x16x32_bf16 v[144:147], a[36:39], v[188:191], v[144:147]
  ds_read_b128 v[180:183], v5 offset:30720
  v_mfma_f32_16x16x32_bf16 v[148:151], a[116:119], v[188:191], v[148:151]
  v_mfma_f32_16x16x32_bf16 v[14:17], a[36:39], v[82:85], v[14:17]
  v_mfma_f32_16x16x32_bf16 v[18:21], a[116:119], v[82:85], v[18:21]
  s_waitcnt lgkmcnt(6)
  v_mfma_f32_16x16x32_bf16 v[88:91], a[40:43], v[152:155], v[88:91]
  ds_read_b128 v[184:187], v6 offset:16384
  v_mfma_f32_16x16x32_bf16 v[92:95], a[120:123], v[152:155], v[92:95]
  v_mfma_f32_16x16x32_bf16 v[96:99], a[40:43], v[156:159], v[96:99]
  ds_read_b128 v[188:191], v6 offset:18432
  v_mfma_f32_16x16x32_bf16 v[100:103], a[120:123], v[156:159], v[100:103]
  buffer_load_dwordx4 a[64:67], v2, s[4:7], s85 offen
  buffer_load_dwordx4 a[68:71], v2, s[4:7], s85 offen offset:1024
  s_add_u32 s85, s85, 2048
  s_waitcnt lgkmcnt(6)
  v_mfma_f32_16x16x32_bf16 v[104:107], a[40:43], v[160:163], v[104:107]
  ds_read_b128 v[152:155], v6 offset:20480
  v_mfma_f32_16x16x32_bf16 v[108:111], a[120:123], v[160:163], v[108:111]
  v_mfma_f32_16x16x32_bf16 v[112:115], a[40:43], v[164:167], v[112:115]
  ds_read_b128 v[156:159], v6 offset:22528
  s_add_u32 m0, s52, 0
  v_mfma_f32_16x16x32_bf16 v[116:119], a[120:123], v[164:167], v[116:119]
  buffer_load_dwordx4 v2, s[8:11], s46 offen sc1 lds
  buffer_load_dwordx4 v2, s[8:11], s46 offen offset:1024 sc1 lds
  s_add_u32 s46, s46, 2048
  s_waitcnt lgkmcnt(6)
  v_mfma_f32_16x16x32_bf16 v[120:123], a[40:43], v[168:171], v[120:123]
  ds_read_b128 v[160:163], v6 offset:24576
  v_mfma_f32_16x16x32_bf16 v[124:127], a[120:123], v[168:171], v[124:127]
  v_mfma_f32_16x16x32_bf16 v[128:131], a[40:43], v[172:175], v[128:131]
  ds_read_b128 v[164:167], v6 offset:26624
  v_mfma_f32_16x16x32_bf16 v[132:135], a[120:123], v[172:175], v[132:135]
  s_waitcnt lgkmcnt(6)
  v_mfma_f32_16x16x32_bf16 v[136:139], a[40:43], v[176:179], v[136:139]
  ds_read_b128 v[168:171], v6 offset:28672
  v_mfma_f32_16x16x32_bf16 v[140:143], a[120:123], v[176:179], v[140:143]
  v_mfma_f32_16x16x32_bf16 v[144:147], a[40:43], v[180:183], v[144:147]
  ds_read_b128 v[172:175], v6 offset:30720
  v_mfma_f32_16x16x32_bf16 v[148:151], a[120:123], v[180:183], v[148:151]
  v_mfma_f32_16x16x32_bf16 v[14:17], a[40:43], v[82:85], v[14:17]
  v_mfma_f32_16x16x32_bf16 v[18:21], a[120:123], v[82:85], v[18:21]
  s_waitcnt vmcnt(12) lgkmcnt(0)
  s_barrier
  v_mfma_f32_16x16x32_bf16 v[88:91], a[44:47], v[184:187], v[88:91]
  ds_read_b128 v[176:179], v5 offset:32768
  v_mfma_f32_16x16x32_bf16 v[92:95], a[124:127], v[184:187], v[92:95]
  v_mfma_f32_16x16x32_bf16 v[96:99], a[44:47], v[188:191], v[96:99]
  ds_read_b128 v[180:183], v5 offset:34816
  v_mfma_f32_16x16x32_bf16 v[100:103], a[124:127], v[188:191], v[100:103]
  buffer_load_dwordx4 a[144:147], v2, s[4:7], s91 offen
  buffer_load_dwordx4 a[148:151], v2, s[4:7], s91 offen offset:1024
  s_add_u32 s91, s91, 2048
  v_mfma_f32_16x16x32_bf16 v[104:107], a[44:47], v[152:155], v[104:107]
  ds_read_b128 v[184:187], v5 offset:36864
  v_mfma_f32_16x16x32_bf16 v[108:111], a[124:127], v[152:155], v[108:111]
  v_mfma_f32_16x16x32_bf16 v[112:115], a[44:47], v[156:159], v[112:115]
  ds_read_b128 v[188:191], v5 offset:38912
  s_add_u32 m0, s52, 2048
  v_mfma_f32_16x16x32_bf16 v[116:119], a[124:127], v[156:159], v[116:119]
  buffer_load_dwordx4 v2, s[8:11], s48 offen sc1 lds
  buffer_load_dwordx4 v2, s[8:11], s48 offen offset:1024 sc1 lds
  s_add_u32 s48, s48, 2048
  v_mfma_f32_16x16x32_bf16 v[120:123], a[44:47], v[160:163], v[120:123]
  ds_read_b128 v[152:155], v5 offset:40960
  v_mfma_f32_16x16x32_bf16 v[124:127], a[124:127], v[160:163], v[124:127]
  v_mfma_f32_16x16x32_bf16 v[128:131], a[44:47], v[164:167], v[128:131]
  ds_read_b128 v[156:159], v5 offset:43008
  v_mfma_f32_16x16x32_bf16 v[132:135], a[124:127], v[164:167], v[132:135]
  v_mfma_f32_16x16x32_bf16 v[136:139], a[44:47], v[168:171], v[136:139]
  ds_read_b128 v[160:163], v5 offset:45056
  v_mfma_f32_16x16x32_bf16 v[140:143], a[124:127], v[168:171], v[140:143]
  v_mfma_f32_16x16x32_bf16 v[144:147], a[44:47], v[172:175], v[144:147]
  ds_read_b128 v[164:167], v5 offset:47104
  v_mfma_f32_16x16x32_bf16 v[148:151], a[124:127], v[172:175], v[148:151]
  v_mfma_f32_16x16x32_bf16 v[14:17], a[44:47], v[82:85], v[14:17]
  v_mfma_f32_16x16x32_bf16 v[18:21], a[124:127], v[82:85], v[18:21]
  s_waitcnt lgkmcnt(6)
  v_mfma_f32_16x16x32_bf16 v[88:91], a[48:51], v[176:179], v[88:91]
  ds_read_b128 v[168:171], v6 offset:32768
  v_mfma_f32_16x16x32_bf16 v[92:95], a[128:131], v[176:179], v[92:95]
  v_mfma_f32_16x16x32_bf16 v[96:99], a[48:51], v[180:183], v[96:99]
  ds_read_b128 v[172:175], v6 offset:34816
  v_mfma_f32_16x16x32_bf16 v[100:103], a[128:131], v[180:183], v[100:103]
  buffer_load_dwordx4 a[72:75], v2, s[4:7], s85 offen
  buffer_load_dwordx4 a[76:79], v2, s[4:7], s85 offen offset:1024
  s_add_u32 s85, s85, 2048
  s_waitcnt lgkmcnt(6)
  v_mfma_f32_16x16x32_bf16 v[104:107], a[48:51], v[184:187], v[104:107]
  ds_read_b128 v[176:179], v6 offset:36864
  v_mfma_f32_16x16x32_bf16 v[108:111], a[128:131], v[184:187], v[108:111]
  v_mfma_f32_16x16x32_bf16 v[112:115], a[48:51], v[188:191], v[112:115]
  ds_read_b128 v[180:183], v6 offset:38912
  s_add_u32 m0, s52, 16384
  v_mfma_f32_16x16x32_bf16 v[116:119], a[128:131], v[188:191], v[116:119]
  buffer_load_dwordx4 v2, s[8:11], s46 offen sc1 lds
  buffer_load_dwordx4 v2, s[8:11], s46 offen offset:1024 sc1 lds
  s_add_u32 s46, s46, 2048
  s_waitcnt lgkmcnt(6)
  v_mfma_f32_16x16x32_bf16 v[120:123], a[48:51], v[152:155], v[120:123]
  ds_read_b128 v[184:187], v6 offset:40960
  v_mfma_f32_16x16x32_bf16 v[124:127], a[128:131], v[152:155], v[124:127]
  v_mfma_f32_16x16x32_bf16 v[128:131], a[48:51], v[156:159], v[128:131]
  ds_read_b128 v[188:191], v6 offset:43008
  v_mfma_f32_16x16x32_bf16 v[132:135], a[128:131], v[156:159], v[132:135]
  s_waitcnt lgkmcnt(6)
  v_mfma_f32_16x16x32_bf16 v[136:139], a[48:51], v[160:163], v[136:139]
  ds_read_b128 v[152:155], v6 offset:45056
  v_mfma_f32_16x16x32_bf16 v[140:143], a[128:131], v[160:163], v[140:143]
  v_mfma_f32_16x16x32_bf16 v[144:147], a[48:51], v[164:167], v[144:147]
  ds_read_b128 v[156:159], v6 offset:47104
  v_mfma_f32_16x16x32_bf16 v[148:151], a[128:131], v[164:167], v[148:151]
  v_mfma_f32_16x16x32_bf16 v[14:17], a[48:51], v[82:85], v[14:17]
  v_mfma_f32_16x16x32_bf16 v[18:21], a[128:131], v[82:85], v[18:21]
  s_waitcnt vmcnt(12) lgkmcnt(0)
  s_barrier
  v_mfma_f32_16x16x32_bf16 v[88:91], a[52:55], v[168:171], v[88:91]
  ds_read_b128 v[160:163], v5 offset:49152
  v_mfma_f32_16x16x32_bf16 v[92:95], a[132:135], v[168:171], v[92:95]
  v_mfma_f32_16x16x32_bf16 v[96:99], a[52:55], v[172:175], v[96:99]
  ds_read_b128 v[164:167], v5 offset:51200
  v_mfma_f32_16x16x32_bf16 v[100:103], a[132:135], v[172:175], v[100:103]
  buffer_load_dwordx4 a[152:155], v2, s[4:7], s91 offen
  buffer_load_dwordx4 a[156:159], v2, s[4:7], s91 offen offset:1024
  s_add_u32 s91, s91, 2048
  v_mfma_f32_16x16x32_bf16 v[104:107], a[52:55], v[176:179], v[104:107]
  ds_read_b128 v[168:171], v5 offset:53248
  v_mfma_f32_16x16x32_bf16 v[108:111], a[132:135], v[176:179], v[108:111]
  v_mfma_f32_16x16x32_bf16 v[112:115], a[52:55], v[180:183], v[112:115]
  ds_read_b128 v[172:175], v5 offset:55296
  s_add_u32 m0, s52, 18432
  v_mfma_f32_16x16x32_bf16 v[116:119], a[132:135], v[180:183], v[116:119]
  buffer_load_dwordx4 v2, s[8:11], s48 offen sc1 lds
  buffer_load_dwordx4 v2, s[8:11], s48 offen offset:1024 sc1 lds
  s_add_u32 s48, s48, 2048
  v_mfma_f32_16x16x32_bf16 v[120:123], a[52:55], v[184:187], v[120:123]
  ds_read_b128 v[176:179], v5 offset:57344
  v_mfma_f32_16x16x32_bf16 v[124:127], a[132:135], v[184:187], v[124:127]
  v_mfma_f32_16x16x32_bf16 v[128:131], a[52:55], v[188:191], v[128:131]
  ds_read_b128 v[180:183], v5 offset:59392
  v_mfma_f32_16x16x32_bf16 v[132:135], a[132:135], v[188:191], v[132:135]
  v_mfma_f32_16x16x32_bf16 v[136:139], a[52:55], v[152:155], v[136:139]
  ds_read_b128 v[184:187], v5 offset:61440
  v_mfma_f32_16x16x32_bf16 v[140:143], a[132:135], v[152:155], v[140:143]
  v_mfma_f32_16x16x32_bf16 v[144:147], a[52:55], v[156:159], v[144:147]
  ds_read_b128 v[188:191], v5 offset:63488
  v_mfma_f32_16x16x32_bf16 v[148:151], a[132:135], v[156:159], v[148:151]
  v_mfma_f32_16x16x32_bf16 v[14:17], a[52:55], v[82:85], v[14:17]
  v_mfma_f32_16x16x32_bf16 v[18:21], a[132:135], v[82:85], v[18:21]
  s_mul_i32 s56, s90, 20480
  buffer_load_dwordx2 v[22:23], v66, s[8:11], s56 offen offset:0
  buffer_load_dwordx2 v[24:25], v66, s[8:11], s56 offen offset:512
  buffer_load_dwordx2 v[26:27], v66, s[8:11], s56 offen offset:1024
  buffer_load_dwordx2 v[28:29], v66, s[8:11], s56 offen offset:1536
  buffer_load_dwordx2 v[30:31], v66, s[8:11], s56 offen offset:2048
  s_lshl_b32 s56, s34, 5
  v_mov_b32 v65, s56
  s_mov_b64 exec, 1
  buffer_load_dword v64, v65, s[16:19], 0 offen sc1
  s_mov_b64 exec, -1
  s_mul_i32 s56, s24, 5120
  s_add_u32 m0, s56, 65536
  s_add_u32 s56, s56, s53
  s_add_u32 s57, s56, 4096
  buffer_load_dwordx4 v2, s[4:7], s56 offen offset:0 sc1 lds
  buffer_load_dwordx4 v2, s[4:7], s56 offen offset:1024 sc1 lds
  buffer_load_dwordx4 v2, s[4:7], s56 offen offset:2048 sc1 lds
  buffer_load_dwordx4 v2, s[4:7], s56 offen offset:3072 sc1 lds
  s_add_u32 m0, m0, 4096
  s_nop 0
  buffer_load_dwordx4 v2, s[4:7], s57 offen sc1 lds
  buffer_load_dwordx4 v[78:81], v2, s[4:7], s55 offen sc1
  s_waitcnt lgkmcnt(6)
  v_mfma_f32_16x16x32_bf16 v[88:91], a[56:59], v[160:163], v[88:91]
  ds_read_b128 v[152:155], v6 offset:49152
  v_mfma_f32_16x16x32_bf16 v[92:95], a[136:139], v[160:163], v[92:95]
  v_mfma_f32_16x16x32_bf16 v[96:99], a[56:59], v[164:167], v[96:99]
  ds_read_b128 v[156:159], v6 offset:51200
  s_add_u32 m0, s100, 0
  s_add_u32 s60, s94, 0
  v_mfma_f32_16x16x32_bf16 v[100:103], a[136:139], v[164:167], v[100:103]
  buffer_load_dwordx4 v2, s[4:7], s60 offen lds
  s_waitcnt lgkmcnt(6)
  v_mfma_f32_16x16x32_bf16 v[104:107], a[56:59], v[168:171], v[104:107]
  ds_read_b128 v[160:163], v6 offset:53248
  v_mfma_f32_16x16x32_bf16 v[108:111], a[136:139], v[168:171], v[108:111]
  v_mfma_f32_16x16x32_bf16 v[112:115], a[56:59], v[172:175], v[112:115]
  ds_read_b128 v[164:167], v6 offset:55296
  s_add_u32 m0, s100, 1024
  s_add_u32 s60, s94, 1024
  v_mfma_f32_16x16x32_bf16 v[116:119], a[136:139], v[172:175], v[116:119]
  buffer_load_dwordx4 v2, s[4:7], s60 offen lds
  s_waitcnt lgkmcnt(6)
  v_mfma_f32_16x16x32_bf16 v[120:123], a[56:59], v[176:179], v[120:123]
  ds_read_b128 v[168:171], v6 offset:57344
  v_mfma_f32_16x16x32_bf16 v[124:127], a[136:139], v[176:179], v[124:127]
  v_mfma_f32_16x16x32_bf16 v[128:131], a[56:59], v[180:183], v[128:131]
  ds_read_b128 v[172:175], v6 offset:59392
  s_add_u32 m0, s100, 2048
  s_add_u32 s60, s94, 2048
  v_mfma_f32_16x16x32_bf16 v[132:135], a[136:139], v[180:183], v[132:135]
  buffer_load_dwordx4 v2, s[4:7], s60 offen lds
  s_waitcnt lgkmcnt(6)
  v_mfma_f32_16x16x32_bf16 v[136:139], a[56:59], v[184:187], v[136:139]
  ds_read_b128 v[176:179], v6 offset:61440
  v_mfma_f32_16x16x32_bf16 v[140:143], a[136:139], v[184:187], v[140:143]
  v_mfma_f32_16x16x32_bf16 v[144:147], a[56:59], v[188:191], v[144:147]
  ds_read_b128 v[180:183], v6 offset:63488
  v_mfma_f32_16x16x32_bf16 v[148:151], a[136:139], v[188:191], v[148:151]
  v_mfma_f32_16x16x32_bf16 v[14:17], a[56:59], v[82:85], v[14:17]
  v_mfma_f32_16x16x32_bf16 v[18:21], a[136:139], v[82:85], v[18:21]
  s_waitcnt vmcnt(22) lgkmcnt(0)
  s_barrier
  v_mfma_f32_16x16x32_bf16 v[88:91], a[60:63], v[152:155], v[88:91]
  ds_read_b128 v[184:187], v5 offset:0
  v_mfma_f32_16x16x32_bf16 v[92:95], a[140:143], v[152:155], v[92:95]
  v_mfma_f32_16x16x32_bf16 v[96:99], a[60:63], v[156:159], v[96:99]
  ds_read_b128 v[188:191], v5 offset:2048
  s_add_u32 m0, s100, 3072
  s_add_u32 s60, s94, 3072
  v_mfma_f32_16x16x32_bf16 v[100:103], a[140:143], v[156:159], v[100:103]
  buffer_load_dwordx4 v2, s[4:7], s60 offen lds
  v_mfma_f32_16x16x32_bf16 v[104:107], a[60:63], v[160:163], v[104:107]
  ds_read_b128 v[152:155], v5 offset:4096
  v_mfma_f32_16x16x32_bf16 v[108:111], a[140:143], v[160:163], v[108:111]
  v_mfma_f32_16x16x32_bf16 v[112:115], a[60:63], v[164:167], v[112:115]
  ds_read_b128 v[156:159], v5 offset:6144
  s_add_u32 m0, s100, 4096
  s_add_u32 s60, s94, 4096
  v_mfma_f32_16x16x32_bf16 v[116:119], a[140:143], v[164:167], v[116:119]
  buffer_load_dwordx4 v2, s[4:7], s60 offen lds
  v_mfma_f32_16x16x32_bf16 v[120:123], a[60:63], v[168:171], v[120:123]
  ds_read_b128 v[160:163], v5 offset:8192
  v_mfma_f32_16x16x32_bf16 v[124:127], a[140:143], v[168:171], v[124:127]
  v_mfma_f32_16x16x32_bf16 v[128:131], a[60:63], v[172:175], v[128:131]
  ds_read_b128 v[164:167], v5 offset:10240
  s_add_u32 m0, s100, 5120
  s_add_u32 s60, s94, 5120
  v_mfma_f32_16x16x32_bf16 v[132:135], a[140:143], v[172:175], v[132:135]
  buffer_load_dwordx4 v2, s[4:7], s60 offen lds
  v_mfma_f32_16x16x32_bf16 v[136:139], a[60:63], v[176:179], v[136:139]
  ds_read_b128 v[168:171], v5 offset:12288
  v_mfma_f32_16x16x32_bf16 v[140:143], a[140:143], v[176:179], v[140:143]
  v_mfma_f32_16x16x32_bf16 v[144:147], a[60:63], v[180:183], v[144:147]
  ds_read_b128 v[172:175], v5 offset:14336
  v_mfma_f32_16x16x32_bf16 v[148:151], a[140:143], v[180:183], v[148:151]
  v_mfma_f32_16x16x32_bf16 v[14:17], a[60:63], v[82:85], v[14:17]
  v_mfma_f32_16x16x32_bf16 v[18:21], a[140:143], v[82:85], v[18:21]
  s_waitcnt lgkmcnt(6)
  v_mfma_f32_16x16x32_bf16 v[88:91], a[64:67], v[184:187], v[88:91]
  ds_read_b128 v[176:179], v6 offset:0
  v_mfma_f32_16x16x32_bf16 v[92:95], a[144:147], v[184:187], v[92:95]
  v_mfma_f32_16x16x32_bf16 v[96:99], a[64:67], v[188:191], v[96:99]
  ds_read_b128 v[180:183], v6 offset:2048
  s_add_u32 m0, s100, 6144
  s_add_u32 s60, s94, 6144
  v_mfma_f32_16x16x32_bf16 v[100:103], a[144:147], v[188:191], v[100:103]
  buffer_load_dwordx4 v2, s[4:7], s60 offen lds
  s_waitcnt lgkmcnt(6)
  v_mfma_f32_16x16x32_bf16 v[104:107], a[64:67], v[152:155], v[104:107]
  ds_read_b128 v[184:187], v6 offset:4096
  v_mfma_f32_16x16x32_bf16 v[108:111], a[144:147], v[152:155], v[108:111]
  v_mfma_f32_16x16x32_bf16 v[112:115], a[64:67], v[156:159], v[112:115]
  ds_read_b128 v[188:191], v6 offset:6144
  s_add_u32 m0, s100, 7168
  s_add_u32 s60, s94, 7168
  v_mfma_f32_16x16x32_bf16 v[116:119], a[144:147], v[156:159], v[116:119]
  buffer_load_dwordx4 v2, s[4:7], s60 offen lds
  s_waitcnt lgkmcnt(6)
  v_mfma_f32_16x16x32_bf16 v[120:123], a[64:67], v[160:163], v[120:123]
  ds_read_b128 v[152:155], v6 offset:8192
  v_mfma_f32_16x16x32_bf16 v[124:127], a[144:147], v[160:163], v[124:127]
  v_mfma_f32_16x16x32_bf16 v[128:131], a[64:67], v[164:167], v[128:131]
  ds_read_b128 v[156:159], v6 offset:10240
  s_add_u32 m0, s100, 8192
  s_add_u32 s60, s94, 8192
  v_mfma_f32_16x16x32_bf16 v[132:135], a[144:147], v[164:167], v[132:135]
  buffer_load_dwordx4 v2, s[4:7], s60 offen lds
  s_waitcnt lgkmcnt(6)
  v_mfma_f32_16x16x32_bf16 v[136:139], a[64:67], v[168:171], v[136:139]
  ds_read_b128 v[160:163], v6 offset:12288
  v_mfma_f32_16x16x32_bf16 v[140:143], a[144:147], v[168:171], v[140:143]
  v_mfma_f32_16x16x32_bf16 v[144:147], a[64:67], v[172:175], v[144:147]
  ds_read_b128 v[164:167], v6 offset:14336
  v_mfma_f32_16x16x32_bf16 v[148:151], a[144:147], v[172:175], v[148:151]
  v_mfma_f32_16x16x32_bf16 v[14:17], a[64:67], v[82:85], v[14:17]
  v_mfma_f32_16x16x32_bf16 v[18:21], a[144:147], v[82:85], v[18:21]
  s_waitcnt vmcnt(20) lgkmcnt(0)
  s_barrier
  v_mfma_f32_16x16x32_bf16 v[88:91], a[68:71], v[176:179], v[88:91]
  ds_read_b128 v[168:171], v5 offset:16384
  v_mfma_f32_16x16x32_bf16 v[92:95], a[148:151], v[176:179], v[92:95]
  v_mfma_f32_16x16x32_bf16 v[96:99], a[68:71], v[180:183], v[96:99]
  ds_read_b128 v[172:175], v5 offset:18432
  s_add_u32 m0, s100, 9216
  s_add_u32 s60, s94, 9216
  v_mfma_f32_16x16x32_bf16 v[100:103], a[148:151], v[180:183], v[100:103]
  buffer_load_dwordx4 v2, s[4:7], s60 offen lds
  v_mfma_f32_16x16x32_bf16 v[104:107], a[68:71], v[184:187], v[104:107]
  ds_read_b128 v[176:179], v5 offset:20480
  v_mfma_f32_16x16x32_bf16 v[108:111], a[148:151], v[184:187], v[108:111]
  v_mfma_f32_16x16x32_bf16 v[112:115], a[68:71], v[188:191], v[112:115]
  ds_read_b128 v[180:183], v5 offset:22528
  s_add_u32 m0, s100, 10240
  s_add_u32 s60, s94, 10240
  v_mfma_f32_16x16x32_bf16 v[116:119], a[148:151], v[188:191], v[116:119]
  buffer_load_dwordx4 v2, s[4:7], s60 offen lds
  v_mfma_f32_16x16x32_bf16 v[120:123], a[68:71], v[152:155], v[120:123]
  ds_read_b128 v[184:187], v5 offset:24576
  v_mfma_f32_16x16x32_bf16 v[124:127], a[148:151], v[152:155], v[124:127]
  v_mfma_f32_16x16x32_bf16 v[128:131], a[68:71], v[156:159], v[128:131]
  ds_read_b128 v[188:191], v5 offset:26624
  s_add_u32 m0, s100, 11264
  s_add_u32 s60, s94, 11264
  v_mfma_f32_16x16x32_bf16 v[132:135], a[148:151], v[156:159], v[132:135]
  buffer_load_dwordx4 v2, s[4:7], s60 offen lds
  v_mfma_f32_16x16x32_bf16 v[136:139], a[68:71], v[160:163], v[136:139]
  ds_read_b128 v[152:155], v5 offset:28672
  v_mfma_f32_16x16x32_bf16 v[140:143], a[148:151], v[160:163], v[140:143]
  v_mfma_f32_16x16x32_bf16 v[144:147], a[68:71], v[164:167], v[144:147]
  ds_read_b128 v[156:159], v5 offset:30720
  v_mfma_f32_16x16x32_bf16 v[148:151], a[148:151], v[164:167], v[148:151]
  v_mfma_f32_16x16x32_bf16 v[14:17], a[68:71], v[82:85], v[14:17]
  v_mfma_f32_16x16x32_bf16 v[18:21], a[148:151], v[82:85], v[18:21]
  s_waitcnt lgkmcnt(6)
  v_mfma_f32_16x16x32_bf16 v[88:91], a[72:75], v[168:171], v[88:91]
  ds_read_b128 v[160:163], v6 offset:16384
  v_mfma_f32_16x16x32_bf16 v[92:95], a[152:155], v[168:171], v[92:95]
  v_mfma_f32_16x16x32_bf16 v[96:99], a[72:75], v[172:175], v[96:99]
  ds_read_b128 v[164:167], v6 offset:18432
  s_add_u32 m0, s100, 12288
  s_add_u32 s60, s94, 12288
  v_mfma_f32_16x16x32_bf16 v[100:103], a[152:155], v[172:175], v[100:103]
  buffer_load_dwordx4 v2, s[4:7], s60 offen lds
  s_waitcnt lgkmcnt(6)
  v_mfma_f32_16x16x32_bf16 v[104:107], a[72:75], v[176:179], v[104:107]
  ds_read_b128 v[168:171], v6 offset:20480
  v_mfma_f32_16x16x32_bf16 v[108:111], a[152:155], v[176:179], v[108:111]
  v_mfma_f32_16x16x32_bf16 v[112:115], a[72:75], v[180:183], v[112:115]
  ds_read_b128 v[172:175], v6 offset:22528
  s_add_u32 m0, s100, 13312
  s_add_u32 s60, s94, 13312
  v_mfma_f32_16x16x32_bf16 v[116:119], a[152:155], v[180:183], v[116:119]
  buffer_load_dwordx4 v2, s[4:7], s60 offen lds
  s_waitcnt lgkmcnt(6)
  v_mfma_f32_16x16x32_bf16 v[120:123], a[72:75], v[184:187], v[120:123]
  ds_read_b128 v[176:179], v6 offset:24576
  v_mfma_f32_16x16x32_bf16 v[124:127], a[152:155], v[184:187], v[124:127]
  v_mfma_f32_16x16x32_bf16 v[128:131], a[72:75], v[188:191], v[128:131]
  ds_read_b128 v[180:183], v6 offset:26624
  s_add_u32 m0, s100, 14336
  s_add_u32 s60, s94, 14336
  v_mfma_f32_16x16x32_bf16 v[132:135], a[152:155], v[188:191], v[132:135]
  buffer_load_dwordx4 v2, s[4:7], s60 offen lds
  s_waitcnt lgkmcnt(6)
  v_mfma_f32_16x16x32_bf16 v[136:139], a[72:75], v[152:155], v[136:139]
  ds_read_b128 v[184:187], v6 offset:28672
  v_mfma_f32_16x16x32_bf16 v[140:143], a[152:155], v[152:155], v[140:143]
  v_mfma_f32_16x16x32_bf16 v[144:147], a[72:75], v[156:159], v[144:147]
  ds_read_b128 v[188:191], v6 offset:30720
  v_mfma_f32_16x16x32_bf16 v[148:151], a[152:155], v[156:159], v[148:151]
  v_mfma_f32_16x16x32_bf16 v[14:17], a[72:75], v[82:85], v[14:17]
  v_mfma_f32_16x16x32_bf16 v[18:21], a[152:155], v[82:85], v[18:21]
  s_waitcnt lgkmcnt(6)
  v_mfma_f32_16x16x32_bf16 v[88:91], a[76:79], v[160:163], v[88:91]
  v_mfma_f32_16x16x32_bf16 v[92:95], a[156:159], v[160:163], v[92:95]
  v_mfma_f32_16x16x32_bf16 v[96:99], a[76:79], v[164:167], v[96:99]
  s_add_u32 m0, s100, 15360
  s_add_u32 s60, s94, 15360
  v_mfma_f32_16x16x32_bf16 v[100:103], a[156:159], v[164:167], v[100:103]
  buffer_load_dwordx4 v2, s[4:7], s60 offen lds
  s_waitcnt lgkmcnt(4)
  v_mfma_f32_16x16x32_bf16 v[104:107], a[76:79], v[168:171], v[104:107]
  v_mfma_f32_16x16x32_bf16 v[108:111], a[156:159], v[168:171], v[108:111]
  v_mfma_f32_16x16x32_bf16 v[112:115], a[76:79], v[172:175], v[112:115]
  s_add_u32 m0, s100, 16384
  s_add_u32 s60, s94, 16384
  v_mfma_f32_16x16x32_bf16 v[116:119], a[156:159], v[172:175], v[116:119]
  buffer_load_dwordx4 v2, s[4:7], s60 offen lds
  s_waitcnt lgkmcnt(2)
  v_mfma_f32_16x16x32_bf16 v[120:123], a[76:79], v[176:179], v[120:123]
  v_mfma_f32_16x16x32_bf16 v[124:127], a[156:159], v[176:179], v[124:127]
  v_mfma_f32_16x16x32_bf16 v[128:131], a[76:79], v[180:183], v[128:131]
  s_add_u32 m0, s100, 17408
  s_add_u32 s60, s94, 17408
  v_mfma_f32_16x16x32_bf16 v[132:135], a[156:159], v[180:183], v[132:135]
  buffer_load_dwordx4 v2, s[4:7], s60 offen lds
  s_waitcnt lgkmcnt(0)
  v_mfma_f32_16x16x32_bf16 v[136:139], a[76:79], v[184:187], v[136:139]
  v_mfma_f32_16x16x32_bf16 v[140:143], a[156:159], v[184:187], v[140:143]
  v_mfma_f32_16x16x32_bf16 v[144:147], a[76:79], v[188:191], v[144:147]
  v_mfma_f32_16x16x32_bf16 v[148:151], a[156:159], v[188:191], v[148:151]
  v_mfma_f32_16x16x32_bf16 v[14:17], a[76:79], v[82:85], v[14:17]
  v_mfma_f32_16x16x32_bf16 v[18:21], a[156:159], v[82:85], v[18:21]
  s_mov_b64 exec, 1
  s_mov_b32 s95, 0
  s_waitcnt vmcnt(18)
  s_branch L_gpc_4
L_gpp_2:
  buffer_load_dword v64, v65, s[16:19], 0 offen sc1
  s_waitcnt vmcnt(0)
L_gpc_4:
  v_readfirstlane_b32 s56, v64
  s_nop 2
  s_and_b32 s63, s56, 0xff
  s_cmp_ge_u32 s63, 32
  s_cbranch_scc1 L_gpd_3
  s_add_u32 s95, s95, 1
  s_cmp_lt_u32 s95, 0x20000
  s_cbranch_scc1 L_gpp_2
L_gpd_3:
  s_mov_b64 exec, -1
  s_mul_i32 s63, s98, s98
  s_lshl_b32 s63, s63, 21
  s_lshl_b32 s64, s98, 13
  s_add_u32 s63, s63, s64
  s_add_u32 s63, s63, 32
  s_cmp_eq_u32 s56, s63
  s_cselect_b32 s92, 1, 0
  s_cmp_lg_u32 s24, 0
  s_cbranch_scc1 L_hq2_5
  v_add_f32 v78, v78, v80
  v_add_f32 v79, v79, v81
  s_nop 0
  v_add_f32_dpp v78, v78, v78 quad_perm:[1,0,3,2] row_mask:0xf bank_mask:0xf
  v_add_f32_dpp v79, v79, v79 quad_perm:[1,0,3,2] row_mask:0xf bank_mask:0xf
  s_nop 0
  v_add_f32_dpp v78, v78, v78 quad_perm:[2,3,0,1] row_mask:0xf bank_mask:0xf
  v_add_f32_dpp v79, v79, v79 quad_perm:[2,3,0,1] row_mask:0xf bank_mask:0xf
  v_mul_f32 v78, 0x3acccccd, v78
  v_mul_f32 v79, 0x3acccccd, v79
  v_fma_f32 v79, -v78, v78, v79
  v_max_f32 v79, 0, v79
  v_add_f32 v79, 0x3727c5ac, v79
  v_rsq_f32 v79, v79
  v_lshrrev_b32 v84, 2, v1
  v_lshlrev_b32 v84, 3, v84
  s_lshl_b32 s56, s24, 7
  s_add_u32 s56, s56, 162816
  v_add_u32 v80, 162688, v84
  ds_write_b64 v80, v[78:79]
L_hq2_5:
  s_lshl_b32 s56, s25, 3
  s_lshl_b32 s57, s24, 1
  s_add_u32 s56, s56, s57
  s_mul_i32 s56, s56, 20480
  s_mul_i32 s57, s26, 1280
  s_add_u32 s56, s56, s57
  s_add_u32 s56, s56, s84
  s_mov_b32 exec_lo, 0xfffff
  s_mov_b32 exec_hi, 0
  buffer_load_dword v64, v63, s[4:7], s56 offen
  s_cmp_eq_u32 s27, 4
  s_cbranch_scc1 L_ot_6
  v_lshlrev_b32 v65, 7, v1
  s_mul_i32 s56, s90, 20480
  s_and_b32 s57, s26, 7
  s_mul_i32 s57, s57, 2560
  s_add_u32 s56, s56, s57
  s_add_u32 s56, s56, s82
  s_lshl_b32 s57, s90, 10
  s_add_u32 s57, s57, s83
  buffer_load_dword v64, v65, s[12:15], s56 offen
  s_mov_b32 exec_lo, 0xff
  buffer_load_dword v64, v65, s[4:7], s57 offen
L_ot_6:
  s_mov_b64 exec, -1
  s_barrier
  v_add_u32 v78, 65536, v5
  v_add_u32 v79, 65536, v6
  ds_read_b128 v[160:163], v78 offset:0
  ds_read_b128 v[164:167], v79 offset:0
  ds_read_b128 v[168:171], v78 offset:2048
  ds_read_b128 v[172:175], v79 offset:2048
  ds_read_b128 v[176:179], v78 offset:4096
  ds_read_b128 v[180:183], v79 offset:4096
  ds_read_b128 v[184:187], v78 offset:6144
  ds_read_b128 v[188:191], v79 offset:6144
  s_waitcnt lgkmcnt(7)
  v_mfma_f32_16x16x32_bf16 v[152:155], a[0:3], v[160:163], 0
  v_mfma_f32_16x16x32_bf16 v[156:159], a[80:83], v[160:163], 0
  ds_read_b128 v[160:163], v78 offset:8192
  s_waitcnt lgkmcnt(7)
  v_mfma_f32_16x16x32_bf16 v[152:155], a[4:7], v[164:167], v[152:155]
  v_mfma_f32_16x16x32_bf16 v[156:159], a[84:87], v[164:167], v[156:159]
  ds_read_b128 v[164:167], v79 offset:8192
  s_waitcnt lgkmcnt(7)
  v_mfma_f32_16x16x32_bf16 v[152:155], a[8:11], v[168:171], v[152:155]
  v_mfma_f32_16x16x32_bf16 v[156:159], a[88:91], v[168:171], v[156:159]
  ds_read_b128 v[168:171], v78 offset:10240
  s_waitcnt lgkmcnt(7)
  v_mfma_f32_16x16x32_bf16 v[152:155], a[12:15], v[172:175], v[152:155]
  v_mfma_f32_16x16x32_bf16 v[156:159], a[92:95], v[172:175], v[156:159]
  ds_read_b128 v[172:175], v79 offset:10240
  s_waitcnt lgkmcnt(7)
  v_mfma_f32_16x16x32_bf16 v[152:155], a[16:19], v[176:179], v[152:155]
  v_mfma_f32_16x16x32_bf16 v[156:159], a[96:99], v[176:179], v[156:159]
  ds_read_b128 v[176:179], v78 offset:12288
  s_waitcnt lgkmcnt(7)
  v_mfma_f32_16x16x32_bf16 v[152:155], a[20:23], v[180:183], v[152:155]
  v_mfma_f32_16x16x32_bf16 v[156:159], a[100:103], v[180:183], v[156:159]
  ds_read_b128 v[180:183], v79 offset:12288
  s_waitcnt lgkmcnt(7)
  v_mfma_f32_16x16x32_bf16 v[152:155], a[24:27], v[184:187], v[152:155]
  v_mfma_f32_16x16x32_bf16 v[156:159], a[104:107], v[184:187], v[156:159]
  ds_read_b128 v[184:187], v78 offset:14336
  s_waitcnt lgkmcnt(7)
  v_mfma_f32_16x16x32_bf16 v[152:155], a[28:31], v[188:191], v[152:155]
  v_mfma_f32_16x16x32_bf16 v[156:159], a[108:111], v[188:191], v[156:159]
  ds_read_b128 v[188:191], v79 offset:14336
  s_waitcnt lgkmcnt(7)
  v_mfma_f32_16x16x32_bf16 v[152:155], a[32:35], v[160:163], v[152:155]
  v_mfma_f32_16x16x32_bf16 v[156:159], a[112:115], v[160:163], v[156:159]
  ds_read_b128 v[160:163], v78 offset:16384
  s_waitcnt lgkmcnt(7)
  v_mfma_f32_16x16x32_bf16 v[152:155], a[36:39], v[164:167], v[152:155]
  v_mfma_f32_16x16x32_bf16 v[156:159], a[116:119], v[164:167], v[156:159]
  ds_read_b128 v[164:167], v79 offset:16384
  s_waitcnt lgkmcnt(7)
  v_mfma_f32_16x16x32_bf16 v[152:155], a[40:43], v[168:171], v[152:155]
  v_mfma_f32_16x16x32_bf16 v[156:159], a[120:123], v[168:171], v[156:159]
  ds_read_b128 v[168:171], v78 offset:18432
  s_waitcnt lgkmcnt(7)
  v_mfma_f32_16x16x32_bf16 v[152:155], a[44:47], v[172:175], v[152:155]
  v_mfma_f32_16x16x32_bf16 v[156:159], a[124:127], v[172:175], v[156:159]
  ds_read_b128 v[172:175], v79 offset:18432
  s_waitcnt lgkmcnt(7)
  v_mfma_f32_16x16x32_bf16 v[152:155], a[48:51], v[176:179], v[152:155]
  v_mfma_f32_16x16x32_bf16 v[156:159], a[128:131], v[176:179], v[156:159]
  s_waitcnt lgkmcnt(6)
  v_mfma_f32_16x16x32_bf16 v[152:155], a[52:55], v[180:183], v[152:155]
  v_mfma_f32_16x16x32_bf16 v[156:159], a[132:135], v[180:183], v[156:159]
  s_waitcnt lgkmcnt(5)
  v_mfma_f32_16x16x32_bf16 v[152:155], a[56:59], v[184:187], v[152:155]
  v_mfma_f32_16x16x32_bf16 v[156:159], a[136:139], v[184:187], v[156:159]
  s_waitcnt lgkmcnt(4)
  v_mfma_f32_16x16x32_bf16 v[152:155], a[60:63], v[188:191], v[152:155]
  v_mfma_f32_16x16x32_bf16 v[156:159], a[140:143], v[188:191], v[156:159]
  s_waitcnt lgkmcnt(3)
  v_mfma_f32_16x16x32_bf16 v[152:155], a[64:67], v[160:163], v[152:155]
  v_mfma_f32_16x16x32_bf16 v[156:159], a[144:147], v[160:163], v[156:159]
  s_waitcnt lgkmcnt(2)
  v_mfma_f32_16x16x32_bf16 v[152:155], a[68:71], v[164:167], v[152:155]
  v_mfma_f32_16x16x32_bf16 v[156:159], a[148:151], v[164:167], v[156:159]
  s_waitcnt lgkmcnt(1)
  v_mfma_f32_16x16x32_bf16 v[152:155], a[72:75], v[168:171], v[152:155]
  v_mfma_f32_16x16x32_bf16 v[156:159], a[152:155], v[168:171], v[156:159]
  s_waitcnt lgkmcnt(0)
  v_mfma_f32_16x16x32_bf16 v[152:155], a[76:79], v[172:175], v[152:155]
  v_mfma_f32_16x16x32_bf16 v[156:159], a[156:159], v[172:175], v[156:159]
  s_branch L_a_epi1
L_layer:
  s_cmp_eq_u32 s27, 2
  s_cbranch_scc0 L_is2_7
  s_lshl_b32 s56, s26, 3
  s_lshl_b32 s57, s24, 1
  s_add_u32 s56, s56, s57
  s_mul_i32 s56, s56, 20480
  s_add_u32 s85, s56, 0x4280000
  s_add_u32 s91, s85, 20480
  buffer_load_dwordx4 a[160:163], v2, s[4:7], s85 offen
  buffer_load_dwordx4 a[164:167], v2, s[4:7], s85 offen offset:1024
  s_add_u32 s85, s85, 2048
  buffer_load_dwordx4 a[240:243], v2, s[4:7], s91 offen
  buffer_load_dwordx4 a[244:247], v2, s[4:7], s91 offen offset:1024
  s_add_u32 s91, s91, 2048
  buffer_load_dwordx4 a[168:171], v2, s[4:7], s85 offen
  buffer_load_dwordx4 a[172:175], v2, s[4:7], s85 offen offset:1024
  s_add_u32 s85, s85, 2048
  buffer_load_dwordx4 a[248:251], v2, s[4:7], s91 offen
  buffer_load_dwordx4 a[252:255], v2, s[4:7], s91 offen offset:1024
  s_add_u32 s91, s91, 2048
L_is2_7:
  s_lshl_b32 s56, s25, 8
  s_add_u32 s56, s56, 0x3400000
  s_lshl_b32 s88, s27, 1
  s_sub_u32 s88, s88, 2
  v_lshlrev_b32 v97, 2, v1
  v_add_u32 v97, s56, v97
  s_mov_b32 exec_lo, 0xffffffff
  s_mov_b32 exec_hi, 0xffffffff
  s_mov_b32 s95, 0
L_poll_9:
  buffer_load_dword v96, v97, s[4:7], 0 offen sc1
  s_waitcnt vmcnt(0)
  v_cmp_le_u32 vcc, s88, v96
  s_nop 1
  s_nop 0
  s_cmp_eq_u64 vcc, exec
  s_cbranch_scc1 L_pd_10
  s_add_u32 s95, s95, 1
  s_cmp_lt_u32 s95, 0x20000
  s_cbranch_scc1 L_poll_9
L_pd_10:
  s_mov_b64 exec, -1
  s_cmp_eq_u32 s96, 1
  s_cbranch_scc0 L_nx_11
  s_lshl_b32 s60, s25, 8
  s_lshl_b32 s61, s26, 2
  s_add_u32 s60, s60, s61
  s_add_u32 s60, s60, 0x3418000
  v_mov_b32 v96, 1
  v_mov_b32 v97, s60
  s_mov_b64 exec, 1
  buffer_store_dword v96, v97, s[4:7], 0 offen sc1
  s_mov_b64 exec, -1
L_nx_11:
  s_cmp_eq_u32 s27, 2
  s_cbranch_scc1 L_l2
  s_add_u32 m0, s52, 0
  s_nop 0
  buffer_load_dwordx4 v2, s[8:11], s46 offen sc1 lds
  buffer_load_dwordx4 v2, s[8:11], s46 offen offset:1024 sc1 lds
  s_add_u32 s46, s46, 2048
  s_add_u32 m0, s52, 2048
  s_nop 0
  buffer_load_dwordx4 v2, s[8:11], s48 offen sc1 lds
  buffer_load_dwordx4 v2, s[8:11], s48 offen offset:1024 sc1 lds
  s_add_u32 s48, s48, 2048
  s_lshl_b32 s56, s24, 10
  s_add_u32 s56, s56, 0
  s_add_u32 s56, s56, s54
  buffer_load_dwordx4 v[80:83], v2, s[4:7], s56 offen sc1
  s_lshl_b32 s56, s24, 10
  s_add_u32 s56, s56, 4096
  s_add_u32 s56, s56, s54
  buffer_load_dwordx4 v[84:87], v2, s[4:7], s56 offen sc1
  s_add_u32 m0, s52, 16384
  s_nop 0
  buffer_load_dwordx4 v2, s[8:11], s46 offen sc1 lds
  buffer_load_dwordx4 v2, s[8:11], s46 offen offset:1024 sc1 lds
  s_add_u32 s46, s46, 2048
  s_add_u32 m0, s52, 18432
  s_nop 0
  buffer_load_dwordx4 v2, s[8:11], s48 offen sc1 lds
  buffer_load_dwordx4 v2, s[8:11], s48 offen offset:1024 sc1 lds
  s_add_u32 s48, s48, 2048
  s_add_u32 m0, s52, 32768
  s_nop 0
  buffer_load_dwordx4 v2, s[8:11], s46 offen sc1 lds
  buffer_load_dwordx4 v2, s[8:11], s46 offen offset:1024 sc1 lds
  s_add_u32 s46, s46, 2048
  s_add_u32 m0, s52, 34816
  s_nop 0
  buffer_load_dwordx4 v2, s[8:11], s48 offen sc1 lds
  buffer_load_dwordx4 v2, s[8:11], s48 offen offset:1024 sc1 lds
  s_add_u32 s48, s48, 2048
  s_cmp_eq_u32 s89, 1
  s_cbranch_scc1 L_l4
  s_waitcnt vmcnt(10)
  s_barrier
  ds_read_b128 v[152:155], v5 offset:0
  ds_read_b128 v[156:159], v5 offset:2048
  ds_read_b128 v[160:163], v5 offset:4096
  ds_read_b128 v[164:167], v5 offset:6144
  ds_read_b128 v[168:171], v5 offset:8192
  ds_read_b128 v[172:175], v5 offset:10240
  ds_read_b128 v[176:179], v5 offset:12288
  ds_read_b128 v[180:183], v5 offset:14336
  s_waitcnt lgkmcnt(6)
  v_mfma_f32_16x16x32_bf16 v[88:91], a[0:3], v[152:155], 0
  ds_read_b128 v[184:187], v6 offset:0
  v_mfma_f32_16x16x32_bf16 v[92:95], a[80:83], v[152:155], 0
  v_mfma_f32_16x16x32_bf16 v[96:99], a[0:3], v[156:159], 0
  ds_read_b128 v[188:191], v6 offset:2048
  s_add_u32 m0, s52, 49152
  v_mfma_f32_16x16x32_bf16 v[100:103], a[80:83], v[156:159], 0
  buffer_load_dwordx4 v2, s[8:11], s46 offen sc1 lds
  buffer_load_dwordx4 v2, s[8:11], s46 offen offset:1024 sc1 lds
  s_add_u32 s46, s46, 2048
  s_waitcnt lgkmcnt(6)
  v_mfma_f32_16x16x32_bf16 v[104:107], a[0:3], v[160:163], 0
  ds_read_b128 v[152:155], v6 offset:4096
  v_mfma_f32_16x16x32_bf16 v[108:111], a[80:83], v[160:163], 0
  v_mfma_f32_16x16x32_bf16 v[112:115], a[0:3], v[164:167], 0
  ds_read_b128 v[156:159], v6 offset:6144
  s_add_u32 m0, s100, 0
  s_add_u32 s60, s94, 0
  v_mfma_f32_16x16x32_bf16 v[116:119], a[80:83], v[164:167], 0
  buffer_load_dwordx4 v2, s[4:7], s60 offen lds
  s_waitcnt lgkmcnt(6)
  v_mfma_f32_16x16x32_bf16 v[120:123], a[0:3], v[168:171], 0
  ds_read_b128 v[160:163], v6 offset:8192
  v_mfma_f32_16x16x32_bf16 v[124:127], a[80:83], v[168:171], 0
  v_mfma_f32_16x16x32_bf16 v[128:131], a[0:3], v[172:175], 0
  ds_read_b128 v[164:167], v6 offset:10240
  s_add_u32 m0, s100, 1024
  s_add_u32 s60, s94, 1024
  v_mfma_f32_16x16x32_bf16 v[132:135], a[80:83], v[172:175], 0
  buffer_load_dwordx4 v2, s[4:7], s60 offen lds
  s_waitcnt lgkmcnt(6)
  v_mfma_f32_16x16x32_bf16 v[136:139], a[0:3], v[176:179], 0
  ds_read_b128 v[168:171], v6 offset:12288
  v_mfma_f32_16x16x32_bf16 v[140:143], a[80:83], v[176:179], 0
  v_mfma_f32_16x16x32_bf16 v[144:147], a[0:3], v[180:183], 0
  ds_read_b128 v[172:175], v6 offset:14336
  v_mfma_f32_16x16x32_bf16 v[148:151], a[80:83], v[180:183], 0
  s_waitcnt vmcnt(8) lgkmcnt(0)
  s_barrier
  v_add_f32 v80, v80, v82
  v_add_f32 v84, v84, v86
  v_add_f32 v81, v81, v83
  v_add_f32 v85, v85, v87
  v_add_f32_dpp v80, v80, v80 quad_perm:[1,0,3,2] row_mask:0xf bank_mask:0xf
  v_add_f32_dpp v84, v84, v84 quad_perm:[1,0,3,2] row_mask:0xf bank_mask:0xf
  v_add_f32_dpp v81, v81, v81 quad_perm:[1,0,3,2] row_mask:0xf bank_mask:0xf
  v_add_f32_dpp v85, v85, v85 quad_perm:[1,0,3,2] row_mask:0xf bank_mask:0xf
  v_add_f32_dpp v80, v80, v80 quad_perm:[2,3,0,1] row_mask:0xf bank_mask:0xf
  v_add_f32_dpp v84, v84, v84 quad_perm:[2,3,0,1] row_mask:0xf bank_mask:0xf
  v_add_f32_dpp v81, v81, v81 quad_perm:[2,3,0,1] row_mask:0xf bank_mask:0xf
  v_add_f32_dpp v85, v85, v85 quad_perm:[2,3,0,1] row_mask:0xf bank_mask:0xf
  v_mul_f32 v80, 0x3acccccd, v80
  v_mul_f32 v84, 0x3acccccd, v84
  v_mul_f32 v81, 0x3acccccd, v81
  v_mul_f32 v85, 0x3acccccd, v85
  v_fma_f32 v81, -v80, v80, v81
  v_fma_f32 v85, -v84, v84, v85
  v_max_f32 v81, 0, v81
  v_max_f32 v85, 0, v85
  v_add_f32 v81, 0x3727c5ac, v81
  v_add_f32 v85, 0x3727c5ac, v85
  v_rsq_f32 v81, v81
  v_rsq_f32 v85, v85
  v_lshrrev_b32 v64, 2, v1
  v_lshlrev_b32 v64, 3, v64
  s_lshl_b32 s56, s24, 7
  s_add_u32 s56, s56, 162816
  v_add_u32 v82, s56, v64
  ds_write_b64 v82, v[80:81] offset:0
  v_add_u32 v86, s56, v64
  ds_write_b64 v86, v[84:85] offset:512
  v_mfma_f32_16x16x32_bf16 v[88:91], a[4:7], v[184:187], v[88:91]
  ds_read_b128 v[176:179], v5 offset:16384
  v_mfma_f32_16x16x32_bf16 v[92:95], a[84:87], v[184:187], v[92:95]
  v_mfma_f32_16x16x32_bf16 v[96:99], a[4:7], v[188:191], v[96:99]
  ds_read_b128 v[180:183], v5 offset:18432
  s_add_u32 m0, s52, 51200
  v_mfma_f32_16x16x32_bf16 v[100:103], a[84:87], v[188:191], v[100:103]
  buffer_load_dwordx4 v2, s[8:11], s48 offen sc1 lds
  buffer_load_dwordx4 v2, s[8:11], s48 offen offset:1024 sc1 lds
  s_add_u32 s48, s48, 2048
  v_mfma_f32_16x16x32_bf16 v[104:107], a[4:7], v[152:155], v[104:107]
  ds_read_b128 v[184:187], v5 offset:20480
  v_mfma_f32_16x16x32_bf16 v[108:111], a[84:87], v[152:155], v[108:111]
  v_mfma_f32_16x16x32_bf16 v[112:115], a[4:7], v[156:159], v[112:115]
  ds_read_b128 v[188:191], v5 offset:22528
  v_mfma_f32_16x16x32_bf16 v[116:119], a[84:87], v[156:159], v[116:119]
  v_mfma_f32_16x16x32_bf16 v[120:123], a[4:7], v[160:163], v[120:123]
  ds_read_b128 v[152:155], v5 offset:24576
  v_mfma_f32_16x16x32_bf16 v[124:127], a[84:87], v[160:163], v[124:127]
  v_mfma_f32_16x16x32_bf16 v[128:131], a[4:7], v[164:167], v[128:131]
  ds_read_b128 v[156:159], v5 offset:26624
  v_mfma_f32_16x16x32_bf16 v[132:135], a[84:87], v[164:167], v[132:135]
  v_mfma_f32_16x16x32_bf16 v[136:139], a[4:7], v[168:171], v[136:139]
  ds_read_b128 v[160:163], v5 offset:28672
  v_mfma_f32_16x16x32_bf16 v[140:143], a[84:87], v[168:171], v[140:143]
  v_mfma_f32_16x16x32_bf16 v[144:147], a[4:7], v[172:175], v[144:147]
  ds_read_b128 v[164:167], v5 offset:30720
  v_mfma_f32_16x16x32_bf16 v[148:151], a[84:87], v[172:175], v[148:151]
  s_waitcnt lgkmcnt(6)
  v_mfma_f32_16x16x32_bf16 v[88:91], a[8:11], v[176:179], v[88:91]
  ds_read_b128 v[168:171], v6 offset:16384
  v_mfma_f32_16x16x32_bf16 v[92:95], a[88:91], v[176:179], v[92:95]
  v_mfma_f32_16x16x32_bf16 v[96:99], a[8:11], v[180:183], v[96:99]
  ds_read_b128 v[172:175], v6 offset:18432
  s_add_u32 m0, s52, 0
  v_mfma_f32_16x16x32_bf16 v[100:103], a[88:91], v[180:183], v[100:103]
  buffer_load_dwordx4 v2, s[8:11], s46 offen sc1 lds
  buffer_load_dwordx4 v2, s[8:11], s46 offen offset:1024 sc1 lds
  s_add_u32 s46, s46, 2048
  s_waitcnt lgkmcnt(6)
  v_mfma_f32_16x16x32_bf16 v[104:107], a[8:11], v[184:187], v[104:107]
  ds_read_b128 v[176:179], v6 offset:20480
  v_mfma_f32_16x16x32_bf16 v[108:111], a[88:91], v[184:187], v[108:111]
  v_mfma_f32_16x16x32_bf16 v[112:115], a[8:11], v[188:191], v[112:115]
  ds_read_b128 v[180:183], v6 offset:22528
  s_add_u32 m0, s100, 2048
  s_add_u32 s60, s94, 2048
  v_mfma_f32_16x16x32_bf16 v[116:119], a[88:91], v[188:191], v[116:119]
  buffer_load_dwordx4 v2, s[4:7], s60 offen lds
  s_waitcnt lgkmcnt(6)
  v_mfma_f32_16x16x32_bf16 v[120:123], a[8:11], v[152:155], v[120:123]
  ds_read_b128 v[184:187], v6 offset:24576
  v_mfma_f32_16x16x32_bf16 v[124:127], a[88:91], v[152:155], v[124:127]
  v_mfma_f32_16x16x32_bf16 v[128:131], a[8:11], v[156:159], v[128:131]
  ds_read_b128 v[188:191], v6 offset:26624
  s_add_u32 m0, s100, 3072
  s_add_u32 s60, s94, 3072
  v_mfma_f32_16x16x32_bf16 v[132:135], a[88:91], v[156:159], v[132:135]
  buffer_load_dwordx4 v2, s[4:7], s60 offen lds
  s_waitcnt lgkmcnt(6)
  v_mfma_f32_16x16x32_bf16 v[136:139], a[8:11], v[160:163], v[136:139]
  ds_read_b128 v[152:155], v6 offset:28672
  v_mfma_f32_16x16x32_bf16 v[140:143], a[88:91], v[160:163], v[140:143]
  v_mfma_f32_16x16x32_bf16 v[144:147], a[8:11], v[164:167], v[144:147]
  ds_read_b128 v[156:159], v6 offset:30720
  v_mfma_f32_16x16x32_bf16 v[148:151], a[88:91], v[164:167], v[148:151]
  s_waitcnt vmcnt(10) lgkmcnt(0)
  s_barrier
  v_mfma_f32_16x16x32_bf16 v[88:91], a[12:15], v[168:171], v[88:91]
  ds_read_b128 v[160:163], v5 offset:32768
  v_mfma_f32_16x16x32_bf16 v[92:95], a[92:95], v[168:171], v[92:95]
  v_mfma_f32_16x16x32_bf16 v[96:99], a[12:15], v[172:175], v[96:99]
  ds_read_b128 v[164:167], v5 offset:34816
  s_add_u32 m0, s52, 2048
  v_mfma_f32_16x16x32_bf16 v[100:103], a[92:95], v[172:175], v[100:103]
  buffer_load_dwordx4 v2, s[8:11], s48 offen sc1 lds
  buffer_load_dwordx4 v2, s[8:11], s48 offen offset:1024 sc1 lds
  s_add_u32 s48, s48, 2048
  v_mfma_f32_16x16x32_bf16 v[104:107], a[12:15], v[176:179], v[104:107]
  ds_read_b128 v[168:171], v5 offset:36864
  v_mfma_f32_16x16x32_bf16 v[108:111], a[92:95], v[176:179], v[108:111]
  v_mfma_f32_16x16x32_bf16 v[112:115], a[12:15], v[180:183], v[112:115]
  ds_read_b128 v[172:175], v5 offset:38912
  v_mfma_f32_16x16x32_bf16 v[116:119], a[92:95], v[180:183], v[116:119]
  v_mfma_f32_16x16x32_bf16 v[120:123], a[12:15], v[184:187], v[120:123]
  ds_read_b128 v[176:179], v5 offset:40960
  v_mfma_f32_16x16x32_bf16 v[124:127], a[92:95], v[184:187], v[124:127]
  v_mfma_f32_16x16x32_bf16 v[128:131], a[12:15], v[188:191], v[128:131]
  ds_read_b128 v[180:183], v5 offset:43008
  v_mfma_f32_16x16x32_bf16 v[132:135], a[92:95], v[188:191], v[132:135]
  v_mfma_f32_16x16x32_bf16 v[136:139], a[12:15], v[152:155], v[136:139]
  ds_read_b128 v[184:187], v5 offset:45056
  v_mfma_f32_16x16x32_bf16 v[140:143], a[92:95], v[152:155], v[140:143]
  v_mfma_f32_16x16x32_bf16 v[144:147], a[12:15], v[156:159], v[144:147]
  ds_read_b128 v[188:191], v5 offset:47104
  v_mfma_f32_16x16x32_bf16 v[148:151], a[92:95], v[156:159], v[148:151]
  s_waitcnt lgkmcnt(6)
  v_mfma_f32_16x16x32_bf16 v[88:91], a[16:19], v[160:163], v[88:91]
  ds_read_b128 v[152:155], v6 offset:32768
  v_mfma_f32_16x16x32_bf16 v[92:95], a[96:99], v[160:163], v[92:95]
  v_mfma_f32_16x16x32_bf16 v[96:99], a[16:19], v[164:167], v[96:99]
  ds_read_b128 v[156:159], v6 offset:34816
  s_add_u32 m0, s52, 16384
  v_mfma_f32_16x16x32_bf16 v[100:103], a[96:99], v[164:167], v[100:103]
  buffer_load_dwordx4 v2, s[8:11], s46 offen sc1 lds
  buffer_load_dwordx4 v2, s[8:11], s46 offen offset:1024 sc1 lds
  s_add_u32 s46, s46, 2048
  s_waitcnt lgkmcnt(6)
  v_mfma_f32_16x16x32_bf16 v[104:107], a[16:19], v[168:171], v[104:107]
  ds_read_b128 v[160:163], v6 offset:36864
  v_mfma_f32_16x16x32_bf16 v[108:111], a[96:99], v[168:171], v[108:111]
  v_mfma_f32_16x16x32_bf16 v[112:115], a[16:19], v[172:175], v[112:115]
  ds_read_b128 v[164:167], v6 offset:38912
  s_add_u32 m0, s100, 4096
  s_add_u32 s60, s94, 4096
  v_mfma_f32_16x16x32_bf16 v[116:119], a[96:99], v[172:175], v[116:119]
  buffer_load_dwordx4 v2, s[4:7], s60 offen lds
  s_waitcnt lgkmcnt(6)
  v_mfma_f32_16x16x32_bf16 v[120:123], a[16:19], v[176:179], v[120:123]
  ds_read_b128 v[168:171], v6 offset:40960
  v_mfma_f32_16x16x32_bf16 v[124:127], a[96:99], v[176:179], v[124:127]
  v_mfma_f32_16x16x32_bf16 v[128:131], a[16:19], v[180:183], v[128:131]
  ds_read_b128 v[172:175], v6 offset:43008
  s_add_u32 m0, s100, 5120
  s_add_u32 s60, s94, 5120
  v_mfma_f32_16x16x32_bf16 v[132:135], a[96:99], v[180:183], v[132:135]
  buffer_load_dwordx4 v2, s[4:7], s60 offen lds
  s_waitcnt lgkmcnt(6)
  v_mfma_f32_16x16x32_bf16 v[136:139], a[16:19], v[184:187], v[136:139]
  ds_read_b128 v[176:179], v6 offset:45056
  v_mfma_f32_16x16x32_bf16 v[140:143], a[96:99], v[184:187], v[140:143]
  v_mfma_f32_16x16x32_bf16 v[144:147], a[16:19], v[188:191], v[144:147]
  ds_read_b128 v[180:183], v6 offset:47104
  v_mfma_f32_16x16x32_bf16 v[148:151], a[96:99], v[188:191], v[148:151]
  s_waitcnt vmcnt(10) lgkmcnt(0)
  s_barrier
  v_mfma_f32_16x16x32_bf16 v[88:91], a[20:23], v[152:155], v[88:91]
  ds_read_b128 v[184:187], v5 offset:49152
  v_mfma_f32_16x16x32_bf16 v[92:95], a[100:103], v[152:155], v[92:95]
  v_mfma_f32_16x16x32_bf16 v[96:99], a[20:23], v[156:159], v[96:99]
  ds_read_b128 v[188:191], v5 offset:51200
  s_add_u32 m0, s52, 18432
  v_mfma_f32_16x16x32_bf16 v[100:103], a[100:103], v[156:159], v[100:103]
  buffer_load_dwordx4 v2, s[8:11], s48 offen sc1 lds
  buffer_load_dwordx4 v2, s[8:11], s48 offen offset:1024 sc1 lds
  s_add_u32 s48, s48, 2048
  v_mfma_f32_16x16x32_bf16 v[104:107], a[20:23], v[160:163], v[104:107]
  ds_read_b128 v[152:155], v5 offset:53248
  v_mfma_f32_16x16x32_bf16 v[108:111], a[100:103], v[160:163], v[108:111]
  v_mfma_f32_16x16x32_bf16 v[112:115], a[20:23], v[164:167], v[112:115]
  ds_read_b128 v[156:159], v5 offset:55296
  v_mfma_f32_16x16x32_bf16 v[116:119], a[100:103], v[164:167], v[116:119]
  v_mfma_f32_16x16x32_bf16 v[120:123], a[20:23], v[168:171], v[120:123]
  ds_read_b128 v[160:163], v5 offset:57344
  v_mfma_f32_16x16x32_bf16 v[124:127], a[100:103], v[168:171], v[124:127]
  v_mfma_f32_16x16x32_bf16 v[128:131], a[20:23], v[172:175], v[128:131]
  ds_read_b128 v[164:167], v5 offset:59392
  v_mfma_f32_16x16x32_bf16 v[132:135], a[100:103], v[172:175], v[132:135]
  v_mfma_f32_16x16x32_bf16 v[136:139], a[20:23], v[176:179], v[136:139]
  ds_read_b128 v[168:171], v5 offset:61440
  v_mfma_f32_16x16x32_bf16 v[140:143], a[100:103], v[176:179], v[140:143]
  v_mfma_f32_16x16x32_bf16 v[144:147], a[20:23], v[180:183], v[144:147]
  ds_read_b128 v[172:175], v5 offset:63488
  v_mfma_f32_16x16x32_bf16 v[148:151], a[100:103], v[180:183], v[148:151]
  s_waitcnt lgkmcnt(6)
  v_mfma_f32_16x16x32_bf16 v[88:91], a[24:27], v[184:187], v[88:91]
  ds_read_b128 v[176:179], v6 offset:49152
  v_mfma_f32_16x16x32_bf16 v[92:95], a[104:107], v[184:187], v[92:95]
  v_mfma_f32_16x16x32_bf16 v[96:99], a[24:27], v[188:191], v[96:99]
  ds_read_b128 v[180:183], v6 offset:51200
  s_add_u32 m0, s52, 32768
  v_mfma_f32_16x16x32_bf16 v[100:103], a[104:107], v[188:191], v[100:103]
  buffer_load_dwordx4 v2, s[8:11], s46 offen sc1 lds
  buffer_load_dwordx4 v2, s[8:11], s46 offen offset:1024 sc1 lds
  s_add_u32 s46, s46, 2048
  s_waitcnt lgkmcnt(6)
  v_mfma_f32_16x16x32_bf16 v[104:107], a[24:27], v[152:155], v[104:107]
  ds_read_b128 v[184:187], v6 offset:53248
  v_mfma_f32_16x16x32_bf16 v[108:111], a[104:107], v[152:155], v[108:111]
  v_mfma_f32_16x16x32_bf16 v[112:115], a[24:27], v[156:159], v[112:115]
  ds_read_b128 v[188:191], v6 offset:55296
  s_add_u32 m0, s100, 6144
  s_add_u32 s60, s94, 6144
  v_mfma_f32_16x16x32_bf16 v[116:119], a[104:107], v[156:159], v[116:119]
  buffer_load_dwordx4 v2, s[4:7], s60 offen lds
  s_waitcnt lgkmcnt(6)
  v_mfma_f32_16x16x32_bf16 v[120:123], a[24:27], v[160:163], v[120:123]
  ds_read_b128 v[152:155], v6 offset:57344
  v_mfma_f32_16x16x32_bf16 v[124:127], a[104:107], v[160:163], v[124:127]
  v_mfma_f32_16x16x32_bf16 v[128:131], a[24:27], v[164:167], v[128:131]
  ds_read_b128 v[156:159], v6 offset:59392
  s_add_u32 m0, s100, 7168
  s_add_u32 s60, s94, 7168
  v_mfma_f32_16x16x32_bf16 v[132:135], a[104:107], v[164:167], v[132:135]
  buffer_load_dwordx4 v2, s[4:7], s60 offen lds
  s_waitcnt lgkmcnt(6)
  v_mfma_f32_16x16x32_bf16 v[136:139], a[24:27], v[168:171], v[136:139]
  ds_read_b128 v[160:163], v6 offset:61440
  v_mfma_f32_16x16x32_bf16 v[140:143], a[104:107], v[168:171], v[140:143]
  v_mfma_f32_16x16x32_bf16 v[144:147], a[24:27], v[172:175], v[144:147]
  ds_read_b128 v[164:167], v6 offset:63488
  v_mfma_f32_16x16x32_bf16 v[148:151], a[104:107], v[172:175], v[148:151]
  s_waitcnt vmcnt(10) lgkmcnt(0)
  s_barrier
  v_mfma_f32_16x16x32_bf16 v[88:91], a[28:31], v[176:179], v[88:91]
  ds_read_b128 v[168:171], v5 offset:0
  v_mfma_f32_16x16x32_bf16 v[92:95], a[108:111], v[176:179], v[92:95]
  v_mfma_f32_16x16x32_bf16 v[96:99], a[28:31], v[180:183], v[96:99]
  ds_read_b128 v[172:175], v5 offset:2048
  s_add_u32 m0, s52, 34816
  v_mfma_f32_16x16x32_bf16 v[100:103], a[108:111], v[180:183], v[100:103]
  buffer_load_dwordx4 v2, s[8:11], s48 offen sc1 lds
  buffer_load_dwordx4 v2, s[8:11], s48 offen offset:1024 sc1 lds
  s_add_u32 s48, s48, 2048
  v_mfma_f32_16x16x32_bf16 v[104:107], a[28:31], v[184:187], v[104:107]
  ds_read_b128 v[176:179], v5 offset:4096
  v_mfma_f32_16x16x32_bf16 v[108:111], a[108:111], v[184:187], v[108:111]
  v_mfma_f32_16x16x32_bf16 v[112:115], a[28:31], v[188:191], v[112:115]
  ds_read_b128 v[180:183], v5 offset:6144
  v_mfma_f32_16x16x32_bf16 v[116:119], a[108:111], v[188:191], v[116:119]
  v_mfma_f32_16x16x32_bf16 v[120:123], a[28:31], v[152:155], v[120:123]
  ds_read_b128 v[184:187], v5 offset:8192
  v_mfma_f32_16x16x32_bf16 v[124:127], a[108:111], v[152:155], v[124:127]
  v_mfma_f32_16x16x32_bf16 v[128:131], a[28:31], v[156:159], v[128:131]
  ds_read_b128 v[188:191], v5 offset:10240
  v_mfma_f32_16x16x32_bf16 v[132:135], a[108:111], v[156:159], v[132:135]
  v_mfma_f32_16x16x32_bf16 v[136:139], a[28:31], v[160:163], v[136:139]
  ds_read_b128 v[152:155], v5 offset:12288
  v_mfma_f32_16x16x32_bf16 v[140:143], a[108:111], v[160:163], v[140:143]
  v_mfma_f32_16x16x32_bf16 v[144:147], a[28:31], v[164:167], v[144:147]
  ds_read_b128 v[156:159], v5 offset:14336
  v_mfma_f32_16x16x32_bf16 v[148:151], a[108:111], v[164:167], v[148:151]
  s_waitcnt lgkmcnt(6)
  v_mfma_f32_16x16x32_bf16 v[88:91], a[32:35], v[168:171], v[88:91]
  ds_read_b128 v[160:163], v6 offset:0
  v_mfma_f32_16x16x32_bf16 v[92:95], a[112:115], v[168:171], v[92:95]
  v_mfma_f32_16x16x32_bf16 v[96:99], a[32:35], v[172:175], v[96:99]
  ds_read_b128 v[164:167], v6 offset:2048
  s_add_u32 m0, s52, 49152
  v_mfma_f32_16x16x32_bf16 v[100:103], a[112:115], v[172:175], v[100:103]
  buffer_load_dwordx4 v2, s[8:11], s46 offen sc1 lds
  buffer_load_dwordx4 v2, s[8:11], s46 offen offset:1024 sc1 lds
  s_add_u32 s46, s46, 2048
  s_waitcnt lgkmcnt(6)
  v_mfma_f32_16x16x32_bf16 v[104:107], a[32:35], v[176:179], v[104:107]
  ds_read_b128 v[168:171], v6 offset:4096
  v_mfma_f32_16x16x32_bf16 v[108:111], a[112:115], v[176:179], v[108:111]
  v_mfma_f32_16x16x32_bf16 v[112:115], a[32:35], v[180:183], v[112:115]
  ds_read_b128 v[172:175], v6 offset:6144
  s_add_u32 m0, s100, 8192
  s_add_u32 s60, s94, 8192
  v_mfma_f32_16x16x32_bf16 v[116:119], a[112:115], v[180:183], v[116:119]
  buffer_load_dwordx4 v2, s[4:7], s60 offen lds
  s_waitcnt lgkmcnt(6)
  v_mfma_f32_16x16x32_bf16 v[120:123], a[32:35], v[184:187], v[120:123]
  ds_read_b128 v[176:179], v6 offset:8192
  v_mfma_f32_16x16x32_bf16 v[124:127], a[112:115], v[184:187], v[124:127]
  v_mfma_f32_16x16x32_bf16 v[128:131], a[32:35], v[188:191], v[128:131]
  ds_read_b128 v[180:183], v6 offset:10240
  s_add_u32 m0, s100, 9216
  s_add_u32 s60, s94, 9216
  v_mfma_f32_16x16x32_bf16 v[132:135], a[112:115], v[188:191], v[132:135]
  buffer_load_dwordx4 v2, s[4:7], s60 offen lds
  s_waitcnt lgkmcnt(6)
  v_mfma_f32_16x16x32_bf16 v[136:139], a[32:35], v[152:155], v[136:139]
  ds_read_b128 v[184:187], v6 offset:12288
  v_mfma_f32_16x16x32_bf16 v[140:143], a[112:115], v[152:155], v[140:143]
  v_mfma_f32_16x16x32_bf16 v[144:147], a[32:35], v[156:159], v[144:147]
  ds_read_b128 v[188:191], v6 offset:14336
  v_mfma_f32_16x16x32_bf16 v[148:151], a[112:115], v[156:159], v[148:151]
  s_waitcnt vmcnt(10) lgkmcnt(0)
  s_barrier
  v_mfma_f32_16x16x32_bf16 v[88:91], a[36:39], v[160:163], v[88:91]
  ds_read_b128 v[152:155], v5 offset:16384
  v_mfma_f32_16x16x32_bf16 v[92:95], a[116:119], v[160:163], v[92:95]
  v_mfma_f32_16x16x32_bf16 v[96:99], a[36:39], v[164:167], v[96:99]
  ds_read_b128 v[156:159], v5 offset:18432
  s_add_u32 m0, s52, 51200
  v_mfma_f32_16x16x32_bf16 v[100:103], a[116:119], v[164:167], v[100:103]
  buffer_load_dwordx4 v2, s[8:11], s48 offen sc1 lds
  buffer_load_dwordx4 v2, s[8:11], s48 offen offset:1024 sc1 lds
  s_add_u32 s48, s48, 2048
  v_mfma_f32_16x16x32_bf16 v[104:107], a[36:39], v[168:171], v[104:107]
  ds_read_b128 v[160:163], v5 offset:20480
  v_mfma_f32_16x16x32_bf16 v[108:111], a[116:119], v[168:171], v[108:111]
  v_mfma_f32_16x16x32_bf16 v[112:115], a[36:39], v[172:175], v[112:115]
  ds_read_b128 v[164:167], v5 offset:22528
  v_mfma_f32_16x16x32_bf16 v[116:119], a[116:119], v[172:175], v[116:119]
  v_mfma_f32_16x16x32_bf16 v[120:123], a[36:39], v[176:179], v[120:123]
  ds_read_b128 v[168:171], v5 offset:24576
  v_mfma_f32_16x16x32_bf16 v[124:127], a[116:119], v[176:179], v[124:127]
  v_mfma_f32_16x16x32_bf16 v[128:131], a[36:39], v[180:183], v[128:131]
  ds_read_b128 v[172:175], v5 offset:26624
  v_mfma_f32_16x16x32_bf16 v[132:135], a[116:119], v[180:183], v[132:135]
  v_mfma_f32_16x16x32_bf16 v[136:139], a[36:39], v[184:187], v[136:139]
  ds_read_b128 v[176:179], v5 offset:28672
  v_mfma_f32_16x16x32_bf16 v[140:143], a[116:119], v[184:187], v[140:143]
  v_mfma_f32_16x16x32_bf16 v[144:147], a[36:39], v[188:191], v[144:147]
  ds_read_b128 v[180:183], v5 offset:30720
  v_mfma_f32_16x16x32_bf16 v[148:151], a[116:119], v[188:191], v[148:151]
  s_waitcnt lgkmcnt(6)
  v_mfma_f32_16x16x32_bf16 v[88:91], a[40:43], v[152:155], v[88:91]
  ds_read_b128 v[184:187], v6 offset:16384
  v_mfma_f32_16x16x32_bf16 v[92:95], a[120:123], v[152:155], v[92:95]
  v_mfma_f32_16x16x32_bf16 v[96:99], a[40:43], v[156:159], v[96:99]
  ds_read_b128 v[188:191], v6 offset:18432
  s_add_u32 m0, s52, 0
  v_mfma_f32_16x16x32_bf16 v[100:103], a[120:123], v[156:159], v[100:103]
  buffer_load_dwordx4 v2, s[8:11], s46 offen sc1 lds
  buffer_load_dwordx4 v2, s[8:11], s46 offen offset:1024 sc1 lds
  s_add_u32 s46, s46, 2048
  s_waitcnt lgkmcnt(6)
  v_mfma_f32_16x16x32_bf16 v[104:107], a[40:43], v[160:163], v[104:107]
  ds_read_b128 v[152:155], v6 offset:20480
  v_mfma_f32_16x16x32_bf16 v[108:111], a[120:123], v[160:163], v[108:111]
  v_mfma_f32_16x16x32_bf16 v[112:115], a[40:43], v[164:167], v[112:115]
  ds_read_b128 v[156:159], v6 offset:22528
  s_add_u32 m0, s100, 10240
  s_add_u32 s60, s94, 10240
  v_mfma_f32_16x16x32_bf16 v[116:119], a[120:123], v[164:167], v[116:119]
  buffer_load_dwordx4 v2, s[4:7], s60 offen lds
  s_waitcnt lgkmcnt(6)
  v_mfma_f32_16x16x32_bf16 v[120:123], a[40:43], v[168:171], v[120:123]
  ds_read_b128 v[160:163], v6 offset:24576
  v_mfma_f32_16x16x32_bf16 v[124:127], a[120:123], v[168:171], v[124:127]
  v_mfma_f32_16x16x32_bf16 v[128:131], a[40:43], v[172:175], v[128:131]
  ds_read_b128 v[164:167], v6 offset:26624
  s_add_u32 m0, s100, 11264
  s_add_u32 s60, s94, 11264
  v_mfma_f32_16x16x32_bf16 v[132:135], a[120:123], v[172:175], v[132:135]
  buffer_load_dwordx4 v2, s[4:7], s60 offen lds
  s_waitcnt lgkmcnt(6)
  v_mfma_f32_16x16x32_bf16 v[136:139], a[40:43], v[176:179], v[136:139]
  ds_read_b128 v[168:171], v6 offset:28672
  v_mfma_f32_16x16x32_bf16 v[140:143], a[120:123], v[176:179], v[140:143]
  v_mfma_f32_16x16x32_bf16 v[144:147], a[40:43], v[180:183], v[144:147]
  ds_read_b128 v[172:175], v6 offset:30720
  v_mfma_f32_16x16x32_bf16 v[148:151], a[120:123], v[180:183], v[148:151]
  s_waitcnt vmcnt(10) lgkmcnt(0)
  s_barrier
  v_mfma_f32_16x16x32_bf16 v[88:91], a[44:47], v[184:187], v[88:91]
  ds_read_b128 v[176:179], v5 offset:32768
  v_mfma_f32_16x16x32_bf16 v[92:95], a[124:127], v[184:187], v[92:95]
  v_mfma_f32_16x16x32_bf16 v[96:99], a[44:47], v[188:191], v[96:99]
  ds_read_b128 v[180:183], v5 offset:34816
  s_add_u32 m0, s52, 2048
  v_mfma_f32_16x16x32_bf16 v[100:103], a[124:127], v[188:191], v[100:103]
  buffer_load_dwordx4 v2, s[8:11], s48 offen sc1 lds
  buffer_load_dwordx4 v2, s[8:11], s48 offen offset:1024 sc1 lds
  s_add_u32 s48, s48, 2048
  v_mfma_f32_16x16x32_bf16 v[104:107], a[44:47], v[152:155], v[104:107]
  ds_read_b128 v[184:187], v5 offset:36864
  v_mfma_f32_16x16x32_bf16 v[108:111], a[124:127], v[152:155], v[108:111]
  v_mfma_f32_16x16x32_bf16 v[112:115], a[44:47], v[156:159], v[112:115]
  ds_read_b128 v[188:191], v5 offset:38912
  v_mfma_f32_16x16x32_bf16 v[116:119], a[124:127], v[156:159], v[116:119]
  v_mfma_f32_16x16x32_bf16 v[120:123], a[44:47], v[160:163], v[120:123]
  ds_read_b128 v[152:155], v5 offset:40960
  v_mfma_f32_16x16x32_bf16 v[124:127], a[124:127], v[160:163], v[124:127]
  v_mfma_f32_16x16x32_bf16 v[128:131], a[44:47], v[164:167], v[128:131]
  ds_read_b128 v[156:159], v5 offset:43008
  v_mfma_f32_16x16x32_bf16 v[132:135], a[124:127], v[164:167], v[132:135]
  v_mfma_f32_16x16x32_bf16 v[136:139], a[44:47], v[168:171], v[136:139]
  ds_read_b128 v[160:163], v5 offset:45056
  v_mfma_f32_16x16x32_bf16 v[140:143], a[124:127], v[168:171], v[140:143]
  v_mfma_f32_16x16x32_bf16 v[144:147], a[44:47], v[172:175], v[144:147]
  ds_read_b128 v[164:167], v5 offset:47104
  v_mfma_f32_16x16x32_bf16 v[148:151], a[124:127], v[172:175], v[148:151]
  s_max_u32 s56, s25, 1
  s_sub_u32 s56, s56, 1
  s_lshl_b32 s56, s56, 8
  s_add_u32 s56, s56, 0x3418020
  v_and_b32 v85, 7, v1
  v_lshlrev_b32 v85, 2, v85
  buffer_load_dword v84, v85, s[4:7], s56 offen sc1
  s_waitcnt lgkmcnt(6)
  v_mfma_f32_16x16x32_bf16 v[88:91], a[48:51], v[176:179], v[88:91]
  ds_read_b128 v[168:171], v6 offset:32768
  v_mfma_f32_16x16x32_bf16 v[92:95], a[128:131], v[176:179], v[92:95]
  v_mfma_f32_16x16x32_bf16 v[96:99], a[48:51], v[180:183], v[96:99]
  ds_read_b128 v[172:175], v6 offset:34816
  s_add_u32 m0, s52, 16384
  v_mfma_f32_16x16x32_bf16 v[100:103], a[128:131], v[180:183], v[100:103]
  buffer_load_dwordx4 v2, s[8:11], s46 offen sc1 lds
  buffer_load_dwordx4 v2, s[8:11], s46 offen offset:1024 sc1 lds
  s_add_u32 s46, s46, 2048
  s_waitcnt lgkmcnt(6)
  v_mfma_f32_16x16x32_bf16 v[104:107], a[48:51], v[184:187], v[104:107]
  ds_read_b128 v[176:179], v6 offset:36864
  v_mfma_f32_16x16x32_bf16 v[108:111], a[128:131], v[184:187], v[108:111]
  v_mfma_f32_16x16x32_bf16 v[112:115], a[48:51], v[188:191], v[112:115]
  ds_read_b128 v[180:183], v6 offset:38912
  s_add_u32 m0, s100, 12288
  s_add_u32 s60, s94, 12288
  v_mfma_f32_16x16x32_bf16 v[116:119], a[128:131], v[188:191], v[116:119]
  buffer_load_dwordx4 v2, s[4:7], s60 offen lds
  s_waitcnt lgkmcnt(6)
  v_mfma_f32_16x16x32_bf16 v[120:123], a[48:51], v[152:155], v[120:123]
  ds_read_b128 v[184:187], v6 offset:40960
  v_mfma_f32_16x16x32_bf16 v[124:127], a[128:131], v[152:155], v[124:127]
  v_mfma_f32_16x16x32_bf16 v[128:131], a[48:51], v[156:159], v[128:131]
  ds_read_b128 v[188:191], v6 offset:43008
  s_add_u32 m0, s100, 13312
  s_add_u32 s60, s94, 13312
  v_mfma_f32_16x16x32_bf16 v[132:135], a[128:131], v[156:159], v[132:135]
  buffer_load_dwordx4 v2, s[4:7], s60 offen lds
  s_waitcnt lgkmcnt(6)
  v_mfma_f32_16x16x32_bf16 v[136:139], a[48:51], v[160:163], v[136:139]
  ds_read_b128 v[152:155], v6 offset:45056
  v_mfma_f32_16x16x32_bf16 v[140:143], a[128:131], v[160:163], v[140:143]
  v_mfma_f32_16x16x32_bf16 v[144:147], a[48:51], v[164:167], v[144:147]
  ds_read_b128 v[156:159], v6 offset:47104
  v_mfma_f32_16x16x32_bf16 v[148:151], a[128:131], v[164:167], v[148:151]
  s_waitcnt vmcnt(11) lgkmcnt(0)
  s_barrier
  v_mfma_f32_16x16x32_bf16 v[88:91], a[52:55], v[168:171], v[88:91]
  ds_read_b128 v[160:163], v5 offset:49152
  v_mfma_f32_16x16x32_bf16 v[92:95], a[132:135], v[168:171], v[92:95]
  v_mfma_f32_16x16x32_bf16 v[96:99], a[52:55], v[172:175], v[96:99]
  ds_read_b128 v[164:167], v5 offset:51200
  s_add_u32 m0, s52, 18432
  v_mfma_f32_16x16x32_bf16 v[100:103], a[132:135], v[172:175], v[100:103]
  buffer_load_dwordx4 v2, s[8:11], s48 offen sc1 lds
  buffer_load_dwordx4 v2, s[8:11], s48 offen offset:1024 sc1 lds
  s_add_u32 s48, s48, 2048
  v_mfma_f32_16x16x32_bf16 v[104:107], a[52:55], v[176:179], v[104:107]
  ds_read_b128 v[168:171], v5 offset:53248
  v_mfma_f32_16x16x32_bf16 v[108:111], a[132:135], v[176:179], v[108:111]
  v_mfma_f32_16x16x32_bf16 v[112:115], a[52:55], v[180:183], v[112:115]
  ds_read_b128 v[172:175], v5 offset:55296
  v_mfma_f32_16x16x32_bf16 v[116:119], a[132:135], v[180:183], v[116:119]
  v_mfma_f32_16x16x32_bf16 v[120:123], a[52:55], v[184:187], v[120:123]
  ds_read_b128 v[176:179], v5 offset:57344
  v_mfma_f32_16x16x32_bf16 v[124:127], a[132:135], v[184:187], v[124:127]
  v_mfma_f32_16x16x32_bf16 v[128:131], a[52:55], v[188:191], v[128:131]
  ds_read_b128 v[180:183], v5 offset:59392
  v_mfma_f32_16x16x32_bf16 v[132:135], a[132:135], v[188:191], v[132:135]
  v_mfma_f32_16x16x32_bf16 v[136:139], a[52:55], v[152:155], v[136:139]
  ds_read_b128 v[184:187], v5 offset:61440
  v_mfma_f32_16x16x32_bf16 v[140:143], a[132:135], v[152:155], v[140:143]
  v_mfma_f32_16x16x32_bf16 v[144:147], a[52:55], v[156:159], v[144:147]
  ds_read_b128 v[188:191], v5 offset:63488
  v_mfma_f32_16x16x32_bf16 v[148:151], a[132:135], v[156:159], v[148:151]
  s_waitcnt lgkmcnt(6)
  v_mfma_f32_16x16x32_bf16 v[88:91], a[56:59], v[160:163], v[88:91]
  ds_read_b128 v[152:155], v6 offset:49152
  v_mfma_f32_16x16x32_bf16 v[92:95], a[136:139], v[160:163], v[92:95]
  v_mfma_f32_16x16x32_bf16 v[96:99], a[56:59], v[164:167], v[96:99]
  ds_read_b128 v[156:159], v6 offset:51200
  s_add_u32 m0, s100, 14336
  s_add_u32 s60, s94, 14336
  v_mfma_f32_16x16x32_bf16 v[100:103], a[136:139], v[164:167], v[100:103]
  buffer_load_dwordx4 v2, s[4:7], s60 offen lds
  s_waitcnt lgkmcnt(6)
  v_mfma_f32_16x16x32_bf16 v[104:107], a[56:59], v[168:171], v[104:107]
  ds_read_b128 v[160:163], v6 offset:53248
  v_mfma_f32_16x16x32_bf16 v[108:111], a[136:139], v[168:171], v[108:111]
  v_mfma_f32_16x16x32_bf16 v[112:115], a[56:59], v[172:175], v[112:115]
  ds_read_b128 v[164:167], v6 offset:55296
  s_add_u32 m0, s100, 15360
  s_add_u32 s60, s94, 15360
  v_mfma_f32_16x16x32_bf16 v[116:119], a[136:139], v[172:175], v[116:119]
  buffer_load_dwordx4 v2, s[4:7], s60 offen lds
  s_waitcnt lgkmcnt(6)
  v_mfma_f32_16x16x32_bf16 v[120:123], a[56:59], v[176:179], v[120:123]
  ds_read_b128 v[168:171], v6 offset:57344
  v_mfma_f32_16x16x32_bf16 v[124:127], a[136:139], v[176:179], v[124:127]
  v_mfma_f32_16x16x32_bf16 v[128:131], a[56:59], v[180:183], v[128:131]
  ds_read_b128 v[172:175], v6 offset:59392
  v_mfma_f32_16x16x32_bf16 v[132:135], a[136:139], v[180:183], v[132:135]
  s_waitcnt lgkmcnt(6)
  v_mfma_f32_16x16x32_bf16 v[136:139], a[56:59], v[184:187], v[136:139]
  ds_read_b128 v[176:179], v6 offset:61440
  v_mfma_f32_16x16x32_bf16 v[140:143], a[136:139], v[184:187], v[140:143]
  v_mfma_f32_16x16x32_bf16 v[144:147], a[56:59], v[188:191], v[144:147]
  ds_read_b128 v[180:183], v6 offset:63488
  v_mfma_f32_16x16x32_bf16 v[148:151], a[136:139], v[188:191], v[148:151]
  s_waitcnt vmcnt(9) lgkmcnt(0)
  s_barrier
  v_mfma_f32_16x16x32_bf16 v[88:91], a[60:63], v[152:155], v[88:91]
  ds_read_b128 v[184:187], v5 offset:0
  v_mfma_f32_16x16x32_bf16 v[92:95], a[140:143], v[152:155], v[92:95]
  v_mfma_f32_16x16x32_bf16 v[96:99], a[60:63], v[156:159], v[96:99]
  ds_read_b128 v[188:191], v5 offset:2048
  v_mfma_f32_16x16x32_bf16 v[100:103], a[140:143], v[156:159], v[100:103]
  v_mfma_f32_16x16x32_bf16 v[104:107], a[60:63], v[160:163], v[104:107]
  ds_read_b128 v[152:155], v5 offset:4096
  v_mfma_f32_16x16x32_bf16 v[108:111], a[140:143], v[160:163], v[108:111]
  v_mfma_f32_16x16x32_bf16 v[112:115], a[60:63], v[164:167], v[112:115]
  ds_read_b128 v[156:159], v5 offset:6144
  v_mfma_f32_16x16x32_bf16 v[116:119], a[140:143], v[164:167], v[116:119]
  v_mfma_f32_16x16x32_bf16 v[120:123], a[60:63], v[168:171], v[120:123]
  ds_read_b128 v[160:163], v5 offset:8192
  v_mfma_f32_16x16x32_bf16 v[124:127], a[140:143], v[168:171], v[124:127]
  v_mfma_f32_16x16x32_bf16 v[128:131], a[60:63], v[172:175], v[128:131]
  ds_read_b128 v[164:167], v5 offset:10240
  v_mfma_f32_16x16x32_bf16 v[132:135], a[140:143], v[172:175], v[132:135]
  v_mfma_f32_16x16x32_bf16 v[136:139], a[60:63], v[176:179], v[136:139]
  ds_read_b128 v[168:171], v5 offset:12288
  v_mfma_f32_16x16x32_bf16 v[140:143], a[140:143], v[176:179], v[140:143]
  v_mfma_f32_16x16x32_bf16 v[144:147], a[60:63], v[180:183], v[144:147]
  ds_read_b128 v[172:175], v5 offset:14336
  v_mfma_f32_16x16x32_bf16 v[148:151], a[140:143], v[180:183], v[148:151]
  s_waitcnt vmcnt(8)
  v_cmp_le_u32 vcc, 1, v84
  s_nop 1
  s_nop 0
  s_and_b32 s56, vcc_lo, 0xff
  s_cmp_eq_u32 s56, 0xff
  s_cbranch_scc1 L_nopoll_12
  s_max_u32 s56, s25, 1
  s_sub_u32 s56, s56, 1
  s_lshl_b32 s56, s56, 8
  s_add_u32 s56, s56, 0x3418020
  s_mov_b32 s88, 1
  v_lshlrev_b32 v79, 2, v1
  v_add_u32 v79, s56, v79
  s_mov_b32 exec_lo, 0xff
  s_mov_b32 exec_hi, 0x0
  s_mov_b32 s95, 0
L_poll_13:
  buffer_load_dword v78, v79, s[4:7], 0 offen sc1
  s_waitcnt vmcnt(0)
  v_cmp_le_u32 vcc, s88, v78
  s_nop 1
  s_nop 0
  s_cmp_eq_u64 vcc, exec
  s_cbranch_scc1 L_pd_14
  s_add_u32 s95, s95, 1
  s_cmp_lt_u32 s95, 0x20000
  s_cbranch_scc1 L_poll_13
L_pd_14:
  s_mov_b64 exec, -1
L_nopoll_12:
  s_mul_i32 s56, s24, 5120
  s_add_u32 m0, s56, 65536
  s_add_u32 s56, s56, s53
  s_add_u32 s57, s56, 4096
  buffer_load_dwordx4 v2, s[4:7], s56 offen offset:0 sc1 lds
  buffer_load_dwordx4 v2, s[4:7], s56 offen offset:1024 sc1 lds
  buffer_load_dwordx4 v2, s[4:7], s56 offen offset:2048 sc1 lds
  buffer_load_dwordx4 v2, s[4:7], s56 offen offset:3072 sc1 lds
  s_add_u32 m0, m0, 4096
  s_nop 0
  buffer_load_dwordx4 v2, s[4:7], s57 offen sc1 lds
  buffer_load_dwordx4 v[80:83], v2, s[4:7], s55 offen sc1
  s_waitcnt lgkmcnt(6)
  v_mfma_f32_16x16x32_bf16 v[88:91], a[64:67], v[184:187], v[88:91]
  ds_read_b128 v[176:179], v6 offset:0
  v_mfma_f32_16x16x32_bf16 v[92:95], a[144:147], v[184:187], v[92:95]
  v_mfma_f32_16x16x32_bf16 v[96:99], a[64:67], v[188:191], v[96:99]
  ds_read_b128 v[180:183], v6 offset:2048
  s_add_u32 m0, s100, 16384
  s_add_u32 s60, s94, 16384
  v_mfma_f32_16x16x32_bf16 v[100:103], a[144:147], v[188:191], v[100:103]
  buffer_load_dwordx4 v2, s[4:7], s60 offen lds
  s_waitcnt lgkmcnt(6)
  v_mfma_f32_16x16x32_bf16 v[104:107], a[64:67], v[152:155], v[104:107]
  ds_read_b128 v[184:187], v6 offset:4096
  v_mfma_f32_16x16x32_bf16 v[108:111], a[144:147], v[152:155], v[108:111]
  v_mfma_f32_16x16x32_bf16 v[112:115], a[64:67], v[156:159], v[112:115]
  ds_read_b128 v[188:191], v6 offset:6144
  s_add_u32 m0, s100, 17408
  s_add_u32 s60, s94, 17408
  v_mfma_f32_16x16x32_bf16 v[116:119], a[144:147], v[156:159], v[116:119]
  buffer_load_dwordx4 v2, s[4:7], s60 offen lds
  s_waitcnt lgkmcnt(6)
  v_mfma_f32_16x16x32_bf16 v[120:123], a[64:67], v[160:163], v[120:123]
  ds_read_b128 v[152:155], v6 offset:8192
  v_mfma_f32_16x16x32_bf16 v[124:127], a[144:147], v[160:163], v[124:127]
  v_mfma_f32_16x16x32_bf16 v[128:131], a[64:67], v[164:167], v[128:131]
  ds_read_b128 v[156:159], v6 offset:10240
  v_mfma_f32_16x16x32_bf16 v[132:135], a[144:147], v[164:167], v[132:135]
  s_waitcnt lgkmcnt(6)
  v_mfma_f32_16x16x32_bf16 v[136:139], a[64:67], v[168:171], v[136:139]
  ds_read_b128 v[160:163], v6 offset:12288
  v_mfma_f32_16x16x32_bf16 v[140:143], a[144:147], v[168:171], v[140:143]
  v_mfma_f32_16x16x32_bf16 v[144:147], a[64:67], v[172:175], v[144:147]
  ds_read_b128 v[164:167], v6 offset:14336
  v_mfma_f32_16x16x32_bf16 v[148:151], a[144:147], v[172:175], v[148:151]
  s_waitcnt vmcnt(10) lgkmcnt(0)
  s_barrier
  v_mfma_f32_16x16x32_bf16 v[88:91], a[68:71], v[176:179], v[88:91]
  ds_read_b128 v[168:171], v5 offset:16384
  v_mfma_f32_16x16x32_bf16 v[92:95], a[148:151], v[176:179], v[92:95]
  v_mfma_f32_16x16x32_bf16 v[96:99], a[68:71], v[180:183], v[96:99]
  ds_read_b128 v[172:175], v5 offset:18432
  v_mfma_f32_16x16x32_bf16 v[100:103], a[148:151], v[180:183], v[100:103]
  v_mfma_f32_16x16x32_bf16 v[104:107], a[68:71], v[184:187], v[104:107]
  ds_read_b128 v[176:179], v5 offset:20480
  v_mfma_f32_16x16x32_bf16 v[108:111], a[148:151], v[184:187], v[108:111]
  v_mfma_f32_16x16x32_bf16 v[112:115], a[68:71], v[188:191], v[112:115]
  ds_read_b128 v[180:183], v5 offset:22528
  v_mfma_f32_16x16x32_bf16 v[116:119], a[148:151], v[188:191], v[116:119]
  v_mfma_f32_16x16x32_bf16 v[120:123], a[68:71], v[152:155], v[120:123]
  ds_read_b128 v[184:187], v5 offset:24576
  v_mfma_f32_16x16x32_bf16 v[124:127], a[148:151], v[152:155], v[124:127]
  v_mfma_f32_16x16x32_bf16 v[128:131], a[68:71], v[156:159], v[128:131]
  ds_read_b128 v[188:191], v5 offset:26624
  v_mfma_f32_16x16x32_bf16 v[132:135], a[148:151], v[156:159], v[132:135]
  v_mfma_f32_16x16x32_bf16 v[136:139], a[68:71], v[160:163], v[136:139]
  ds_read_b128 v[152:155], v5 offset:28672
  v_mfma_f32_16x16x32_bf16 v[140:143], a[148:151], v[160:163], v[140:143]
  v_mfma_f32_16x16x32_bf16 v[144:147], a[68:71], v[164:167], v[144:147]
  ds_read_b128 v[156:159], v5 offset:30720
  v_mfma_f32_16x16x32_bf16 v[148:151], a[148:151], v[164:167], v[148:151]
  s_waitcnt lgkmcnt(6)
  v_mfma_f32_16x16x32_bf16 v[88:91], a[72:75], v[168:171], v[88:91]
  ds_read_b128 v[160:163], v6 offset:16384
  v_mfma_f32_16x16x32_bf16 v[92:95], a[152:155], v[168:171], v[92:95]
  v_mfma_f32_16x16x32_bf16 v[96:99], a[72:75], v[172:175], v[96:99]
  ds_read_b128 v[164:167], v6 offset:18432
  v_mfma_f32_16x16x32_bf16 v[100:103], a[152:155], v[172:175], v[100:103]
  s_waitcnt lgkmcnt(6)
  v_mfma_f32_16x16x32_bf16 v[104:107], a[72:75], v[176:179], v[104:107]
  ds_read_b128 v[168:171], v6 offset:20480
  v_mfma_f32_16x16x32_bf16 v[108:111], a[152:155], v[176:179], v[108:111]
  v_mfma_f32_16x16x32_bf16 v[112:115], a[72:75], v[180:183], v[112:115]
  ds_read_b128 v[172:175], v6 offset:22528
  v_mfma_f32_16x16x32_bf16 v[116:119], a[152:155], v[180:183], v[116:119]
  s_waitcnt lgkmcnt(6)
  v_mfma_f32_16x16x32_bf16 v[120:123], a[72:75], v[184:187], v[120:123]
  ds_read_b128 v[176:179], v6 offset:24576
  v_mfma_f32_16x16x32_bf16 v[124:127], a[152:155], v[184:187], v[124:127]
  v_mfma_f32_16x16x32_bf16 v[128:131], a[72:75], v[188:191], v[128:131]
  ds_read_b128 v[180:183], v6 offset:26624
  v_mfma_f32_16x16x32_bf16 v[132:135], a[152:155], v[188:191], v[132:135]
  s_waitcnt lgkmcnt(6)
  v_mfma_f32_16x16x32_bf16 v[136:139], a[72:75], v[152:155], v[136:139]
  ds_read_b128 v[184:187], v6 offset:28672
  v_mfma_f32_16x16x32_bf16 v[140:143], a[152:155], v[152:155], v[140:143]
  v_mfma_f32_16x16x32_bf16 v[144:147], a[72:75], v[156:159], v[144:147]
  ds_read_b128 v[188:191], v6 offset:30720
  v_mfma_f32_16x16x32_bf16 v[148:151], a[152:155], v[156:159], v[148:151]
  s_waitcnt lgkmcnt(6)
  v_mfma_f32_16x16x32_bf16 v[88:91], a[76:79], v[160:163], v[88:91]
  v_mfma_f32_16x16x32_bf16 v[92:95], a[156:159], v[160:163], v[92:95]
  v_mfma_f32_16x16x32_bf16 v[96:99], a[76:79], v[164:167], v[96:99]
  v_mfma_f32_16x16x32_bf16 v[100:103], a[156:159], v[164:167], v[100:103]
  s_waitcnt lgkmcnt(4)
  v_mfma_f32_16x16x32_bf16 v[104:107], a[76:79], v[168:171], v[104:107]
  v_mfma_f32_16x16x32_bf16 v[108:111], a[156:159], v[168:171], v[108:111]
  v_mfma_f32_16x16x32_bf16 v[112:115], a[76:79], v[172:175], v[112:115]
  v_mfma_f32_16x16x32_bf16 v[116:119], a[156:159], v[172:175], v[116:119]
  s_waitcnt lgkmcnt(2)
  v_mfma_f32_16x16x32_bf16 v[120:123], a[76:79], v[176:179], v[120:123]
  v_mfma_f32_16x16x32_bf16 v[124:127], a[156:159], v[176:179], v[124:127]
  v_mfma_f32_16x16x32_bf16 v[128:131], a[76:79], v[180:183], v[128:131]
  v_mfma_f32_16x16x32_bf16 v[132:135], a[156:159], v[180:183], v[132:135]
  s_waitcnt lgkmcnt(0)
  v_mfma_f32_16x16x32_bf16 v[136:139], a[76:79], v[184:187], v[136:139]
  v_mfma_f32_16x16x32_bf16 v[140:143], a[156:159], v[184:187], v[140:143]
  v_mfma_f32_16x16x32_bf16 v[144:147], a[76:79], v[188:191], v[144:147]
  v_mfma_f32_16x16x32_bf16 v[148:151], a[156:159], v[188:191], v[148:151]
  s_waitcnt vmcnt(0)
  s_cmp_lg_u32 s24, 0
  s_cbranch_scc1 L_hq3_15
  v_add_f32 v80, v80, v82
  v_add_f32 v81, v81, v83
  s_nop 0
  v_add_f32_dpp v80, v80, v80 quad_perm:[1,0,3,2] row_mask:0xf bank_mask:0xf
  v_add_f32_dpp v81, v81, v81 quad_perm:[1,0,3,2] row_mask:0xf bank_mask:0xf
  s_nop 0
  v_add_f32_dpp v80, v80, v80 quad_perm:[2,3,0,1] row_mask:0xf bank_mask:0xf
  v_add_f32_dpp v81, v81, v81 quad_perm:[2,3,0,1] row_mask:0xf bank_mask:0xf
  v_mul_f32 v80, 0x3acccccd, v80
  v_mul_f32 v81, 0x3acccccd, v81
  v_fma_f32 v81, -v80, v80, v81
  v_max_f32 v81, 0, v81
  v_add_f32 v81, 0x3727c5ac, v81
  v_rsq_f32 v81, v81
  v_lshrrev_b32 v84, 2, v1
  v_lshlrev_b32 v84, 3, v84
  s_lshl_b32 s56, s24, 7
  s_add_u32 s56, s56, 162816
  v_add_u32 v82, 162688, v84
  ds_write_b64 v82, v[80:81]
L_hq3_15:
  s_lshl_b32 s56, s25, 3
  s_lshl_b32 s57, s24, 1
  s_add_u32 s56, s56, s57
  s_mul_i32 s56, s56, 20480
  s_mul_i32 s57, s26, 1280
  s_add_u32 s56, s56, s57
  s_add_u32 s56, s56, s84
  s_mov_b32 exec_lo, 0xfffff
  s_mov_b32 exec_hi, 0
  buffer_load_dword v64, v63, s[4:7], s56 offen
  s_cmp_eq_u32 s27, 4
  s_cbranch_scc1 L_ot_16
  v_lshlrev_b32 v65, 7, v1
  s_mul_i32 s56, s90, 20480
  s_and_b32 s57, s26, 7
  s_mul_i32 s57, s57, 2560
  s_add_u32 s56, s56, s57
  s_add_u32 s56, s56, s82
  s_lshl_b32 s57, s90, 10
  s_add_u32 s57, s57, s83
  buffer_load_dword v64, v65, s[12:15], s56 offen
  s_mov_b32 exec_lo, 0xff
  buffer_load_dword v64, v65, s[4:7], s57 offen
L_ot_16:
  s_mov_b64 exec, -1
  s_barrier
  v_add_u32 v78, 65536, v5
  v_add_u32 v79, 65536, v6
  ds_read_b128 v[160:163], v78 offset:0
  ds_read_b128 v[164:167], v79 offset:0
  ds_read_b128 v[168:171], v78 offset:2048
  ds_read_b128 v[172:175], v79 offset:2048
  ds_read_b128 v[176:179], v78 offset:4096
  ds_read_b128 v[180:183], v79 offset:4096
  ds_read_b128 v[184:187], v78 offset:6144
  ds_read_b128 v[188:191], v79 offset:6144
  s_waitcnt lgkmcnt(7)
  v_mfma_f32_16x16x32_bf16 v[152:155], a[0:3], v[160:163], 0
  v_mfma_f32_16x16x32_bf16 v[156:159], a[80:83], v[160:163], 0
  ds_read_b128 v[160:163], v78 offset:8192
  s_waitcnt lgkmcnt(7)
  v_mfma_f32_16x16x32_bf16 v[152:155], a[4:7], v[164:167], v[152:155]
  v_mfma_f32_16x16x32_bf16 v[156:159], a[84:87], v[164:167], v[156:159]
  ds_read_b128 v[164:167], v79 offset:8192
  s_waitcnt lgkmcnt(7)
  v_mfma_f32_16x16x32_bf16 v[152:155], a[8:11], v[168:171], v[152:155]
  v_mfma_f32_16x16x32_bf16 v[156:159], a[88:91], v[168:171], v[156:159]
  ds_read_b128 v[168:171], v78 offset:10240
  s_waitcnt lgkmcnt(7)
  v_mfma_f32_16x16x32_bf16 v[152:155], a[12:15], v[172:175], v[152:155]
  v_mfma_f32_16x16x32_bf16 v[156:159], a[92:95], v[172:175], v[156:159]
  ds_read_b128 v[172:175], v79 offset:10240
  s_waitcnt lgkmcnt(7)
  v_mfma_f32_16x16x32_bf16 v[152:155], a[16:19], v[176:179], v[152:155]
  v_mfma_f32_16x16x32_bf16 v[156:159], a[96:99], v[176:179], v[156:159]
  ds_read_b128 v[176:179], v78 offset:12288
  s_waitcnt lgkmcnt(7)
  v_mfma_f32_16x16x32_bf16 v[152:155], a[20:23], v[180:183], v[152:155]
  v_mfma_f32_16x16x32_bf16 v[156:159], a[100:103], v[180:183], v[156:159]
  ds_read_b128 v[180:183], v79 offset:12288
  s_waitcnt lgkmcnt(7)
  v_mfma_f32_16x16x32_bf16 v[152:155], a[24:27], v[184:187], v[152:155]
  v_mfma_f32_16x16x32_bf16 v[156:159], a[104:107], v[184:187], v[156:159]
  ds_read_b128 v[184:187], v78 offset:14336
  s_waitcnt lgkmcnt(7)
  v_mfma_f32_16x16x32_bf16 v[152:155], a[28:31], v[188:191], v[152:155]
  v_mfma_f32_16x16x32_bf16 v[156:159], a[108:111], v[188:191], v[156:159]
  ds_read_b128 v[188:191], v79 offset:14336
  s_waitcnt lgkmcnt(7)
  v_mfma_f32_16x16x32_bf16 v[152:155], a[32:35], v[160:163], v[152:155]
  v_mfma_f32_16x16x32_bf16 v[156:159], a[112:115], v[160:163], v[156:159]
  ds_read_b128 v[160:163], v78 offset:16384
  s_waitcnt lgkmcnt(7)
  v_mfma_f32_16x16x32_bf16 v[152:155], a[36:39], v[164:167], v[152:155]
  v_mfma_f32_16x16x32_bf16 v[156:159], a[116:119], v[164:167], v[156:159]
  ds_read_b128 v[164:167], v79 offset:16384
  s_waitcnt lgkmcnt(7)
  v_mfma_f32_16x16x32_bf16 v[152:155], a[40:43], v[168:171], v[152:155]
  v_mfma_f32_16x16x32_bf16 v[156:159], a[120:123], v[168:171], v[156:159]
  ds_read_b128 v[168:171], v78 offset:18432
  s_waitcnt lgkmcnt(7)
  v_mfma_f32_16x16x32_bf16 v[152:155], a[44:47], v[172:175], v[152:155]
  v_mfma_f32_16x16x32_bf16 v[156:159], a[124:127], v[172:175], v[156:159]
  ds_read_b128 v[172:175], v79 offset:18432
  s_waitcnt lgkmcnt(7)
  v_mfma_f32_16x16x32_bf16 v[152:155], a[48:51], v[176:179], v[152:155]
  v_mfma_f32_16x16x32_bf16 v[156:159], a[128:131], v[176:179], v[156:159]
  s_waitcnt lgkmcnt(6)
  v_mfma_f32_16x16x32_bf16 v[152:155], a[52:55], v[180:183], v[152:155]
  v_mfma_f32_16x16x32_bf16 v[156:159], a[132:135], v[180:183], v[156:159]
  s_waitcnt lgkmcnt(5)
  v_mfma_f32_16x16x32_bf16 v[152:155], a[56:59], v[184:187], v[152:155]
  v_mfma_f32_16x16x32_bf16 v[156:159], a[136:139], v[184:187], v[156:159]
  s_waitcnt lgkmcnt(4)
  v_mfma_f32_16x16x32_bf16 v[152:155], a[60:63], v[188:191], v[152:155]
  v_mfma_f32_16x16x32_bf16 v[156:159], a[140:143], v[188:191], v[156:159]
  s_waitcnt lgkmcnt(3)
  v_mfma_f32_16x16x32_bf16 v[152:155], a[64:67], v[160:163], v[152:155]
  v_mfma_f32_16x16x32_bf16 v[156:159], a[144:147], v[160:163], v[156:159]
  s_waitcnt lgkmcnt(2)
  v_mfma_f32_16x16x32_bf16 v[152:155], a[68:71], v[164:167], v[152:155]
  v_mfma_f32_16x16x32_bf16 v[156:159], a[148:151], v[164:167], v[156:159]
  s_waitcnt lgkmcnt(1)
  v_mfma_f32_16x16x32_bf16 v[152:155], a[72:75], v[168:171], v[152:155]
  v_mfma_f32_16x16x32_bf16 v[156:159], a[152:155], v[168:171], v[156:159]
  s_waitcnt lgkmcnt(0)
  v_mfma_f32_16x16x32_bf16 v[152:155], a[76:79], v[172:175], v[152:155]
  v_mfma_f32_16x16x32_bf16 v[156:159], a[156:159], v[172:175], v[156:159]
L_a_epi1:
  s_waitcnt lgkmcnt(0)
  s_barrier
  ds_read_b64 v[160:161], v59 offset:0
  ds_read_b64 v[162:163], v59 offset:128
  ds_read_b64 v[164:165], v59 offset:256
  ds_read_b64 v[166:167], v59 offset:384
  ds_read_b64 v[168:169], v59 offset:512
  ds_read_b64 v[170:171], v59 offset:640
  ds_read_b64 v[172:173], v59 offset:768
  ds_read_b64 v[174:175], v59 offset:896
  ds_read_b64 v[176:177], v59 offset:1024
  s_waitcnt lgkmcnt(0)
  v_mul_f32 v180, v161, v10
  v_mul_f32 v182, v161, v11
  v_mul_f32 v184, v163, v10
  v_mul_f32 v186, v163, v11
  v_pk_fma_f32 v[152:153], v[14:15], v[160:161], v[152:153] op_sel:[0,0,0] op_sel_hi:[1,0,1] neg_lo:[0,1,0] neg_hi:[0,1,0]
  v_pk_fma_f32 v[156:157], v[18:19], v[160:161], v[156:157] op_sel:[0,0,0] op_sel_hi:[1,0,1] neg_lo:[0,1,0] neg_hi:[0,1,0]
  v_pk_fma_f32 v[88:89], v[14:15], v[162:163], v[88:89] op_sel:[0,0,0] op_sel_hi:[1,0,1] neg_lo:[0,1,0] neg_hi:[0,1,0]
  v_pk_fma_f32 v[92:93], v[18:19], v[162:163], v[92:93] op_sel:[0,0,0] op_sel_hi:[1,0,1] neg_lo:[0,1,0] neg_hi:[0,1,0]
  v_pk_fma_f32 v[154:155], v[16:17], v[160:161], v[154:155] op_sel:[0,0,0] op_sel_hi:[1,0,1] neg_lo:[0,1,0] neg_hi:[0,1,0]
  v_pk_fma_f32 v[158:159], v[20:21], v[160:161], v[158:159] op_sel:[0,0,0] op_sel_hi:[1,0,1] neg_lo:[0,1,0] neg_hi:[0,1,0]
  v_pk_fma_f32 v[90:91], v[16:17], v[162:163], v[90:91] op_sel:[0,0,0] op_sel_hi:[1,0,1] neg_lo:[0,1,0] neg_hi:[0,1,0]
  v_pk_fma_f32 v[94:95], v[20:21], v[162:163], v[94:95] op_sel:[0,0,0] op_sel_hi:[1,0,1] neg_lo:[0,1,0] neg_hi:[0,1,0]
  v_pk_mul_f32 v[152:153], v[152:153], v[180:181] op_sel:[0,0] op_sel_hi:[1,0]
  v_pk_fma_f32 v[156:157], v[156:157], v[182:183], v[12:13] op_sel:[0,0,0] op_sel_hi:[1,0,1]
  v_pk_mul_f32 v[88:89], v[88:89], v[184:185] op_sel:[0,0] op_sel_hi:[1,0]
  v_pk_fma_f32 v[92:93], v[92:93], v[186:187], v[12:13] op_sel:[0,0,0] op_sel_hi:[1,0,1]
  v_pk_mul_f32 v[154:155], v[154:155], v[180:181] op_sel:[0,0] op_sel_hi:[1,0]
  v_pk_mul_f32 v[158:159], v[158:159], v[182:183] op_sel:[0,0] op_sel_hi:[1,0]
  v_pk_mul_f32 v[90:91], v[90:91], v[184:185] op_sel:[0,0] op_sel_hi:[1,0]
  v_pk_mul_f32 v[94:95], v[94:95], v[186:187] op_sel:[0,0] op_sel_hi:[1,0]
  v_cvt_pk_bf16_f32 v152, v152, v153
  v_cvt_pk_bf16_f32 v156, v156, v157
  v_cvt_pk_bf16_f32 v88, v88, v89
  v_cvt_pk_bf16_f32 v92, v92, v93
  v_cvt_pk_bf16_f32 v153, v154, v155
  v_cvt_pk_bf16_f32 v157, v158, v159
  v_cvt_pk_bf16_f32 v89, v90, v91
  v_cvt_pk_bf16_f32 v93, v94, v95
  v_mul_f32 v180, v165, v10
  v_mul_f32 v182, v165, v11
  v_mul_f32 v184, v167, v10
  v_mul_f32 v186, v167, v11
  v_pk_fma_f32 v[96:97], v[14:15], v[164:165], v[96:97] op_sel:[0,0,0] op_sel_hi:[1,0,1] neg_lo:[0,1,0] neg_hi:[0,1,0]
  v_pk_fma_f32 v[100:101], v[18:19], v[164:165], v[100:101] op_sel:[0,0,0] op_sel_hi:[1,0,1] neg_lo:[0,1,0] neg_hi:[0,1,0]
  v_pk_fma_f32 v[104:105], v[14:15], v[166:167], v[104:105] op_sel:[0,0,0] op_sel_hi:[1,0,1] neg_lo:[0,1,0] neg_hi:[0,1,0]
  v_pk_fma_f32 v[108:109], v[18:19], v[166:167], v[108:109] op_sel:[0,0,0] op_sel_hi:[1,0,1] neg_lo:[0,1,0] neg_hi:[0,1,0]
  v_pk_fma_f32 v[98:99], v[16:17], v[164:165], v[98:99] op_sel:[0,0,0] op_sel_hi:[1,0,1] neg_lo:[0,1,0] neg_hi:[0,1,0]
  v_pk_fma_f32 v[102:103], v[20:21], v[164:165], v[102:103] op_sel:[0,0,0] op_sel_hi:[1,0,1] neg_lo:[0,1,0] neg_hi:[0,1,0]
  v_pk_fma_f32 v[106:107], v[16:17], v[166:167], v[106:107] op_sel:[0,0,0] op_sel_hi:[1,0,1] neg_lo:[0,1,0] neg_hi:[0,1,0]
  v_pk_fma_f32 v[110:111], v[20:21], v[166:167], v[110:111] op_sel:[0,0,0] op_sel_hi:[1,0,1] neg_lo:[0,1,0] neg_hi:[0,1,0]
  v_pk_mul_f32 v[96:97], v[96:97], v[180:181] op_sel:[0,0] op_sel_hi:[1,0]
  v_pk_fma_f32 v[100:101], v[100:101], v[182:183], v[12:13] op_sel:[0,0,0] op_sel_hi:[1,0,1]
  v_pk_mul_f32 v[104:105], v[104:105], v[184:185] op_sel:[0,0] op_sel_hi:[1,0]
  v_pk_fma_f32 v[108:109], v[108:109], v[186:187], v[12:13] op_sel:[0,0,0] op_sel_hi:[1,0,1]
  v_pk_mul_f32 v[98:99], v[98:99], v[180:181] op_sel:[0,0] op_sel_hi:[1,0]
  v_pk_mul_f32 v[102:103], v[102:103], v[182:183] op_sel:[0,0] op_sel_hi:[1,0]
  v_pk_mul_f32 v[106:107], v[106:107], v[184:185] op_sel:[0,0] op_sel_hi:[1,0]
  v_pk_mul_f32 v[110:111], v[110:111], v[186:187] op_sel:[0,0] op_sel_hi:[1,0]
  v_cvt_pk_bf16_f32 v96, v96, v97
  v_cvt_pk_bf16_f32 v100, v100, v101
  v_cvt_pk_bf16_f32 v104, v104, v105
  v_cvt_pk_bf16_f32 v108, v108, v109
  v_cvt_pk_bf16_f32 v97, v98, v99
  v_cvt_pk_bf16_f32 v101, v102, v103
  v_cvt_pk_bf16_f32 v105, v106, v107
  v_cvt_pk_bf16_f32 v109, v110, v111
  v_mul_f32 v180, v169, v10
  v_pk_fma_f32 v[112:113], v[14:15], v[168:169], v[112:113] op_sel:[0,0,0] op_sel_hi:[1,0,1] neg_lo:[0,1,0] neg_hi:[0,1,0]
  v_pk_fma_f32 v[114:115], v[16:17], v[168:169], v[114:115] op_sel:[0,0,0] op_sel_hi:[1,0,1] neg_lo:[0,1,0] neg_hi:[0,1,0]
  v_pk_mul_f32 v[112:113], v[112:113], v[180:181] op_sel:[0,0] op_sel_hi:[1,0]
  v_pk_mul_f32 v[114:115], v[114:115], v[180:181] op_sel:[0,0] op_sel_hi:[1,0]
  v_cvt_pk_bf16_f32 v112, v112, v113
  v_cvt_pk_bf16_f32 v113, v114, v115
  v_mul_f32 v182, v169, v11
  v_mul_f32 v184, v171, v10
  v_mul_f32 v186, v171, v11
  v_mul_f32 v180, v173, v10
  v_pk_fma_f32 v[116:117], v[18:19], v[168:169], v[116:117] op_sel:[0,0,0] op_sel_hi:[1,0,1] neg_lo:[0,1,0] neg_hi:[0,1,0]
  v_pk_fma_f32 v[120:121], v[14:15], v[170:171], v[120:121] op_sel:[0,0,0] op_sel_hi:[1,0,1] neg_lo:[0,1,0] neg_hi:[0,1,0]
  ds_write_b64 v8, v[152:153] offset:0
  v_pk_fma_f32 v[124:125], v[18:19], v[170:171], v[124:125] op_sel:[0,0,0] op_sel_hi:[1,0,1] neg_lo:[0,1,0] neg_hi:[0,1,0]
  v_pk_fma_f32 v[128:129], v[14:15], v[172:173], v[128:129] op_sel:[0,0,0] op_sel_hi:[1,0,1] neg_lo:[0,1,0] neg_hi:[0,1,0]
  v_pk_fma_f32 v[118:119], v[20:21], v[168:169], v[118:119] op_sel:[0,0,0] op_sel_hi:[1,0,1] neg_lo:[0,1,0] neg_hi:[0,1,0]
  v_pk_fma_f32 v[122:123], v[16:17], v[170:171], v[122:123] op_sel:[0,0,0] op_sel_hi:[1,0,1] neg_lo:[0,1,0] neg_hi:[0,1,0]
  v_pk_fma_f32 v[126:127], v[20:21], v[170:171], v[126:127] op_sel:[0,0,0] op_sel_hi:[1,0,1] neg_lo:[0,1,0] neg_hi:[0,1,0]
  v_pk_fma_f32 v[130:131], v[16:17], v[172:173], v[130:131] op_sel:[0,0,0] op_sel_hi:[1,0,1] neg_lo:[0,1,0] neg_hi:[0,1,0]
  ds_write_b64 v9, v[156:157] offset:0
  v_pk_fma_f32 v[116:117], v[116:117], v[182:183], v[12:13] op_sel:[0,0,0] op_sel_hi:[1,0,1]
  v_pk_mul_f32 v[120:121], v[120:121], v[184:185] op_sel:[0,0] op_sel_hi:[1,0]
  v_pk_fma_f32 v[124:125], v[124:125], v[186:187], v[12:13] op_sel:[0,0,0] op_sel_hi:[1,0,1]
  v_pk_mul_f32 v[128:129], v[128:129], v[180:181] op_sel:[0,0] op_sel_hi:[1,0]
  v_pk_mul_f32 v[118:119], v[118:119], v[182:183] op_sel:[0,0] op_sel_hi:[1,0]
  v_pk_mul_f32 v[122:123], v[122:123], v[184:185] op_sel:[0,0] op_sel_hi:[1,0]
  ds_write_b64 v8, v[88:89] offset:768
  v_pk_mul_f32 v[126:127], v[126:127], v[186:187] op_sel:[0,0] op_sel_hi:[1,0]
  v_pk_mul_f32 v[130:131], v[130:131], v[180:181] op_sel:[0,0] op_sel_hi:[1,0]
  v_cvt_pk_bf16_f32 v116, v116, v117
  v_cvt_pk_bf16_f32 v120, v120, v121
  v_cvt_pk_bf16_f32 v124, v124, v125
  v_cvt_pk_bf16_f32 v128, v128, v129
  ds_write_b64 v9, v[92:93] offset:768
  v_cvt_pk_bf16_f32 v117, v118, v119
  v_cvt_pk_bf16_f32 v121, v122, v123
  v_cvt_pk_bf16_f32 v125, v126, v127
  v_cvt_pk_bf16_f32 v129, v130, v131
  v_mul_f32 v182, v173, v11
  v_mul_f32 v184, v175, v10
  ds_write_b64 v8, v[96:97] offset:1536
  v_mul_f32 v186, v175, v11
  v_mul_f32 v180, v177, v10
  v_pk_fma_f32 v[132:133], v[18:19], v[172:173], v[132:133] op_sel:[0,0,0] op_sel_hi:[1,0,1] neg_lo:[0,1,0] neg_hi:[0,1,0]
  v_pk_fma_f32 v[136:137], v[14:15], v[174:175], v[136:137] op_sel:[0,0,0] op_sel_hi:[1,0,1] neg_lo:[0,1,0] neg_hi:[0,1,0]
  v_pk_fma_f32 v[140:141], v[18:19], v[174:175], v[140:141] op_sel:[0,0,0] op_sel_hi:[1,0,1] neg_lo:[0,1,0] neg_hi:[0,1,0]
  v_pk_fma_f32 v[144:145], v[14:15], v[176:177], v[144:145] op_sel:[0,0,0] op_sel_hi:[1,0,1] neg_lo:[0,1,0] neg_hi:[0,1,0]
  ds_write_b64 v9, v[100:101] offset:1536
  v_pk_fma_f32 v[134:135], v[20:21], v[172:173], v[134:135] op_sel:[0,0,0] op_sel_hi:[1,0,1] neg_lo:[0,1,0] neg_hi:[0,1,0]
  v_pk_fma_f32 v[138:139], v[16:17], v[174:175], v[138:139] op_sel:[0,0,0] op_sel_hi:[1,0,1] neg_lo:[0,1,0] neg_hi:[0,1,0]
  v_pk_fma_f32 v[142:143], v[20:21], v[174:175], v[142:143] op_sel:[0,0,0] op_sel_hi:[1,0,1] neg_lo:[0,1,0] neg_hi:[0,1,0]
  v_pk_fma_f32 v[146:147], v[16:17], v[176:177], v[146:147] op_sel:[0,0,0] op_sel_hi:[1,0,1] neg_lo:[0,1,0] neg_hi:[0,1,0]
  v_pk_fma_f32 v[132:133], v[132:133], v[182:183], v[12:13] op_sel:[0,0,0] op_sel_hi:[1,0,1]
  v_pk_mul_f32 v[136:137], v[136:137], v[184:185] op_sel:[0,0] op_sel_hi:[1,0]
  ds_write_b64 v8, v[104:105] offset:2304
  v_pk_fma_f32 v[140:141], v[140:141], v[186:187], v[12:13] op_sel:[0,0,0] op_sel_hi:[1,0,1]
  v_pk_mul_f32 v[144:145], v[144:145], v[180:181] op_sel:[0,0] op_sel_hi:[1,0]
  v_pk_mul_f32 v[134:135], v[134:135], v[182:183] op_sel:[0,0] op_sel_hi:[1,0]
  v_pk_mul_f32 v[138:139], v[138:139], v[184:185] op_sel:[0,0] op_sel_hi:[1,0]
  v_pk_mul_f32 v[142:143], v[142:143], v[186:187] op_sel:[0,0] op_sel_hi:[1,0]
  v_pk_mul_f32 v[146:147], v[146:147], v[180:181] op_sel:[0,0] op_sel_hi:[1,0]
  ds_write_b64 v9, v[108:109] offset:2304
  v_cvt_pk_bf16_f32 v132, v132, v133
  v_cvt_pk_bf16_f32 v136, v136, v137
  v_cvt_pk_bf16_f32 v140, v140, v141
  v_cvt_pk_bf16_f32 v144, v144, v145
  v_cvt_pk_bf16_f32 v133, v134, v135
  v_cvt_pk_bf16_f32 v137, v138, v139
  ds_write_b64 v8, v[112:113] offset:3072
  v_cvt_pk_bf16_f32 v141, v142, v143
  v_cvt_pk_bf16_f32 v145, v146, v147
  v_mul_f32 v182, v177, v11
  v_pk_fma_f32 v[148:149], v[18:19], v[176:177], v[148:149] op_sel:[0,0,0] op_sel_hi:[1,0,1] neg_lo:[0,1,0] neg_hi:[0,1,0]
  v_pk_fma_f32 v[150:151], v[20:21], v[176:177], v[150:151] op_sel:[0,0,0] op_sel_hi:[1,0,1] neg_lo:[0,1,0] neg_hi:[0,1,0]
  v_pk_fma_f32 v[148:149], v[148:149], v[182:183], v[12:13] op_sel:[0,0,0] op_sel_hi:[1,0,1]
  v_pk_mul_f32 v[150:151], v[150:151], v[182:183] op_sel:[0,0] op_sel_hi:[1,0]
  v_cvt_pk_bf16_f32 v148, v148, v149
  v_cvt_pk_bf16_f32 v149, v150, v151
  ds_write_b64 v9, v[116:117] offset:3072
  ds_write_b64 v8, v[120:121] offset:3840
  ds_write_b64 v9, v[124:125] offset:3840
  ds_write_b64 v8, v[128:129] offset:4608
  ds_write_b64 v9, v[132:133] offset:4608
  ds_write_b64 v8, v[136:137] offset:5376
  ds_write_b64 v9, v[140:141] offset:5376
  ds_write_b64 v8, v[144:145] offset:6144
  ds_write_b64 v9, v[148:149] offset:6144
  s_waitcnt lgkmcnt(0)
  s_barrier
  ds_read_b128 v[88:91], v46 offset:0
  ds_read_b128 v[92:95], v47 offset:0
  ds_read_b128 v[96:99], v47 offset:768
  ds_read_b128 v[108:111], v46 offset:6912
  ds_read_b128 v[112:115], v47 offset:18432
  ds_read_b128 v[116:119], v47 offset:19200
  ds_read_b128 v[128:131], v46 offset:768
  ds_read_b128 v[132:135], v47 offset:768
  ds_read_b128 v[136:139], v47 offset:1536
  ds_read_b128 v[148:151], v46 offset:7680
  ds_read_b128 v[152:155], v47 offset:19200
  ds_read_b128 v[156:159], v47 offset:19968
  s_waitcnt lgkmcnt(0)
  v_and_b32 v88, v88, v45
  v_and_b32 v108, v108, v45
  v_and_b32 v128, v128, v45
  v_and_b32 v148, v148, v45
  v_and_b32 v89, v89, v45
  v_and_b32 v109, v109, v45
  v_and_b32 v129, v129, v45
  v_and_b32 v149, v149, v45
  v_and_b32 v90, v90, v44
  v_and_b32 v110, v110, v44
  v_and_b32 v130, v130, v44
  v_and_b32 v150, v150, v44
  v_and_b32 v91, v91, v44
  v_and_b32 v111, v111, v44
  v_and_b32 v131, v131, v44
  v_and_b32 v151, v151, v44
  v_and_b32 v94, v94, v44
  v_and_b32 v114, v114, v44
  v_and_b32 v134, v134, v44
  v_and_b32 v154, v154, v44
  v_and_b32 v95, v95, v44
  v_and_b32 v115, v115, v44
  v_and_b32 v135, v135, v44
  v_and_b32 v155, v155, v44
  v_and_b32 v98, v98, v44
  v_and_b32 v118, v118, v44
  v_and_b32 v138, v138, v44
  v_and_b32 v158, v158, v44
  v_and_b32 v99, v99, v44
  v_and_b32 v119, v119, v44
  v_and_b32 v139, v139, v44
  v_and_b32 v159, v159, v44
  v_mfma_f32_16x16x32_bf16 v[100:103], v[92:95], v[88:91], v[40:43]
  v_mfma_f32_16x16x32_bf16 v[120:123], v[112:115], v[108:111], v[40:43]
  v_mfma_f32_16x16x32_bf16 v[140:143], v[132:135], v[128:131], v[32:35]
  v_mfma_f32_16x16x32_bf16 v[160:163], v[152:155], v[148:151], v[32:35]
  v_mfma_f32_16x16x32_bf16 v[104:107], v[96:99], v[88:91], v[36:39]
  v_mfma_f32_16x16x32_bf16 v[124:127], v[116:119], v[108:111], v[36:39]
  v_mfma_f32_16x16x32_bf16 v[144:147], v[136:139], v[128:131], v[36:39]
  v_mfma_f32_16x16x32_bf16 v[164:167], v[156:159], v[148:151], v[36:39]
  ds_read_b64_tr_b16 v[88:89], v48 offset:0
  ds_read_b64_tr_b16 v[90:91], v48 offset:768
  ds_read_b64_tr_b16 v[92:93], v48 offset:32
  ds_read_b64_tr_b16 v[94:95], v48 offset:800
  ds_read_b64_tr_b16 v[108:109], v48 offset:18432
  ds_read_b64_tr_b16 v[110:111], v48 offset:19200
  ds_read_b64_tr_b16 v[112:113], v48 offset:18464
  ds_read_b64_tr_b16 v[114:115], v48 offset:19232
  ds_read_b64_tr_b16 v[128:129], v48 offset:768
  ds_read_b64_tr_b16 v[130:131], v48 offset:1536
  ds_read_b64_tr_b16 v[132:133], v48 offset:800
  ds_read_b64_tr_b16 v[134:135], v48 offset:1568
  ds_read_b64_tr_b16 v[148:149], v48 offset:19200
  ds_read_b64_tr_b16 v[150:151], v48 offset:19968
  ds_read_b64_tr_b16 v[152:153], v48 offset:19232
  ds_read_b64_tr_b16 v[154:155], v48 offset:20000
  v_max3_f32 v96, v100, v101, v102
  v_max3_f32 v116, v120, v121, v122
  v_max3_f32 v136, v140, v141, v142
  v_max3_f32 v156, v160, v161, v162
  v_max3_f32 v97, v103, v104, v105
  v_max3_f32 v117, v123, v124, v125
  v_max3_f32 v137, v143, v144, v145
  v_max3_f32 v157, v163, v164, v165
  v_max3_f32 v96, v96, v106, v107
  v_max3_f32 v116, v116, v126, v127
  v_max3_f32 v136, v136, v146, v147
  v_max3_f32 v156, v156, v166, v167
  v_max_f32 v96, v96, v97
  v_max_f32 v116, v116, v117
  v_max_f32 v136, v136, v137
  v_max_f32 v156, v156, v157
  v_mov_b32 v97, v96
  v_mov_b32 v117, v116
  v_mov_b32 v137, v136
  v_mov_b32 v157, v156
  v_permlane16_swap_b32 v96, v97
  v_permlane16_swap_b32 v116, v117
  v_permlane16_swap_b32 v136, v137
  v_permlane16_swap_b32 v156, v157
  v_max_f32 v96, v96, v97
  v_max_f32 v116, v116, v117
  v_max_f32 v136, v136, v137
  v_max_f32 v156, v156, v157
  v_mov_b32 v97, v96
  v_mov_b32 v117, v116
  v_mov_b32 v137, v136
  v_mov_b32 v157, v156
  v_permlane32_swap_b32 v96, v97
  v_permlane32_swap_b32 v116, v117
  v_permlane32_swap_b32 v136, v137
  v_permlane32_swap_b32 v156, v157
  v_max_f32 v96, v96, v97
  v_max_f32 v116, v116, v117
  v_max_f32 v136, v136, v137
  v_max_f32 v156, v156, v157
  v_pk_add_f32 v[100:101], v[100:101], v[96:97] op_sel:[0,0] op_sel_hi:[1,0] neg_lo:[0,1] neg_hi:[0,1]
  v_pk_add_f32 v[120:121], v[120:121], v[116:117] op_sel:[0,0] op_sel_hi:[1,0] neg_lo:[0,1] neg_hi:[0,1]
  v_pk_add_f32 v[140:141], v[140:141], v[136:137] op_sel:[0,0] op_sel_hi:[1,0] neg_lo:[0,1] neg_hi:[0,1]
  v_pk_add_f32 v[160:161], v[160:161], v[156:157] op_sel:[0,0] op_sel_hi:[1,0] neg_lo:[0,1] neg_hi:[0,1]
  v_pk_add_f32 v[102:103], v[102:103], v[96:97] op_sel:[0,0] op_sel_hi:[1,0] neg_lo:[0,1] neg_hi:[0,1]
  v_pk_add_f32 v[122:123], v[122:123], v[116:117] op_sel:[0,0] op_sel_hi:[1,0] neg_lo:[0,1] neg_hi:[0,1]
  v_pk_add_f32 v[142:143], v[142:143], v[136:137] op_sel:[0,0] op_sel_hi:[1,0] neg_lo:[0,1] neg_hi:[0,1]
  v_pk_add_f32 v[162:163], v[162:163], v[156:157] op_sel:[0,0] op_sel_hi:[1,0] neg_lo:[0,1] neg_hi:[0,1]
  v_pk_add_f32 v[104:105], v[104:105], v[96:97] op_sel:[0,0] op_sel_hi:[1,0] neg_lo:[0,1] neg_hi:[0,1]
  v_pk_add_f32 v[124:125], v[124:125], v[116:117] op_sel:[0,0] op_sel_hi:[1,0] neg_lo:[0,1] neg_hi:[0,1]
  v_pk_add_f32 v[144:145], v[144:145], v[136:137] op_sel:[0,0] op_sel_hi:[1,0] neg_lo:[0,1] neg_hi:[0,1]
  v_pk_add_f32 v[164:165], v[164:165], v[156:157] op_sel:[0,0] op_sel_hi:[1,0] neg_lo:[0,1] neg_hi:[0,1]
  v_pk_add_f32 v[106:107], v[106:107], v[96:97] op_sel:[0,0] op_sel_hi:[1,0] neg_lo:[0,1] neg_hi:[0,1]
  v_pk_add_f32 v[126:127], v[126:127], v[116:117] op_sel:[0,0] op_sel_hi:[1,0] neg_lo:[0,1] neg_hi:[0,1]
  v_pk_add_f32 v[146:147], v[146:147], v[136:137] op_sel:[0,0] op_sel_hi:[1,0] neg_lo:[0,1] neg_hi:[0,1]
  v_pk_add_f32 v[166:167], v[166:167], v[156:157] op_sel:[0,0] op_sel_hi:[1,0] neg_lo:[0,1] neg_hi:[0,1]
  v_exp_f32 v100, v100
  v_exp_f32 v120, v120
  v_exp_f32 v140, v140
  v_exp_f32 v160, v160
  v_exp_f32 v101, v101
  v_exp_f32 v121, v121
  v_exp_f32 v141, v141
  v_exp_f32 v161, v161
  v_exp_f32 v102, v102
  v_exp_f32 v122, v122
  v_exp_f32 v142, v142
  v_exp_f32 v162, v162
  v_exp_f32 v103, v103
  v_exp_f32 v123, v123
  v_exp_f32 v143, v143
  v_exp_f32 v163, v163
  v_exp_f32 v104, v104
  v_exp_f32 v124, v124
  v_exp_f32 v144, v144
  v_exp_f32 v164, v164
  v_exp_f32 v105, v105
  v_exp_f32 v125, v125
  v_exp_f32 v145, v145
  v_exp_f32 v165, v165
  v_exp_f32 v106, v106
  v_exp_f32 v126, v126
  v_exp_f32 v146, v146
  v_exp_f32 v166, v166
  v_exp_f32 v107, v107
  v_exp_f32 v127, v127
  v_exp_f32 v147, v147
  v_exp_f32 v167, v167
  v_cvt_pk_bf16_f32 v100, v100, v101
  v_cvt_pk_bf16_f32 v120, v120, v121
  v_cvt_pk_bf16_f32 v140, v140, v141
  v_cvt_pk_bf16_f32 v160, v160, v161
  v_cvt_pk_bf16_f32 v101, v102, v103
  v_cvt_pk_bf16_f32 v121, v122, v123
  v_cvt_pk_bf16_f32 v141, v142, v143
  v_cvt_pk_bf16_f32 v161, v162, v163
  v_cvt_pk_bf16_f32 v102, v104, v105
  v_cvt_pk_bf16_f32 v122, v124, v125
  v_cvt_pk_bf16_f32 v142, v144, v145
  v_cvt_pk_bf16_f32 v162, v164, v165
  v_cvt_pk_bf16_f32 v103, v106, v107
  v_cvt_pk_bf16_f32 v123, v126, v127
  v_cvt_pk_bf16_f32 v143, v146, v147
  v_cvt_pk_bf16_f32 v163, v166, v167
  s_waitcnt lgkmcnt(0)
  v_mfma_f32_16x16x32_bf16 v[104:107], v[88:91], v[100:103], 0
  v_mfma_f32_16x16x32_bf16 v[96:99], v[92:95], v[100:103], 0
  v_mfma_f32_16x16x32_bf16 v[124:127], v[108:111], v[120:123], 0
  v_mfma_f32_16x16x32_bf16 v[116:119], v[112:115], v[120:123], 0
  v_mfma_f32_16x16x32_bf16 v[144:147], v[128:131], v[140:143], 0
  v_mfma_f32_16x16x32_bf16 v[136:139], v[132:135], v[140:143], 0
  v_mfma_f32_16x16x32_bf16 v[164:167], v[148:151], v[160:163], 0
  v_mfma_f32_16x16x32_bf16 v[156:159], v[152:155], v[160:163], 0
  s_nop 1
  v_mov_b32 v88, v96
  s_nop 0
  v_mov_b32 v108, v116
  s_nop 0
  v_mov_b32 v128, v136
  s_nop 0
  v_mov_b32 v148, v156
  v_mov_b32 v89, v96
  v_mov_b32 v109, v116
  v_mov_b32 v129, v136
  v_mov_b32 v149, v156
  v_permlane16_swap_b32 v88, v89
  v_permlane16_swap_b32 v108, v109
  v_permlane16_swap_b32 v128, v129
  v_permlane16_swap_b32 v148, v149
  v_mov_b32 v88, v89
  v_mov_b32 v108, v109
  v_mov_b32 v128, v129
  v_mov_b32 v148, v149
  v_permlane32_swap_b32 v88, v89
  v_permlane32_swap_b32 v108, v109
  v_permlane32_swap_b32 v128, v129
  v_permlane32_swap_b32 v148, v149
  v_rcp_f32 v88, v88
  v_rcp_f32 v108, v108
  v_rcp_f32 v128, v128
  v_rcp_f32 v148, v148
  v_pk_mul_f32 v[104:105], v[104:105], v[88:89] op_sel:[0,0] op_sel_hi:[1,0]
  v_pk_mul_f32 v[124:125], v[124:125], v[108:109] op_sel:[0,0] op_sel_hi:[1,0]
  v_pk_mul_f32 v[144:145], v[144:145], v[128:129] op_sel:[0,0] op_sel_hi:[1,0]
  v_pk_mul_f32 v[164:165], v[164:165], v[148:149] op_sel:[0,0] op_sel_hi:[1,0]
  v_pk_mul_f32 v[106:107], v[106:107], v[88:89] op_sel:[0,0] op_sel_hi:[1,0]
  v_pk_mul_f32 v[126:127], v[126:127], v[108:109] op_sel:[0,0] op_sel_hi:[1,0]
  v_pk_mul_f32 v[146:147], v[146:147], v[128:129] op_sel:[0,0] op_sel_hi:[1,0]
  v_pk_mul_f32 v[166:167], v[166:167], v[148:149] op_sel:[0,0] op_sel_hi:[1,0]
  v_pk_mul_f32 v[96:97], v[96:97], v[88:89] op_sel:[0,0] op_sel_hi:[1,0]
  v_pk_mul_f32 v[116:117], v[116:117], v[108:109] op_sel:[0,0] op_sel_hi:[1,0]
  v_pk_mul_f32 v[136:137], v[136:137], v[128:129] op_sel:[0,0] op_sel_hi:[1,0]
  v_pk_mul_f32 v[156:157], v[156:157], v[148:149] op_sel:[0,0] op_sel_hi:[1,0]
  v_pk_mul_f32 v[98:99], v[98:99], v[88:89] op_sel:[0,0] op_sel_hi:[1,0]
  v_pk_mul_f32 v[118:119], v[118:119], v[108:109] op_sel:[0,0] op_sel_hi:[1,0]
  v_pk_mul_f32 v[138:139], v[138:139], v[128:129] op_sel:[0,0] op_sel_hi:[1,0]
  v_pk_mul_f32 v[158:159], v[158:159], v[148:149] op_sel:[0,0] op_sel_hi:[1,0]
  v_cvt_pk_bf16_f32 v92, v104, v105
  v_cvt_pk_bf16_f32 v112, v124, v125
  v_cvt_pk_bf16_f32 v132, v144, v145
  v_cvt_pk_bf16_f32 v152, v164, v165
  v_cvt_pk_bf16_f32 v93, v106, v107
  v_cvt_pk_bf16_f32 v113, v126, v127
  v_cvt_pk_bf16_f32 v133, v146, v147
  v_cvt_pk_bf16_f32 v153, v166, v167
  v_cvt_pk_bf16_f32 v94, v96, v97
  v_cvt_pk_bf16_f32 v114, v116, v117
  v_cvt_pk_bf16_f32 v134, v136, v137
  v_cvt_pk_bf16_f32 v154, v156, v157
  v_cvt_pk_bf16_f32 v95, v98, v99
  v_cvt_pk_bf16_f32 v115, v118, v119
  v_cvt_pk_bf16_f32 v135, v138, v139
  v_cvt_pk_bf16_f32 v155, v158, v159
  ds_write_b64 v60, v[92:93] offset:0
  ds_write_b64 v60, v[112:113] offset:6912
  ds_write_b64 v60, v[132:133] offset:768
  ds_write_b64 v60, v[152:153] offset:7680
  s_mov_b64 exec, 0xffff
  ds_write_b64 v60, v[94:95] offset:32
  ds_write_b64 v60, v[114:115] offset:6944
  ds_write_b64 v60, v[134:135] offset:800
  ds_write_b64 v60, v[154:155] offset:7712
  s_mov_b64 exec, -1
  s_barrier
  s_branch L_join
L_l2:
  s_lshl_b32 s56, s24, 10
  s_add_u32 s56, s56, 0
  s_add_u32 s56, s56, s54
  buffer_load_dwordx4 v[88:91], v2, s[4:7], s56 offen sc1
  s_lshl_b32 s56, s24, 10
  s_add_u32 s56, s56, 4096
  s_add_u32 s56, s56, s54
  buffer_load_dwordx4 v[92:95], v2, s[4:7], s56 offen sc1
  s_add_u32 m0, s52, 0
  s_nop 0
  buffer_load_dwordx4 v2, s[8:11], s46 offen sc1 lds
  buffer_load_dwordx4 v2, s[8:11], s46 offen offset:1024 sc1 lds
  s_add_u32 s46, s46, 2048
  s_add_u32 m0, s52, 2048
  s_nop 0
  buffer_load_dwordx4 v2, s[8:11], s48 offen sc1 lds
  buffer_load_dwordx4 v2, s[8:11], s48 offen offset:1024 sc1 lds
  s_add_u32 s48, s48, 2048
  s_add_u32 m0, s52, 16384
  s_nop 0
  buffer_load_dwordx4 v2, s[8:11], s46 offen sc1 lds
  buffer_load_dwordx4 v2, s[8:11], s46 offen offset:1024 sc1 lds
  s_add_u32 s46, s46, 2048
  s_add_u32 m0, s52, 18432
  s_nop 0
  buffer_load_dwordx4 v2, s[8:11], s48 offen sc1 lds
  buffer_load_dwordx4 v2, s[8:11], s48 offen offset:1024 sc1 lds
  s_add_u32 s48, s48, 2048
  buffer_load_dwordx4 a[176:179], v2, s[4:7], s85 offen
  buffer_load_dwordx4 a[180:183], v2, s[4:7], s85 offen offset:1024
  s_add_u32 s85, s85, 2048
  s_add_u32 m0, s52, 32768
  s_nop 0
  buffer_load_dwordx4 v2, s[8:11], s46 offen sc1 lds
  buffer_load_dwordx4 v2, s[8:11], s46 offen offset:1024 sc1 lds
  s_add_u32 s46, s46, 2048
  buffer_load_dwordx4 v[192:195], v2, s[4:7], s91 offen
  buffer_load_dwordx4 v[196:199], v2, s[4:7], s91 offen offset:1024
  s_add_u32 s91, s91, 2048
  s_add_u32 m0, s52, 34816
  s_nop 0
  buffer_load_dwordx4 v2, s[8:11], s48 offen sc1 lds
  buffer_load_dwordx4 v2, s[8:11], s48 offen offset:1024 sc1 lds
  s_add_u32 s48, s48, 2048
  s_waitcnt vmcnt(16)
  v_add_f32 v88, v88, v90
  v_add_f32 v92, v92, v94
  v_add_f32 v89, v89, v91
  v_add_f32 v93, v93, v95
  v_add_f32_dpp v88, v88, v88 quad_perm:[1,0,3,2] row_mask:0xf bank_mask:0xf
  v_add_f32_dpp v92, v92, v92 quad_perm:[1,0,3,2] row_mask:0xf bank_mask:0xf
  v_add_f32_dpp v89, v89, v89 quad_perm:[1,0,3,2] row_mask:0xf bank_mask:0xf
  v_add_f32_dpp v93, v93, v93 quad_perm:[1,0,3,2] row_mask:0xf bank_mask:0xf
  v_add_f32_dpp v88, v88, v88 quad_perm:[2,3,0,1] row_mask:0xf bank_mask:0xf
  v_add_f32_dpp v92, v92, v92 quad_perm:[2,3,0,1] row_mask:0xf bank_mask:0xf
  v_add_f32_dpp v89, v89, v89 quad_perm:[2,3,0,1] row_mask:0xf bank_mask:0xf
  v_add_f32_dpp v93, v93, v93 quad_perm:[2,3,0,1] row_mask:0xf bank_mask:0xf
  v_mul_f32 v88, 0x3acccccd, v88
  v_mul_f32 v92, 0x3acccccd, v92
  v_mul_f32 v89, 0x3acccccd, v89
  v_mul_f32 v93, 0x3acccccd, v93
  v_fma_f32 v89, -v88, v88, v89
  v_fma_f32 v93, -v92, v92, v93
  v_max_f32 v89, 0, v89
  v_max_f32 v93, 0, v93
  v_add_f32 v89, 0x3727c5ac, v89
  v_add_f32 v93, 0x3727c5ac, v93
  v_rsq_f32 v89, v89
  v_rsq_f32 v93, v93
  v_lshrrev_b32 v100, 2, v1
  v_lshlrev_b32 v100, 3, v100
  s_lshl_b32 s56, s24, 7
  s_add_u32 s56, s56, 162816
  v_add_u32 v90, s56, v100
  ds_write_b64 v90, v[88:89] offset:0
  v_add_u32 v94, s56, v100
  ds_write_b64 v94, v[92:93] offset:512
  v_mov_b32 v82, 0x3f803f80
  v_mov_b32 v83, 0x3f803f80
  v_mov_b32 v84, 0x3f803f80
  v_mov_b32 v85, 0x3f803f80
  s_waitcnt vmcnt(12)
  s_barrier
  ds_read_b128 v[152:155], v5 offset:0
  ds_read_b128 v[156:159], v5 offset:2048
  ds_read_b128 v[160:163], v5 offset:4096
  ds_read_b128 v[164:167], v5 offset:6144
  ds_read_b128 v[168:171], v5 offset:8192
  ds_read_b128 v[172:175], v5 offset:10240
  ds_read_b128 v[176:179], v5 offset:12288
  ds_read_b128 v[180:183], v5 offset:14336
  s_waitcnt lgkmcnt(6)
  v_mfma_f32_16x16x32_bf16 v[88:91], a[160:163], v[152:155], 0
  ds_read_b128 v[184:187], v6 offset:0
  v_mfma_f32_16x16x32_bf16 v[92:95], a[240:243], v[152:155], 0
  v_mfma_f32_16x16x32_bf16 v[96:99], a[160:163], v[156:159], 0
  ds_read_b128 v[188:191], v6 offset:2048
  v_mfma_f32_16x16x32_bf16 v[100:103], a[240:243], v[156:159], 0
  buffer_load_dwordx4 a[184:187], v2, s[4:7], s85 offen
  buffer_load_dwordx4 a[188:191], v2, s[4:7], s85 offen offset:1024
  s_add_u32 s85, s85, 2048
  s_waitcnt lgkmcnt(6)
  v_mfma_f32_16x16x32_bf16 v[104:107], a[160:163], v[160:163], 0
  ds_read_b128 v[152:155], v6 offset:4096
  v_mfma_f32_16x16x32_bf16 v[108:111], a[240:243], v[160:163], 0
  v_mfma_f32_16x16x32_bf16 v[112:115], a[160:163], v[164:167], 0
  ds_read_b128 v[156:159], v6 offset:6144
  s_add_u32 m0, s52, 49152
  v_mfma_f32_16x16x32_bf16 v[116:119], a[240:243], v[164:167], 0
  buffer_load_dwordx4 v2, s[8:11], s46 offen sc1 lds
  buffer_load_dwordx4 v2, s[8:11], s46 offen offset:1024 sc1 lds
  s_add_u32 s46, s46, 2048
  s_waitcnt lgkmcnt(6)
  v_mfma_f32_16x16x32_bf16 v[120:123], a[160:163], v[168:171], 0
  ds_read_b128 v[160:163], v6 offset:8192
  v_mfma_f32_16x16x32_bf16 v[124:127], a[240:243], v[168:171], 0
  v_mfma_f32_16x16x32_bf16 v[128:131], a[160:163], v[172:175], 0
  ds_read_b128 v[164:167], v6 offset:10240
  v_mfma_f32_16x16x32_bf16 v[132:135], a[240:243], v[172:175], 0
  s_waitcnt lgkmcnt(6)
  v_mfma_f32_16x16x32_bf16 v[136:139], a[160:163], v[176:179], 0
  ds_read_b128 v[168:171], v6 offset:12288
  v_mfma_f32_16x16x32_bf16 v[140:143], a[240:243], v[176:179], 0
  v_mfma_f32_16x16x32_bf16 v[144:147], a[160:163], v[180:183], 0
  ds_read_b128 v[172:175], v6 offset:14336
  v_mfma_f32_16x16x32_bf16 v[148:151], a[240:243], v[180:183], 0
  v_mfma_f32_16x16x32_bf16 v[70:73], a[160:163], v[82:85], 0
  v_mfma_f32_16x16x32_bf16 v[74:77], a[240:243], v[82:85], 0
  s_waitcnt vmcnt(12) lgkmcnt(0)
  s_barrier
  v_mfma_f32_16x16x32_bf16 v[88:91], a[164:167], v[184:187], v[88:91]
  ds_read_b128 v[176:179], v5 offset:16384
  v_mfma_f32_16x16x32_bf16 v[92:95], a[244:247], v[184:187], v[92:95]
  v_mfma_f32_16x16x32_bf16 v[96:99], a[164:167], v[188:191], v[96:99]
  ds_read_b128 v[180:183], v5 offset:18432
  v_mfma_f32_16x16x32_bf16 v[100:103], a[244:247], v[188:191], v[100:103]
  buffer_load_dwordx4 v[200:203], v2, s[4:7], s91 offen
  buffer_load_dwordx4 v[204:207], v2, s[4:7], s91 offen offset:1024
  s_add_u32 s91, s91, 2048
  v_mfma_f32_16x16x32_bf16 v[104:107], a[164:167], v[152:155], v[104:107]
  ds_read_b128 v[184:187], v5 offset:20480
  v_mfma_f32_16x16x32_bf16 v[108:111], a[244:247], v[152:155], v[108:111]
  v_mfma_f32_16x16x32_bf16 v[112:115], a[164:167], v[156:159], v[112:115]
  ds_read_b128 v[188:191], v5 offset:22528
  s_add_u32 m0, s52, 51200
  v_mfma_f32_16x16x32_bf16 v[116:119], a[244:247], v[156:159], v[116:119]
  buffer_load_dwordx4 v2, s[8:11], s48 offen sc1 lds
  buffer_load_dwordx4 v2, s[8:11], s48 offen offset:1024 sc1 lds
  s_add_u32 s48, s48, 2048
  v_mfma_f32_16x16x32_bf16 v[120:123], a[164:167], v[160:163], v[120:123]
  ds_read_b128 v[152:155], v5 offset:24576
  v_mfma_f32_16x16x32_bf16 v[124:127], a[244:247], v[160:163], v[124:127]
  v_mfma_f32_16x16x32_bf16 v[128:131], a[164:167], v[164:167], v[128:131]
  ds_read_b128 v[156:159], v5 offset:26624
  v_mfma_f32_16x16x32_bf16 v[132:135], a[244:247], v[164:167], v[132:135]
  v_mfma_f32_16x16x32_bf16 v[136:139], a[164:167], v[168:171], v[136:139]
  ds_read_b128 v[160:163], v5 offset:28672
  v_mfma_f32_16x16x32_bf16 v[140:143], a[244:247], v[168:171], v[140:143]
  v_mfma_f32_16x16x32_bf16 v[144:147], a[164:167], v[172:175], v[144:147]
  ds_read_b128 v[164:167], v5 offset:30720
  v_mfma_f32_16x16x32_bf16 v[148:151], a[244:247], v[172:175], v[148:151]
  v_mfma_f32_16x16x32_bf16 v[70:73], a[164:167], v[82:85], v[70:73]
  v_mfma_f32_16x16x32_bf16 v[74:77], a[244:247], v[82:85], v[74:77]
  s_waitcnt lgkmcnt(6)
  v_mfma_f32_16x16x32_bf16 v[88:91], a[168:171], v[176:179], v[88:91]
  ds_read_b128 v[168:171], v6 offset:16384
  v_mfma_f32_16x16x32_bf16 v[92:95], a[248:251], v[176:179], v[92:95]
  v_mfma_f32_16x16x32_bf16 v[96:99], a[168:171], v[180:183], v[96:99]
  ds_read_b128 v[172:175], v6 offset:18432
  v_mfma_f32_16x16x32_bf16 v[100:103], a[248:251], v[180:183], v[100:103]
  buffer_load_dwordx4 a[192:195], v2, s[4:7], s85 offen
  buffer_load_dwordx4 a[196:199], v2, s[4:7], s85 offen offset:1024
  s_add_u32 s85, s85, 2048
  s_waitcnt lgkmcnt(6)
  v_mfma_f32_16x16x32_bf16 v[104:107], a[168:171], v[184:187], v[104:107]
  ds_read_b128 v[176:179], v6 offset:20480
  v_mfma_f32_16x16x32_bf16 v[108:111], a[248:251], v[184:187], v[108:111]
  v_mfma_f32_16x16x32_bf16 v[112:115], a[168:171], v[188:191], v[112:115]
  ds_read_b128 v[180:183], v6 offset:22528
  s_add_u32 m0, s52, 0
  v_mfma_f32_16x16x32_bf16 v[116:119], a[248:251], v[188:191], v[116:119]
  buffer_load_dwordx4 v2, s[8:11], s46 offen sc1 lds
  buffer_load_dwordx4 v2, s[8:11], s46 offen offset:1024 sc1 lds
  s_add_u32 s46, s46, 2048
  s_waitcnt lgkmcnt(6)
  v_mfma_f32_16x16x32_bf16 v[120:123], a[168:171], v[152:155], v[120:123]
  ds_read_b128 v[184:187], v6 offset:24576
  v_mfma_f32_16x16x32_bf16 v[124:127], a[248:251], v[152:155], v[124:127]
  v_mfma_f32_16x16x32_bf16 v[128:131], a[168:171], v[156:159], v[128:131]
  ds_read_b128 v[188:191], v6 offset:26624
  v_mfma_f32_16x16x32_bf16 v[132:135], a[248:251], v[156:159], v[132:135]
  s_waitcnt lgkmcnt(6)
  v_mfma_f32_16x16x32_bf16 v[136:139], a[168:171], v[160:163], v[136:139]
  ds_read_b128 v[152:155], v6 offset:28672
  v_mfma_f32_16x16x32_bf16 v[140:143], a[248:251], v[160:163], v[140:143]
  v_mfma_f32_16x16x32_bf16 v[144:147], a[168:171], v[164:167], v[144:147]
  ds_read_b128 v[156:159], v6 offset:30720
  v_mfma_f32_16x16x32_bf16 v[148:151], a[248:251], v[164:167], v[148:151]
  v_mfma_f32_16x16x32_bf16 v[70:73], a[168:171], v[82:85], v[70:73]
  v_mfma_f32_16x16x32_bf16 v[74:77], a[248:251], v[82:85], v[74:77]
  s_waitcnt vmcnt(12) lgkmcnt(0)
  s_barrier
  v_mfma_f32_16x16x32_bf16 v[88:91], a[172:175], v[168:171], v[88:91]
  ds_read_b128 v[160:163], v5 offset:32768
  v_mfma_f32_16x16x32_bf16 v[92:95], a[252:255], v[168:171], v[92:95]
  v_mfma_f32_16x16x32_bf16 v[96:99], a[172:175], v[172:175], v[96:99]
  ds_read_b128 v[164:167], v5 offset:34816
  v_mfma_f32_16x16x32_bf16 v[100:103], a[252:255], v[172:175], v[100:103]
  buffer_load_dwordx4 v[208:211], v2, s[4:7], s91 offen
  buffer_load_dwordx4 v[212:215], v2, s[4:7], s91 offen offset:1024
  s_add_u32 s91, s91, 2048
  v_mfma_f32_16x16x32_bf16 v[104:107], a[172:175], v[176:179], v[104:107]
  ds_read_b128 v[168:171], v5 offset:36864
  v_mfma_f32_16x16x32_bf16 v[108:111], a[252:255], v[176:179], v[108:111]
  v_mfma_f32_16x16x32_bf16 v[112:115], a[172:175], v[180:183], v[112:115]
  ds_read_b128 v[172:175], v5 offset:38912
  s_add_u32 m0, s52, 2048
  v_mfma_f32_16x16x32_bf16 v[116:119], a[252:255], v[180:183], v[116:119]
  buffer_load_dwordx4 v2, s[8:11], s48 offen sc1 lds
  buffer_load_dwordx4 v2, s[8:11], s48 offen offset:1024 sc1 lds
  s_add_u32 s48, s48, 2048
  v_mfma_f32_16x16x32_bf16 v[120:123], a[172:175], v[184:187], v[120:123]
  ds_read_b128 v[176:179], v5 offset:40960
  v_mfma_f32_16x16x32_bf16 v[124:127], a[252:255], v[184:187], v[124:127]
  v_mfma_f32_16x16x32_bf16 v[128:131], a[172:175], v[188:191], v[128:131]
  ds_read_b128 v[180:183], v5 offset:43008
  v_mfma_f32_16x16x32_bf16 v[132:135], a[252:255], v[188:191], v[132:135]
  v_mfma_f32_16x16x32_bf16 v[136:139], a[172:175], v[152:155], v[136:139]
  ds_read_b128 v[184:187], v5 offset:45056
  v_mfma_f32_16x16x32_bf16 v[140:143], a[252:255], v[152:155], v[140:143]
  v_mfma_f32_16x16x32_bf16 v[144:147], a[172:175], v[156:159], v[144:147]
  ds_read_b128 v[188:191], v5 offset:47104
  v_mfma_f32_16x16x32_bf16 v[148:151], a[252:255], v[156:159], v[148:151]
  v_mfma_f32_16x16x32_bf16 v[70:73], a[172:175], v[82:85], v[70:73]
  v_mfma_f32_16x16x32_bf16 v[74:77], a[252:255], v[82:85], v[74:77]
  s_waitcnt lgkmcnt(6)
  v_mfma_f32_16x16x32_bf16 v[88:91], a[176:179], v[160:163], v[88:91]
  ds_read_b128 v[152:155], v6 offset:32768
  v_mfma_f32_16x16x32_bf16 v[92:95], v[192:195], v[160:163], v[92:95]
  v_mfma_f32_16x16x32_bf16 v[96:99], a[176:179], v[164:167], v[96:99]
  ds_read_b128 v[156:159], v6 offset:34816
  v_mfma_f32_16x16x32_bf16 v[100:103], v[192:195], v[164:167], v[100:103]
  buffer_load_dwordx4 a[200:203], v2, s[4:7], s85 offen
  buffer_load_dwordx4 a[204:207], v2, s[4:7], s85 offen offset:1024
  s_add_u32 s85, s85, 2048
  s_waitcnt lgkmcnt(6)
  v_mfma_f32_16x16x32_bf16 v[104:107], a[176:179], v[168:171], v[104:107]
  ds_read_b128 v[160:163], v6 offset:36864
  v_mfma_f32_16x16x32_bf16 v[108:111], v[192:195], v[168:171], v[108:111]
  v_mfma_f32_16x16x32_bf16 v[112:115], a[176:179], v[172:175], v[112:115]
  ds_read_b128 v[164:167], v6 offset:38912
  s_add_u32 m0, s52, 16384
  v_mfma_f32_16x16x32_bf16 v[116:119], v[192:195], v[172:175], v[116:119]
  buffer_load_dwordx4 v2, s[8:11], s46 offen sc1 lds
  buffer_load_dwordx4 v2, s[8:11], s46 offen offset:1024 sc1 lds
  s_add_u32 s46, s46, 2048
  s_waitcnt lgkmcnt(6)
  v_mfma_f32_16x16x32_bf16 v[120:123], a[176:179], v[176:179], v[120:123]
  ds_read_b128 v[168:171], v6 offset:40960
  v_mfma_f32_16x16x32_bf16 v[124:127], v[192:195], v[176:179], v[124:127]
  v_mfma_f32_16x16x32_bf16 v[128:131], a[176:179], v[180:183], v[128:131]
  ds_read_b128 v[172:175], v6 offset:43008
  v_mfma_f32_16x16x32_bf16 v[132:135], v[192:195], v[180:183], v[132:135]
  s_waitcnt lgkmcnt(6)
  v_mfma_f32_16x16x32_bf16 v[136:139], a[176:179], v[184:187], v[136:139]
  ds_read_b128 v[176:179], v6 offset:45056
  v_mfma_f32_16x16x32_bf16 v[140:143], v[192:195], v[184:187], v[140:143]
  v_mfma_f32_16x16x32_bf16 v[144:147], a[176:179], v[188:191], v[144:147]
  ds_read_b128 v[180:183], v6 offset:47104
  v_mfma_f32_16x16x32_bf16 v[148:151], v[192:195], v[188:191], v[148:151]
  v_mfma_f32_16x16x32_bf16 v[70:73], a[176:179], v[82:85], v[70:73]
  v_mfma_f32_16x16x32_bf16 v[74:77], v[192:195], v[82:85], v[74:77]
  s_waitcnt vmcnt(12) lgkmcnt(0)
  s_barrier
  v_mfma_f32_16x16x32_bf16 v[88:91], a[180:183], v[152:155], v[88:91]
  ds_read_b128 v[184:187], v5 offset:49152
  v_mfma_f32_16x16x32_bf16 v[92:95], v[196:199], v[152:155], v[92:95]
  v_mfma_f32_16x16x32_bf16 v[96:99], a[180:183], v[156:159], v[96:99]
  ds_read_b128 v[188:191], v5 offset:51200
  v_mfma_f32_16x16x32_bf16 v[100:103], v[196:199], v[156:159], v[100:103]
  buffer_load_dwordx4 v[216:219], v2, s[4:7], s91 offen
  buffer_load_dwordx4 v[220:223], v2, s[4:7], s91 offen offset:1024
  s_add_u32 s91, s91, 2048
  v_mfma_f32_16x16x32_bf16 v[104:107], a[180:183], v[160:163], v[104:107]
  ds_read_b128 v[152:155], v5 offset:53248
  v_mfma_f32_16x16x32_bf16 v[108:111], v[196:199], v[160:163], v[108:111]
  v_mfma_f32_16x16x32_bf16 v[112:115], a[180:183], v[164:167], v[112:115]
  ds_read_b128 v[156:159], v5 offset:55296
  s_add_u32 m0, s52, 18432
  v_mfma_f32_16x16x32_bf16 v[116:119], v[196:199], v[164:167], v[116:119]
  buffer_load_dwordx4 v2, s[8:11], s48 offen sc1 lds
  buffer_load_dwordx4 v2, s[8:11], s48 offen offset:1024 sc1 lds
  s_add_u32 s48, s48, 2048
  v_mfma_f32_16x16x32_bf16 v[120:123], a[180:183], v[168:171], v[120:123]
  ds_read_b128 v[160:163], v5 offset:57344
  v_mfma_f32_16x16x32_bf16 v[124:127], v[196:199], v[168:171], v[124:127]
  v_mfma_f32_16x16x32_bf16 v[128:131], a[180:183], v[172:175], v[128:131]
  ds_read_b128 v[164:167], v5 offset:59392
  v_mfma_f32_16x16x32_bf16 v[132:135], v[196:199], v[172:175], v[132:135]
  v_mfma_f32_16x16x32_bf16 v[136:139], a[180:183], v[176:179], v[136:139]
  ds_read_b128 v[168:171], v5 offset:61440
  v_mfma_f32_16x16x32_bf16 v[140:143], v[196:199], v[176:179], v[140:143]
  v_mfma_f32_16x16x32_bf16 v[144:147], a[180:183], v[180:183], v[144:147]
  ds_read_b128 v[172:175], v5 offset:63488
  v_mfma_f32_16x16x32_bf16 v[148:151], v[196:199], v[180:183], v[148:151]
  v_mfma_f32_16x16x32_bf16 v[70:73], a[180:183], v[82:85], v[70:73]
  v_mfma_f32_16x16x32_bf16 v[74:77], v[196:199], v[82:85], v[74:77]
  s_waitcnt lgkmcnt(6)
  v_mfma_f32_16x16x32_bf16 v[88:91], a[184:187], v[184:187], v[88:91]
  ds_read_b128 v[176:179], v6 offset:49152
  v_mfma_f32_16x16x32_bf16 v[92:95], v[200:203], v[184:187], v[92:95]
  v_mfma_f32_16x16x32_bf16 v[96:99], a[184:187], v[188:191], v[96:99]
  ds_read_b128 v[180:183], v6 offset:51200
  v_mfma_f32_16x16x32_bf16 v[100:103], v[200:203], v[188:191], v[100:103]
  buffer_load_dwordx4 a[208:211], v2, s[4:7], s85 offen
  buffer_load_dwordx4 a[212:215], v2, s[4:7], s85 offen offset:1024
  s_add_u32 s85, s85, 2048
  s_waitcnt lgkmcnt(6)
  v_mfma_f32_16x16x32_bf16 v[104:107], a[184:187], v[152:155], v[104:107]
  ds_read_b128 v[184:187], v6 offset:53248
  v_mfma_f32_16x16x32_bf16 v[108:111], v[200:203], v[152:155], v[108:111]
  v_mfma_f32_16x16x32_bf16 v[112:115], a[184:187], v[156:159], v[112:115]
  ds_read_b128 v[188:191], v6 offset:55296
  s_add_u32 m0, s52, 32768
  v_mfma_f32_16x16x32_bf16 v[116:119], v[200:203], v[156:159], v[116:119]
  buffer_load_dwordx4 v2, s[8:11], s46 offen sc1 lds
  buffer_load_dwordx4 v2, s[8:11], s46 offen offset:1024 sc1 lds
  s_add_u32 s46, s46, 2048
  s_waitcnt lgkmcnt(6)
  v_mfma_f32_16x16x32_bf16 v[120:123], a[184:187], v[160:163], v[120:123]
  ds_read_b128 v[152:155], v6 offset:57344
  v_mfma_f32_16x16x32_bf16 v[124:127], v[200:203], v[160:163], v[124:127]
  v_mfma_f32_16x16x32_bf16 v[128:131], a[184:187], v[164:167], v[128:131]
  ds_read_b128 v[156:159], v6 offset:59392
  v_mfma_f32_16x16x32_bf16 v[132:135], v[200:203], v[164:167], v[132:135]
  s_waitcnt lgkmcnt(6)
  v_mfma_f32_16x16x32_bf16 v[136:139], a[184:187], v[168:171], v[136:139]
  ds_read_b128 v[160:163], v6 offset:61440
  v_mfma_f32_16x16x32_bf16 v[140:143], v[200:203], v[168:171], v[140:143]
  v_mfma_f32_16x16x32_bf16 v[144:147], a[184:187], v[172:175], v[144:147]
  ds_read_b128 v[164:167], v6 offset:63488
  v_mfma_f32_16x16x32_bf16 v[148:151], v[200:203], v[172:175], v[148:151]
  v_mfma_f32_16x16x32_bf16 v[70:73], a[184:187], v[82:85], v[70:73]
  v_mfma_f32_16x16x32_bf16 v[74:77], v[200:203], v[82:85], v[74:77]
  s_waitcnt vmcnt(12) lgkmcnt(0)
  s_barrier
  v_mfma_f32_16x16x32_bf16 v[88:91], a[188:191], v[176:179], v[88:91]
  ds_read_b128 v[168:171], v5 offset:0
  v_mfma_f32_16x16x32_bf16 v[92:95], v[204:207], v[176:179], v[92:95]
  v_mfma_f32_16x16x32_bf16 v[96:99], a[188:191], v[180:183], v[96:99]
  ds_read_b128 v[172:175], v5 offset:2048
  v_mfma_f32_16x16x32_bf16 v[100:103], v[204:207], v[180:183], v[100:103]
  buffer_load_dwordx4 v[224:227], v2, s[4:7], s91 offen
  buffer_load_dwordx4 v[228:231], v2, s[4:7], s91 offen offset:1024
  s_add_u32 s91, s91, 2048
  v_mfma_f32_16x16x32_bf16 v[104:107], a[188:191], v[184:187], v[104:107]
  ds_read_b128 v[176:179], v5 offset:4096
  v_mfma_f32_16x16x32_bf16 v[108:111], v[204:207], v[184:187], v[108:111]
  v_mfma_f32_16x16x32_bf16 v[112:115], a[188:191], v[188:191], v[112:115]
  ds_read_b128 v[180:183], v5 offset:6144
  s_add_u32 m0, s52, 34816
  v_mfma_f32_16x16x32_bf16 v[116:119], v[204:207], v[188:191], v[116:119]
  buffer_load_dwordx4 v2, s[8:11], s48 offen sc1 lds
  buffer_load_dwordx4 v2, s[8:11], s48 offen offset:1024 sc1 lds
  s_add_u32 s48, s48, 2048
  v_mfma_f32_16x16x32_bf16 v[120:123], a[188:191], v[152:155], v[120:123]
  ds_read_b128 v[184:187], v5 offset:8192
  v_mfma_f32_16x16x32_bf16 v[124:127], v[204:207], v[152:155], v[124:127]
  v_mfma_f32_16x16x32_bf16 v[128:131], a[188:191], v[156:159], v[128:131]
  ds_read_b128 v[188:191], v5 offset:10240
  v_mfma_f32_16x16x32_bf16 v[132:135], v[204:207], v[156:159], v[132:135]
  v_mfma_f32_16x16x32_bf16 v[136:139], a[188:191], v[160:163], v[136:139]
  ds_read_b128 v[152:155], v5 offset:12288
  v_mfma_f32_16x16x32_bf16 v[140:143], v[204:207], v[160:163], v[140:143]
  v_mfma_f32_16x16x32_bf16 v[144:147], a[188:191], v[164:167], v[144:147]
  ds_read_b128 v[156:159], v5 offset:14336
  v_mfma_f32_16x16x32_bf16 v[148:151], v[204:207], v[164:167], v[148:151]
  v_mfma_f32_16x16x32_bf16 v[70:73], a[188:191], v[82:85], v[70:73]
  v_mfma_f32_16x16x32_bf16 v[74:77], v[204:207], v[82:85], v[74:77]
  s_waitcnt lgkmcnt(6)
  v_mfma_f32_16x16x32_bf16 v[88:91], a[192:195], v[168:171], v[88:91]
  ds_read_b128 v[160:163], v6 offset:0
  v_mfma_f32_16x16x32_bf16 v[92:95], v[208:211], v[168:171], v[92:95]
  v_mfma_f32_16x16x32_bf16 v[96:99], a[192:195], v[172:175], v[96:99]
  ds_read_b128 v[164:167], v6 offset:2048
  v_mfma_f32_16x16x32_bf16 v[100:103], v[208:211], v[172:175], v[100:103]
  buffer_load_dwordx4 a[216:219], v2, s[4:7], s85 offen
  buffer_load_dwordx4 a[220:223], v2, s[4:7], s85 offen offset:1024
  s_add_u32 s85, s85, 2048
  s_waitcnt lgkmcnt(6)
  v_mfma_f32_16x16x32_bf16 v[104:107], a[192:195], v[176:179], v[104:107]
  ds_read_b128 v[168:171], v6 offset:4096
  v_mfma_f32_16x16x32_bf16 v[108:111], v[208:211], v[176:179], v[108:111]
  v_mfma_f32_16x16x32_bf16 v[112:115], a[192:195], v[180:183], v[112:115]
  ds_read_b128 v[172:175], v6 offset:6144
  s_add_u32 m0, s52, 49152
  v_mfma_f32_16x16x32_bf16 v[116:119], v[208:211], v[180:183], v[116:119]
  buffer_load_dwordx4 v2, s[8:11], s46 offen sc1 lds
  buffer_load_dwordx4 v2, s[8:11], s46 offen offset:1024 sc1 lds
  s_add_u32 s46, s46, 2048
  s_waitcnt lgkmcnt(6)
  v_mfma_f32_16x16x32_bf16 v[120:123], a[192:195], v[184:187], v[120:123]
  ds_read_b128 v[176:179], v6 offset:8192
  v_mfma_f32_16x16x32_bf16 v[124:127], v[208:211], v[184:187], v[124:127]
  v_mfma_f32_16x16x32_bf16 v[128:131], a[192:195], v[188:191], v[128:131]
  ds_read_b128 v[180:183], v6 offset:10240
  v_mfma_f32_16x16x32_bf16 v[132:135], v[208:211], v[188:191], v[132:135]
  s_waitcnt lgkmcnt(6)
  v_mfma_f32_16x16x32_bf16 v[136:139], a[192:195], v[152:155], v[136:139]
  ds_read_b128 v[184:187], v6 offset:12288
  v_mfma_f32_16x16x32_bf16 v[140:143], v[208:211], v[152:155], v[140:143]
  v_mfma_f32_16x16x32_bf16 v[144:147], a[192:195], v[156:159], v[144:147]
  ds_read_b128 v[188:191], v6 offset:14336
  v_mfma_f32_16x16x32_bf16 v[148:151], v[208:211], v[156:159], v[148:151]
  v_mfma_f32_16x16x32_bf16 v[70:73], a[192:195], v[82:85], v[70:73]
  v_mfma_f32_16x16x32_bf16 v[74:77], v[208:211], v[82:85], v[74:77]
  s_waitcnt vmcnt(12) lgkmcnt(0)
  s_barrier
  v_mfma_f32_16x16x32_bf16 v[88:91], a[196:199], v[160:163], v[88:91]
  ds_read_b128 v[152:155], v5 offset:16384
  v_mfma_f32_16x16x32_bf16 v[92:95], v[212:215], v[160:163], v[92:95]
  v_mfma_f32_16x16x32_bf16 v[96:99], a[196:199], v[164:167], v[96:99]
  ds_read_b128 v[156:159], v5 offset:18432
  v_mfma_f32_16x16x32_bf16 v[100:103], v[212:215], v[164:167], v[100:103]
  buffer_load_dwordx4 v[232:235], v2, s[4:7], s91 offen
  buffer_load_dwordx4 v[236:239], v2, s[4:7], s91 offen offset:1024
  s_add_u32 s91, s91, 2048
  v_mfma_f32_16x16x32_bf16 v[104:107], a[196:199], v[168:171], v[104:107]
  ds_read_b128 v[160:163], v5 offset:20480
  v_mfma_f32_16x16x32_bf16 v[108:111], v[212:215], v[168:171], v[108:111]
  v_mfma_f32_16x16x32_bf16 v[112:115], a[196:199], v[172:175], v[112:115]
  ds_read_b128 v[164:167], v5 offset:22528
  s_add_u32 m0, s52, 51200
  v_mfma_f32_16x16x32_bf16 v[116:119], v[212:215], v[172:175], v[116:119]
  buffer_load_dwordx4 v2, s[8:11], s48 offen sc1 lds
  buffer_load_dwordx4 v2, s[8:11], s48 offen offset:1024 sc1 lds
  s_add_u32 s48, s48, 2048
  v_mfma_f32_16x16x32_bf16 v[120:123], a[196:199], v[176:179], v[120:123]
  ds_read_b128 v[168:171], v5 offset:24576
  v_mfma_f32_16x16x32_bf16 v[124:127], v[212:215], v[176:179], v[124:127]
  v_mfma_f32_16x16x32_bf16 v[128:131], a[196:199], v[180:183], v[128:131]
  ds_read_b128 v[172:175], v5 offset:26624
  v_mfma_f32_16x16x32_bf16 v[132:135], v[212:215], v[180:183], v[132:135]
  v_mfma_f32_16x16x32_bf16 v[136:139], a[196:199], v[184:187], v[136:139]
  ds_read_b128 v[176:179], v5 offset:28672
  v_mfma_f32_16x16x32_bf16 v[140:143], v[212:215], v[184:187], v[140:143]
  v_mfma_f32_16x16x32_bf16 v[144:147], a[196:199], v[188:191], v[144:147]
  ds_read_b128 v[180:183], v5 offset:30720
  v_mfma_f32_16x16x32_bf16 v[148:151], v[212:215], v[188:191], v[148:151]
  v_mfma_f32_16x16x32_bf16 v[70:73], a[196:199], v[82:85], v[70:73]
  v_mfma_f32_16x16x32_bf16 v[74:77], v[212:215], v[82:85], v[74:77]
  s_waitcnt lgkmcnt(6)
  v_mfma_f32_16x16x32_bf16 v[88:91], a[200:203], v[152:155], v[88:91]
  ds_read_b128 v[184:187], v6 offset:16384
  v_mfma_f32_16x16x32_bf16 v[92:95], v[216:219], v[152:155], v[92:95]
  v_mfma_f32_16x16x32_bf16 v[96:99], a[200:203], v[156:159], v[96:99]
  ds_read_b128 v[188:191], v6 offset:18432
  v_mfma_f32_16x16x32_bf16 v[100:103], v[216:219], v[156:159], v[100:103]
  buffer_load_dwordx4 a[224:227], v2, s[4:7], s85 offen
  buffer_load_dwordx4 a[228:231], v2, s[4:7], s85 offen offset:1024
  s_add_u32 s85, s85, 2048
  s_waitcnt lgkmcnt(6)
  v_mfma_f32_16x16x32_bf16 v[104:107], a[200:203], v[160:163], v[104:107]
  ds_read_b128 v[152:155], v6 offset:20480
  v_mfma_f32_16x16x32_bf16 v[108:111], v[216:219], v[160:163], v[108:111]
  v_mfma_f32_16x16x32_bf16 v[112:115], a[200:203], v[164:167], v[112:115]
  ds_read_b128 v[156:159], v6 offset:22528
  s_add_u32 m0, s52, 0
  v_mfma_f32_16x16x32_bf16 v[116:119], v[216:219], v[164:167], v[116:119]
  buffer_load_dwordx4 v2, s[8:11], s46 offen sc1 lds
  buffer_load_dwordx4 v2, s[8:11], s46 offen offset:1024 sc1 lds
  s_add_u32 s46, s46, 2048
  s_waitcnt lgkmcnt(6)
  v_mfma_f32_16x16x32_bf16 v[120:123], a[200:203], v[168:171], v[120:123]
  ds_read_b128 v[160:163], v6 offset:24576
  v_mfma_f32_16x16x32_bf16 v[124:127], v[216:219], v[168:171], v[124:127]
  v_mfma_f32_16x16x32_bf16 v[128:131], a[200:203], v[172:175], v[128:131]
  ds_read_b128 v[164:167], v6 offset:26624
  v_mfma_f32_16x16x32_bf16 v[132:135], v[216:219], v[172:175], v[132:135]
  s_waitcnt lgkmcnt(6)
  v_mfma_f32_16x16x32_bf16 v[136:139], a[200:203], v[176:179], v[136:139]
  ds_read_b128 v[168:171], v6 offset:28672
  v_mfma_f32_16x16x32_bf16 v[140:143], v[216:219], v[176:179], v[140:143]
  v_mfma_f32_16x16x32_bf16 v[144:147], a[200:203], v[180:183], v[144:147]
  ds_read_b128 v[172:175], v6 offset:30720
  v_mfma_f32_16x16x32_bf16 v[148:151], v[216:219], v[180:183], v[148:151]
  v_mfma_f32_16x16x32_bf16 v[70:73], a[200:203], v[82:85], v[70:73]
  v_mfma_f32_16x16x32_bf16 v[74:77], v[216:219], v[82:85], v[74:77]
  s_waitcnt vmcnt(12) lgkmcnt(0)
  s_barrier
  v_mfma_f32_16x16x32_bf16 v[88:91], a[204:207], v[184:187], v[88:91]
  ds_read_b128 v[176:179], v5 offset:32768
  v_mfma_f32_16x16x32_bf16 v[92:95], v[220:223], v[184:187], v[92:95]
  v_mfma_f32_16x16x32_bf16 v[96:99], a[204:207], v[188:191], v[96:99]
  ds_read_b128 v[180:183], v5 offset:34816
  v_mfma_f32_16x16x32_bf16 v[100:103], v[220:223], v[188:191], v[100:103]
  buffer_load_dwordx4 v[240:243], v2, s[4:7], s91 offen
  buffer_load_dwordx4 v[244:247], v2, s[4:7], s91 offen offset:1024
  s_add_u32 s91, s91, 2048
  v_mfma_f32_16x16x32_bf16 v[104:107], a[204:207], v[152:155], v[104:107]
  ds_read_b128 v[184:187], v5 offset:36864
  v_mfma_f32_16x16x32_bf16 v[108:111], v[220:223], v[152:155], v[108:111]
  v_mfma_f32_16x16x32_bf16 v[112:115], a[204:207], v[156:159], v[112:115]
  ds_read_b128 v[188:191], v5 offset:38912
  s_add_u32 m0, s52, 2048
  v_mfma_f32_16x16x32_bf16 v[116:119], v[220:223], v[156:159], v[116:119]
  buffer_load_dwordx4 v2, s[8:11], s48 offen sc1 lds
  buffer_load_dwordx4 v2, s[8:11], s48 offen offset:1024 sc1 lds
  s_add_u32 s48, s48, 2048
  v_mfma_f32_16x16x32_bf16 v[120:123], a[204:207], v[160:163], v[120:123]
  ds_read_b128 v[152:155], v5 offset:40960
  v_mfma_f32_16x16x32_bf16 v[124:127], v[220:223], v[160:163], v[124:127]
  v_mfma_f32_16x16x32_bf16 v[128:131], a[204:207], v[164:167], v[128:131]
  ds_read_b128 v[156:159], v5 offset:43008
  v_mfma_f32_16x16x32_bf16 v[132:135], v[220:223], v[164:167], v[132:135]
  v_mfma_f32_16x16x32_bf16 v[136:139], a[204:207], v[168:171], v[136:139]
  ds_read_b128 v[160:163], v5 offset:45056
  v_mfma_f32_16x16x32_bf16 v[140:143], v[220:223], v[168:171], v[140:143]
  v_mfma_f32_16x16x32_bf16 v[144:147], a[204:207], v[172:175], v[144:147]
  ds_read_b128 v[164:167], v5 offset:47104
  v_mfma_f32_16x16x32_bf16 v[148:151], v[220:223], v[172:175], v[148:151]
  v_mfma_f32_16x16x32_bf16 v[70:73], a[204:207], v[82:85], v[70:73]
  v_mfma_f32_16x16x32_bf16 v[74:77], v[220:223], v[82:85], v[74:77]
  s_waitcnt lgkmcnt(6)
  v_mfma_f32_16x16x32_bf16 v[88:91], a[208:211], v[176:179], v[88:91]
  ds_read_b128 v[168:171], v6 offset:32768
  v_mfma_f32_16x16x32_bf16 v[92:95], v[224:227], v[176:179], v[92:95]
  v_mfma_f32_16x16x32_bf16 v[96:99], a[208:211], v[180:183], v[96:99]
  ds_read_b128 v[172:175], v6 offset:34816
  v_mfma_f32_16x16x32_bf16 v[100:103], v[224:227], v[180:183], v[100:103]
  buffer_load_dwordx4 a[232:235], v2, s[4:7], s85 offen
  buffer_load_dwordx4 a[236:239], v2, s[4:7], s85 offen offset:1024
  s_add_u32 s85, s85, 2048
  s_waitcnt lgkmcnt(6)
  v_mfma_f32_16x16x32_bf16 v[104:107], a[208:211], v[184:187], v[104:107]
  ds_read_b128 v[176:179], v6 offset:36864
  v_mfma_f32_16x16x32_bf16 v[108:111], v[224:227], v[184:187], v[108:111]
  v_mfma_f32_16x16x32_bf16 v[112:115], a[208:211], v[188:191], v[112:115]
  ds_read_b128 v[180:183], v6 offset:38912
  s_add_u32 m0, s52, 16384
  v_mfma_f32_16x16x32_bf16 v[116:119], v[224:227], v[188:191], v[116:119]
  buffer_load_dwordx4 v2, s[8:11], s46 offen sc1 lds
  buffer_load_dwordx4 v2, s[8:11], s46 offen offset:1024 sc1 lds
  s_add_u32 s46, s46, 2048
  s_waitcnt lgkmcnt(6)
  v_mfma_f32_16x16x32_bf16 v[120:123], a[208:211], v[152:155], v[120:123]
  ds_read_b128 v[184:187], v6 offset:40960
  v_mfma_f32_16x16x32_bf16 v[124:127], v[224:227], v[152:155], v[124:127]
  v_mfma_f32_16x16x32_bf16 v[128:131], a[208:211], v[156:159], v[128:131]
  ds_read_b128 v[188:191], v6 offset:43008
  v_mfma_f32_16x16x32_bf16 v[132:135], v[224:227], v[156:159], v[132:135]
  s_waitcnt lgkmcnt(6)
  v_mfma_f32_16x16x32_bf16 v[136:139], a[208:211], v[160:163], v[136:139]
  ds_read_b128 v[152:155], v6 offset:45056
  v_mfma_f32_16x16x32_bf16 v[140:143], v[224:227], v[160:163], v[140:143]
  v_mfma_f32_16x16x32_bf16 v[144:147], a[208:211], v[164:167], v[144:147]
  ds_read_b128 v[156:159], v6 offset:47104
  v_mfma_f32_16x16x32_bf16 v[148:151], v[224:227], v[164:167], v[148:151]
  v_mfma_f32_16x16x32_bf16 v[70:73], a[208:211], v[82:85], v[70:73]
  v_mfma_f32_16x16x32_bf16 v[74:77], v[224:227], v[82:85], v[74:77]
  s_waitcnt vmcnt(12) lgkmcnt(0)
  s_barrier
  v_mfma_f32_16x16x32_bf16 v[88:91], a[212:215], v[168:171], v[88:91]
  ds_read_b128 v[160:163], v5 offset:49152
  v_mfma_f32_16x16x32_bf16 v[92:95], v[228:231], v[168:171], v[92:95]
  v_mfma_f32_16x16x32_bf16 v[96:99], a[212:215], v[172:175], v[96:99]
  ds_read_b128 v[164:167], v5 offset:51200
  v_mfma_f32_16x16x32_bf16 v[100:103], v[228:231], v[172:175], v[100:103]
  buffer_load_dwordx4 v[248:251], v2, s[4:7], s91 offen
  buffer_load_dwordx4 v[252:255], v2, s[4:7], s91 offen offset:1024
  s_add_u32 s91, s91, 2048
  v_mfma_f32_16x16x32_bf16 v[104:107], a[212:215], v[176:179], v[104:107]
  ds_read_b128 v[168:171], v5 offset:53248
  v_mfma_f32_16x16x32_bf16 v[108:111], v[228:231], v[176:179], v[108:111]
  v_mfma_f32_16x16x32_bf16 v[112:115], a[212:215], v[180:183], v[112:115]
  ds_read_b128 v[172:175], v5 offset:55296
  s_add_u32 m0, s52, 18432
  v_mfma_f32_16x16x32_bf16 v[116:119], v[228:231], v[180:183], v[116:119]
  buffer_load_dwordx4 v2, s[8:11], s48 offen sc1 lds
  buffer_load_dwordx4 v2, s[8:11], s48 offen offset:1024 sc1 lds
  s_add_u32 s48, s48, 2048
  v_mfma_f32_16x16x32_bf16 v[120:123], a[212:215], v[184:187], v[120:123]
  ds_read_b128 v[176:179], v5 offset:57344
  v_mfma_f32_16x16x32_bf16 v[124:127], v[228:231], v[184:187], v[124:127]
  v_mfma_f32_16x16x32_bf16 v[128:131], a[212:215], v[188:191], v[128:131]
  ds_read_b128 v[180:183], v5 offset:59392
  v_mfma_f32_16x16x32_bf16 v[132:135], v[228:231], v[188:191], v[132:135]
  v_mfma_f32_16x16x32_bf16 v[136:139], a[212:215], v[152:155], v[136:139]
  ds_read_b128 v[184:187], v5 offset:61440
  v_mfma_f32_16x16x32_bf16 v[140:143], v[228:231], v[152:155], v[140:143]
  v_mfma_f32_16x16x32_bf16 v[144:147], a[212:215], v[156:159], v[144:147]
  ds_read_b128 v[188:191], v5 offset:63488
  v_mfma_f32_16x16x32_bf16 v[148:151], v[228:231], v[156:159], v[148:151]
  v_mfma_f32_16x16x32_bf16 v[70:73], a[212:215], v[82:85], v[70:73]
  v_mfma_f32_16x16x32_bf16 v[74:77], v[228:231], v[82:85], v[74:77]
  s_waitcnt lgkmcnt(6)
  v_mfma_f32_16x16x32_bf16 v[88:91], a[216:219], v[160:163], v[88:91]
  ds_read_b128 v[152:155], v6 offset:49152
  v_mfma_f32_16x16x32_bf16 v[92:95], v[232:235], v[160:163], v[92:95]
  v_mfma_f32_16x16x32_bf16 v[96:99], a[216:219], v[164:167], v[96:99]
  ds_read_b128 v[156:159], v6 offset:51200
  s_add_u32 m0, s100, 0
  s_add_u32 s60, s94, 0
  v_mfma_f32_16x16x32_bf16 v[100:103], v[232:235], v[164:167], v[100:103]
  buffer_load_dwordx4 v2, s[4:7], s60 offen lds
  s_waitcnt lgkmcnt(6)
  v_mfma_f32_16x16x32_bf16 v[104:107], a[216:219], v[168:171], v[104:107]
  ds_read_b128 v[160:163], v6 offset:53248
  v_mfma_f32_16x16x32_bf16 v[108:111], v[232:235], v[168:171], v[108:111]
  v_mfma_f32_16x16x32_bf16 v[112:115], a[216:219], v[172:175], v[112:115]
  ds_read_b128 v[164:167], v6 offset:55296
  s_add_u32 m0, s100, 1024
  s_add_u32 s60, s94, 1024
  v_mfma_f32_16x16x32_bf16 v[116:119], v[232:235], v[172:175], v[116:119]
  buffer_load_dwordx4 v2, s[4:7], s60 offen lds
  s_waitcnt lgkmcnt(6)
  v_mfma_f32_16x16x32_bf16 v[120:123], a[216:219], v[176:179], v[120:123]
  ds_read_b128 v[168:171], v6 offset:57344
  v_mfma_f32_16x16x32_bf16 v[124:127], v[232:235], v[176:179], v[124:127]
  v_mfma_f32_16x16x32_bf16 v[128:131], a[216:219], v[180:183], v[128:131]
  ds_read_b128 v[172:175], v6 offset:59392
  s_add_u32 m0, s100, 2048
  s_add_u32 s60, s94, 2048
  v_mfma_f32_16x16x32_bf16 v[132:135], v[232:235], v[180:183], v[132:135]
  buffer_load_dwordx4 v2, s[4:7], s60 offen lds
  s_waitcnt lgkmcnt(6)
  v_mfma_f32_16x16x32_bf16 v[136:139], a[216:219], v[184:187], v[136:139]
  ds_read_b128 v[176:179], v6 offset:61440
  v_mfma_f32_16x16x32_bf16 v[140:143], v[232:235], v[184:187], v[140:143]
  v_mfma_f32_16x16x32_bf16 v[144:147], a[216:219], v[188:191], v[144:147]
  ds_read_b128 v[180:183], v6 offset:63488
  v_mfma_f32_16x16x32_bf16 v[148:151], v[232:235], v[188:191], v[148:151]
  v_mfma_f32_16x16x32_bf16 v[70:73], a[216:219], v[82:85], v[70:73]
  v_mfma_f32_16x16x32_bf16 v[74:77], v[232:235], v[82:85], v[74:77]
  s_waitcnt vmcnt(11) lgkmcnt(0)
  s_barrier
  v_mfma_f32_16x16x32_bf16 v[88:91], a[220:223], v[152:155], v[88:91]
  ds_read_b128 v[184:187], v5 offset:0
  v_mfma_f32_16x16x32_bf16 v[92:95], v[236:239], v[152:155], v[92:95]
  v_mfma_f32_16x16x32_bf16 v[96:99], a[220:223], v[156:159], v[96:99]
  ds_read_b128 v[188:191], v5 offset:2048
  s_add_u32 m0, s100, 3072
  s_add_u32 s60, s94, 3072
  v_mfma_f32_16x16x32_bf16 v[100:103], v[236:239], v[156:159], v[100:103]
  buffer_load_dwordx4 v2, s[4:7], s60 offen lds
  v_mfma_f32_16x16x32_bf16 v[104:107], a[220:223], v[160:163], v[104:107]
  ds_read_b128 v[152:155], v5 offset:4096
  v_mfma_f32_16x16x32_bf16 v[108:111], v[236:239], v[160:163], v[108:111]
  v_mfma_f32_16x16x32_bf16 v[112:115], a[220:223], v[164:167], v[112:115]
  ds_read_b128 v[156:159], v5 offset:6144
  s_add_u32 m0, s100, 4096
  s_add_u32 s60, s94, 4096
  v_mfma_f32_16x16x32_bf16 v[116:119], v[236:239], v[164:167], v[116:119]
  buffer_load_dwordx4 v2, s[4:7], s60 offen lds
  v_mfma_f32_16x16x32_bf16 v[120:123], a[220:223], v[168:171], v[120:123]
  ds_read_b128 v[160:163], v5 offset:8192
  v_mfma_f32_16x16x32_bf16 v[124:127], v[236:239], v[168:171], v[124:127]
  v_mfma_f32_16x16x32_bf16 v[128:131], a[220:223], v[172:175], v[128:131]
  ds_read_b128 v[164:167], v5 offset:10240
  s_add_u32 m0, s100, 5120
  s_add_u32 s60, s94, 5120
  v_mfma_f32_16x16x32_bf16 v[132:135], v[236:239], v[172:175], v[132:135]
  buffer_load_dwordx4 v2, s[4:7], s60 offen lds
  v_mfma_f32_16x16x32_bf16 v[136:139], a[220:223], v[176:179], v[136:139]
  ds_read_b128 v[168:171], v5 offset:12288
  v_mfma_f32_16x16x32_bf16 v[140:143], v[236:239], v[176:179], v[140:143]
  v_mfma_f32_16x16x32_bf16 v[144:147], a[220:223], v[180:183], v[144:147]
  ds_read_b128 v[172:175], v5 offset:14336
  v_mfma_f32_16x16x32_bf16 v[148:151], v[236:239], v[180:183], v[148:151]
  v_mfma_f32_16x16x32_bf16 v[70:73], a[220:223], v[82:85], v[70:73]
  v_mfma_f32_16x16x32_bf16 v[74:77], v[236:239], v[82:85], v[74:77]
  s_waitcnt lgkmcnt(6)
  v_mfma_f32_16x16x32_bf16 v[88:91], a[224:227], v[184:187], v[88:91]
  ds_read_b128 v[176:179], v6 offset:0
  v_mfma_f32_16x16x32_bf16 v[92:95], v[240:243], v[184:187], v[92:95]
  v_mfma_f32_16x16x32_bf16 v[96:99], a[224:227], v[188:191], v[96:99]
  ds_read_b128 v[180:183], v6 offset:2048
  s_add_u32 m0, s100, 6144
  s_add_u32 s60, s94, 6144
  v_mfma_f32_16x16x32_bf16 v[100:103], v[240:243], v[188:191], v[100:103]
  buffer_load_dwordx4 v2, s[4:7], s60 offen lds
  s_waitcnt lgkmcnt(6)
  v_mfma_f32_16x16x32_bf16 v[104:107], a[224:227], v[152:155], v[104:107]
  ds_read_b128 v[184:187], v6 offset:4096
  v_mfma_f32_16x16x32_bf16 v[108:111], v[240:243], v[152:155], v[108:111]
  v_mfma_f32_16x16x32_bf16 v[112:115], a[224:227], v[156:159], v[112:115]
  ds_read_b128 v[188:191], v6 offset:6144
  s_add_u32 m0, s100, 7168
  s_add_u32 s60, s94, 7168
  v_mfma_f32_16x16x32_bf16 v[116:119], v[240:243], v[156:159], v[116:119]
  buffer_load_dwordx4 v2, s[4:7], s60 offen lds
  s_waitcnt lgkmcnt(6)
  v_mfma_f32_16x16x32_bf16 v[120:123], a[224:227], v[160:163], v[120:123]
  ds_read_b128 v[152:155], v6 offset:8192
  v_mfma_f32_16x16x32_bf16 v[124:127], v[240:243], v[160:163], v[124:127]
  v_mfma_f32_16x16x32_bf16 v[128:131], a[224:227], v[164:167], v[128:131]
  ds_read_b128 v[156:159], v6 offset:10240
  s_add_u32 m0, s100, 8192
  s_add_u32 s60, s94, 8192
  v_mfma_f32_16x16x32_bf16 v[132:135], v[240:243], v[164:167], v[132:135]
  buffer_load_dwordx4 v2, s[4:7], s60 offen lds
  s_waitcnt lgkmcnt(6)
  v_mfma_f32_16x16x32_bf16 v[136:139], a[224:227], v[168:171], v[136:139]
  ds_read_b128 v[160:163], v6 offset:12288
  v_mfma_f32_16x16x32_bf16 v[140:143], v[240:243], v[168:171], v[140:143]
  v_mfma_f32_16x16x32_bf16 v[144:147], a[224:227], v[172:175], v[144:147]
  ds_read_b128 v[164:167], v6 offset:14336
  v_mfma_f32_16x16x32_bf16 v[148:151], v[240:243], v[172:175], v[148:151]
  v_mfma_f32_16x16x32_bf16 v[70:73], a[224:227], v[82:85], v[70:73]
  v_mfma_f32_16x16x32_bf16 v[74:77], v[240:243], v[82:85], v[74:77]
  s_waitcnt vmcnt(9) lgkmcnt(0)
  s_barrier
  v_mfma_f32_16x16x32_bf16 v[88:91], a[228:231], v[176:179], v[88:91]
  ds_read_b128 v[168:171], v5 offset:16384
  v_mfma_f32_16x16x32_bf16 v[92:95], v[244:247], v[176:179], v[92:95]
  v_mfma_f32_16x16x32_bf16 v[96:99], a[228:231], v[180:183], v[96:99]
  ds_read_b128 v[172:175], v5 offset:18432
  s_add_u32 m0, s100, 9216
  s_add_u32 s60, s94, 9216
  v_mfma_f32_16x16x32_bf16 v[100:103], v[244:247], v[180:183], v[100:103]
  buffer_load_dwordx4 v2, s[4:7], s60 offen lds
  v_mfma_f32_16x16x32_bf16 v[104:107], a[228:231], v[184:187], v[104:107]
  ds_read_b128 v[176:179], v5 offset:20480
  v_mfma_f32_16x16x32_bf16 v[108:111], v[244:247], v[184:187], v[108:111]
  v_mfma_f32_16x16x32_bf16 v[112:115], a[228:231], v[188:191], v[112:115]
  ds_read_b128 v[180:183], v5 offset:22528
  s_add_u32 m0, s100, 10240
  s_add_u32 s60, s94, 10240
  v_mfma_f32_16x16x32_bf16 v[116:119], v[244:247], v[188:191], v[116:119]
  buffer_load_dwordx4 v2, s[4:7], s60 offen lds
  v_mfma_f32_16x16x32_bf16 v[120:123], a[228:231], v[152:155], v[120:123]
  ds_read_b128 v[184:187], v5 offset:24576
  v_mfma_f32_16x16x32_bf16 v[124:127], v[244:247], v[152:155], v[124:127]
  v_mfma_f32_16x16x32_bf16 v[128:131], a[228:231], v[156:159], v[128:131]
  ds_read_b128 v[188:191], v5 offset:26624
  s_add_u32 m0, s100, 11264
  s_add_u32 s60, s94, 11264
  v_mfma_f32_16x16x32_bf16 v[132:135], v[244:247], v[156:159], v[132:135]
  buffer_load_dwordx4 v2, s[4:7], s60 offen lds
  v_mfma_f32_16x16x32_bf16 v[136:139], a[228:231], v[160:163], v[136:139]
  ds_read_b128 v[152:155], v5 offset:28672
  v_mfma_f32_16x16x32_bf16 v[140:143], v[244:247], v[160:163], v[140:143]
  v_mfma_f32_16x16x32_bf16 v[144:147], a[228:231], v[164:167], v[144:147]
  ds_read_b128 v[156:159], v5 offset:30720
  v_mfma_f32_16x16x32_bf16 v[148:151], v[244:247], v[164:167], v[148:151]
  v_mfma_f32_16x16x32_bf16 v[70:73], a[228:231], v[82:85], v[70:73]
  v_mfma_f32_16x16x32_bf16 v[74:77], v[244:247], v[82:85], v[74:77]
  s_waitcnt lgkmcnt(6)
  v_mfma_f32_16x16x32_bf16 v[88:91], a[232:235], v[168:171], v[88:91]
  ds_read_b128 v[160:163], v6 offset:16384
  v_mfma_f32_16x16x32_bf16 v[92:95], v[248:251], v[168:171], v[92:95]
  v_mfma_f32_16x16x32_bf16 v[96:99], a[232:235], v[172:175], v[96:99]
  ds_read_b128 v[164:167], v6 offset:18432
  s_add_u32 m0, s100, 12288
  s_add_u32 s60, s94, 12288
  v_mfma_f32_16x16x32_bf16 v[100:103], v[248:251], v[172:175], v[100:103]
  buffer_load_dwordx4 v2, s[4:7], s60 offen lds
  s_waitcnt lgkmcnt(6)
  v_mfma_f32_16x16x32_bf16 v[104:107], a[232:235], v[176:179], v[104:107]
  ds_read_b128 v[168:171], v6 offset:20480
  v_mfma_f32_16x16x32_bf16 v[108:111], v[248:251], v[176:179], v[108:111]
  v_mfma_f32_16x16x32_bf16 v[112:115], a[232:235], v[180:183], v[112:115]
  ds_read_b128 v[172:175], v6 offset:22528
  s_add_u32 m0, s100, 13312
  s_add_u32 s60, s94, 13312
  v_mfma_f32_16x16x32_bf16 v[116:119], v[248:251], v[180:183], v[116:119]
  buffer_load_dwordx4 v2, s[4:7], s60 offen lds
  s_waitcnt lgkmcnt(6)
  v_mfma_f32_16x16x32_bf16 v[120:123], a[232:235], v[184:187], v[120:123]
  ds_read_b128 v[176:179], v6 offset:24576
  v_mfma_f32_16x16x32_bf16 v[124:127], v[248:251], v[184:187], v[124:127]
  v_mfma_f32_16x16x32_bf16 v[128:131], a[232:235], v[188:191], v[128:131]
  ds_read_b128 v[180:183], v6 offset:26624
  s_add_u32 m0, s100, 14336
  s_add_u32 s60, s94, 14336
  v_mfma_f32_16x16x32_bf16 v[132:135], v[248:251], v[188:191], v[132:135]
  buffer_load_dwordx4 v2, s[4:7], s60 offen lds
  s_waitcnt lgkmcnt(6)
  v_mfma_f32_16x16x32_bf16 v[136:139], a[232:235], v[152:155], v[136:139]
  ds_read_b128 v[184:187], v6 offset:28672
  v_mfma_f32_16x16x32_bf16 v[140:143], v[248:251], v[152:155], v[140:143]
  v_mfma_f32_16x16x32_bf16 v[144:147], a[232:235], v[156:159], v[144:147]
  ds_read_b128 v[188:191], v6 offset:30720
  v_mfma_f32_16x16x32_bf16 v[148:151], v[248:251], v[156:159], v[148:151]
  v_mfma_f32_16x16x32_bf16 v[70:73], a[232:235], v[82:85], v[70:73]
  v_mfma_f32_16x16x32_bf16 v[74:77], v[248:251], v[82:85], v[74:77]
  s_waitcnt lgkmcnt(6)
  v_mfma_f32_16x16x32_bf16 v[88:91], a[236:239], v[160:163], v[88:91]
  v_mfma_f32_16x16x32_bf16 v[92:95], v[252:255], v[160:163], v[92:95]
  v_mfma_f32_16x16x32_bf16 v[96:99], a[236:239], v[164:167], v[96:99]
  s_add_u32 m0, s100, 15360
  s_add_u32 s60, s94, 15360
  v_mfma_f32_16x16x32_bf16 v[100:103], v[252:255], v[164:167], v[100:103]
  buffer_load_dwordx4 v2, s[4:7], s60 offen lds
  s_waitcnt lgkmcnt(4)
  v_mfma_f32_16x16x32_bf16 v[104:107], a[236:239], v[168:171], v[104:107]
  v_mfma_f32_16x16x32_bf16 v[108:111], v[252:255], v[168:171], v[108:111]
  v_mfma_f32_16x16x32_bf16 v[112:115], a[236:239], v[172:175], v[112:115]
  s_add_u32 m0, s100, 16384
  s_add_u32 s60, s94, 16384
  v_mfma_f32_16x16x32_bf16 v[116:119], v[252:255], v[172:175], v[116:119]
  buffer_load_dwordx4 v2, s[4:7], s60 offen lds
  s_waitcnt lgkmcnt(2)
  v_mfma_f32_16x16x32_bf16 v[120:123], a[236:239], v[176:179], v[120:123]
  v_mfma_f32_16x16x32_bf16 v[124:127], v[252:255], v[176:179], v[124:127]
  v_mfma_f32_16x16x32_bf16 v[128:131], a[236:239], v[180:183], v[128:131]
  s_add_u32 m0, s100, 17408
  s_add_u32 s60, s94, 17408
  v_mfma_f32_16x16x32_bf16 v[132:135], v[252:255], v[180:183], v[132:135]
  buffer_load_dwordx4 v2, s[4:7], s60 offen lds
  s_waitcnt lgkmcnt(0)
  v_mfma_f32_16x16x32_bf16 v[136:139], a[236:239], v[184:187], v[136:139]
  v_mfma_f32_16x16x32_bf16 v[140:143], v[252:255], v[184:187], v[140:143]
  v_mfma_f32_16x16x32_bf16 v[144:147], a[236:239], v[188:191], v[144:147]
  v_mfma_f32_16x16x32_bf16 v[148:151], v[252:255], v[188:191], v[148:151]
  v_mfma_f32_16x16x32_bf16 v[70:73], a[236:239], v[82:85], v[70:73]
  v_mfma_f32_16x16x32_bf16 v[74:77], v[252:255], v[82:85], v[74:77]
  s_branch L_b_epi
L_l4:
  s_waitcnt vmcnt(10)
  s_barrier
  ds_read_b128 v[152:155], v5 offset:0
  ds_read_b128 v[156:159], v5 offset:2048
  ds_read_b128 v[160:163], v5 offset:4096
  ds_read_b128 v[164:167], v5 offset:6144
  ds_read_b128 v[168:171], v5 offset:8192
  ds_read_b128 v[172:175], v5 offset:10240
  ds_read_b128 v[176:179], v5 offset:12288
  ds_read_b128 v[180:183], v5 offset:14336
  s_waitcnt lgkmcnt(6)
  v_mfma_f32_16x16x32_bf16 v[88:91], a[160:163], v[152:155], 0
  ds_read_b128 v[184:187], v6 offset:0
  v_mfma_f32_16x16x32_bf16 v[92:95], a[240:243], v[152:155], 0
  v_mfma_f32_16x16x32_bf16 v[96:99], a[160:163], v[156:159], 0
  ds_read_b128 v[188:191], v6 offset:2048
  s_add_u32 m0, s52, 49152
  v_mfma_f32_16x16x32_bf16 v[100:103], a[240:243], v[156:159], 0
  buffer_load_dwordx4 v2, s[8:11], s46 offen sc1 lds
  buffer_load_dwordx4 v2, s[8:11], s46 offen offset:1024 sc1 lds
  s_add_u32 s46, s46, 2048
  s_waitcnt lgkmcnt(6)
  v_mfma_f32_16x16x32_bf16 v[104:107], a[160:163], v[160:163], 0
  ds_read_b128 v[152:155], v6 offset:4096
  v_mfma_f32_16x16x32_bf16 v[108:111], a[240:243], v[160:163], 0
  v_mfma_f32_16x16x32_bf16 v[112:115], a[160:163], v[164:167], 0
  ds_read_b128 v[156:159], v6 offset:6144
  s_add_u32 m0, s100, 0
  s_add_u32 s60, s94, 0
  v_mfma_f32_16x16x32_bf16 v[116:119], a[240:243], v[164:167], 0
  buffer_load_dwordx4 v2, s[4:7], s60 offen lds
  s_waitcnt lgkmcnt(6)
  v_mfma_f32_16x16x32_bf16 v[120:123], a[160:163], v[168:171], 0
  ds_read_b128 v[160:163], v6 offset:8192
  v_mfma_f32_16x16x32_bf16 v[124:127], a[240:243], v[168:171], 0
  v_mfma_f32_16x16x32_bf16 v[128:131], a[160:163], v[172:175], 0
  ds_read_b128 v[164:167], v6 offset:10240
  s_add_u32 m0, s100, 1024
  s_add_u32 s60, s94, 1024
  v_mfma_f32_16x16x32_bf16 v[132:135], a[240:243], v[172:175], 0
  buffer_load_dwordx4 v2, s[4:7], s60 offen lds
  s_waitcnt lgkmcnt(6)
  v_mfma_f32_16x16x32_bf16 v[136:139], a[160:163], v[176:179], 0
  ds_read_b128 v[168:171], v6 offset:12288
  v_mfma_f32_16x16x32_bf16 v[140:143], a[240:243], v[176:179], 0
  v_mfma_f32_16x16x32_bf16 v[144:147], a[160:163], v[180:183], 0
  ds_read_b128 v[172:175], v6 offset:14336
  v_mfma_f32_16x16x32_bf16 v[148:151], a[240:243], v[180:183], 0
  s_waitcnt vmcnt(8) lgkmcnt(0)
  s_barrier
  v_add_f32 v80, v80, v82
  v_add_f32 v84, v84, v86
  v_add_f32 v81, v81, v83
  v_add_f32 v85, v85, v87
  v_add_f32_dpp v80, v80, v80 quad_perm:[1,0,3,2] row_mask:0xf bank_mask:0xf
  v_add_f32_dpp v84, v84, v84 quad_perm:[1,0,3,2] row_mask:0xf bank_mask:0xf
  v_add_f32_dpp v81, v81, v81 quad_perm:[1,0,3,2] row_mask:0xf bank_mask:0xf
  v_add_f32_dpp v85, v85, v85 quad_perm:[1,0,3,2] row_mask:0xf bank_mask:0xf
  v_add_f32_dpp v80, v80, v80 quad_perm:[2,3,0,1] row_mask:0xf bank_mask:0xf
  v_add_f32_dpp v84, v84, v84 quad_perm:[2,3,0,1] row_mask:0xf bank_mask:0xf
  v_add_f32_dpp v81, v81, v81 quad_perm:[2,3,0,1] row_mask:0xf bank_mask:0xf
  v_add_f32_dpp v85, v85, v85 quad_perm:[2,3,0,1] row_mask:0xf bank_mask:0xf
  v_mul_f32 v80, 0x3acccccd, v80
  v_mul_f32 v84, 0x3acccccd, v84
  v_mul_f32 v81, 0x3acccccd, v81
  v_mul_f32 v85, 0x3acccccd, v85
  v_fma_f32 v81, -v80, v80, v81
  v_fma_f32 v85, -v84, v84, v85
  v_max_f32 v81, 0, v81
  v_max_f32 v85, 0, v85
  v_add_f32 v81, 0x3727c5ac, v81
  v_add_f32 v85, 0x3727c5ac, v85
  v_rsq_f32 v81, v81
  v_rsq_f32 v85, v85
  v_lshrrev_b32 v64, 2, v1
  v_lshlrev_b32 v64, 3, v64
  s_lshl_b32 s56, s24, 7
  s_add_u32 s56, s56, 162816
  v_add_u32 v82, s56, v64
  ds_write_b64 v82, v[80:81] offset:0
  v_add_u32 v86, s56, v64
  ds_write_b64 v86, v[84:85] offset:512
  v_mfma_f32_16x16x32_bf16 v[88:91], a[164:167], v[184:187], v[88:91]
  ds_read_b128 v[176:179], v5 offset:16384
  v_mfma_f32_16x16x32_bf16 v[92:95], a[244:247], v[184:187], v[92:95]
  v_mfma_f32_16x16x32_bf16 v[96:99], a[164:167], v[188:191], v[96:99]
  ds_read_b128 v[180:183], v5 offset:18432
  s_add_u32 m0, s52, 51200
  v_mfma_f32_16x16x32_bf16 v[100:103], a[244:247], v[188:191], v[100:103]
  buffer_load_dwordx4 v2, s[8:11], s48 offen sc1 lds
  buffer_load_dwordx4 v2, s[8:11], s48 offen offset:1024 sc1 lds
  s_add_u32 s48, s48, 2048
  v_mfma_f32_16x16x32_bf16 v[104:107], a[164:167], v[152:155], v[104:107]
  ds_read_b128 v[184:187], v5 offset:20480
  v_mfma_f32_16x16x32_bf16 v[108:111], a[244:247], v[152:155], v[108:111]
  v_mfma_f32_16x16x32_bf16 v[112:115], a[164:167], v[156:159], v[112:115]
  ds_read_b128 v[188:191], v5 offset:22528
  v_mfma_f32_16x16x32_bf16 v[116:119], a[244:247], v[156:159], v[116:119]
  v_mfma_f32_16x16x32_bf16 v[120:123], a[164:167], v[160:163], v[120:123]
  ds_read_b128 v[152:155], v5 offset:24576
  v_mfma_f32_16x16x32_bf16 v[124:127], a[244:247], v[160:163], v[124:127]
  v_mfma_f32_16x16x32_bf16 v[128:131], a[164:167], v[164:167], v[128:131]
  ds_read_b128 v[156:159], v5 offset:26624
  v_mfma_f32_16x16x32_bf16 v[132:135], a[244:247], v[164:167], v[132:135]
  v_mfma_f32_16x16x32_bf16 v[136:139], a[164:167], v[168:171], v[136:139]
  ds_read_b128 v[160:163], v5 offset:28672
  v_mfma_f32_16x16x32_bf16 v[140:143], a[244:247], v[168:171], v[140:143]
  v_mfma_f32_16x16x32_bf16 v[144:147], a[164:167], v[172:175], v[144:147]
  ds_read_b128 v[164:167], v5 offset:30720
  v_mfma_f32_16x16x32_bf16 v[148:151], a[244:247], v[172:175], v[148:151]
  s_waitcnt lgkmcnt(6)
  v_mfma_f32_16x16x32_bf16 v[88:91], a[168:171], v[176:179], v[88:91]
  ds_read_b128 v[168:171], v6 offset:16384
  v_mfma_f32_16x16x32_bf16 v[92:95], a[248:251], v[176:179], v[92:95]
  v_mfma_f32_16x16x32_bf16 v[96:99], a[168:171], v[180:183], v[96:99]
  ds_read_b128 v[172:175], v6 offset:18432
  s_add_u32 m0, s52, 0
  v_mfma_f32_16x16x32_bf16 v[100:103], a[248:251], v[180:183], v[100:103]
  buffer_load_dwordx4 v2, s[8:11], s46 offen sc1 lds
  buffer_load_dwordx4 v2, s[8:11], s46 offen offset:1024 sc1 lds
  s_add_u32 s46, s46, 2048
  s_waitcnt lgkmcnt(6)
  v_mfma_f32_16x16x32_bf16 v[104:107], a[168:171], v[184:187], v[104:107]
  ds_read_b128 v[176:179], v6 offset:20480
  v_mfma_f32_16x16x32_bf16 v[108:111], a[248:251], v[184:187], v[108:111]
  v_mfma_f32_16x16x32_bf16 v[112:115], a[168:171], v[188:191], v[112:115]
  ds_read_b128 v[180:183], v6 offset:22528
  s_add_u32 m0, s100, 2048
  s_add_u32 s60, s94, 2048
  v_mfma_f32_16x16x32_bf16 v[116:119], a[248:251], v[188:191], v[116:119]
  buffer_load_dwordx4 v2, s[4:7], s60 offen lds
  s_waitcnt lgkmcnt(6)
  v_mfma_f32_16x16x32_bf16 v[120:123], a[168:171], v[152:155], v[120:123]
  ds_read_b128 v[184:187], v6 offset:24576
  v_mfma_f32_16x16x32_bf16 v[124:127], a[248:251], v[152:155], v[124:127]
  v_mfma_f32_16x16x32_bf16 v[128:131], a[168:171], v[156:159], v[128:131]
  ds_read_b128 v[188:191], v6 offset:26624
  s_add_u32 m0, s100, 3072
  s_add_u32 s60, s94, 3072
  v_mfma_f32_16x16x32_bf16 v[132:135], a[248:251], v[156:159], v[132:135]
  buffer_load_dwordx4 v2, s[4:7], s60 offen lds
  s_waitcnt lgkmcnt(6)
  v_mfma_f32_16x16x32_bf16 v[136:139], a[168:171], v[160:163], v[136:139]
  ds_read_b128 v[152:155], v6 offset:28672
  v_mfma_f32_16x16x32_bf16 v[140:143], a[248:251], v[160:163], v[140:143]
  v_mfma_f32_16x16x32_bf16 v[144:147], a[168:171], v[164:167], v[144:147]
  ds_read_b128 v[156:159], v6 offset:30720
  v_mfma_f32_16x16x32_bf16 v[148:151], a[248:251], v[164:167], v[148:151]
  s_waitcnt vmcnt(10) lgkmcnt(0)
  s_barrier
  v_mfma_f32_16x16x32_bf16 v[88:91], a[172:175], v[168:171], v[88:91]
  ds_read_b128 v[160:163], v5 offset:32768
  v_mfma_f32_16x16x32_bf16 v[92:95], a[252:255], v[168:171], v[92:95]
  v_mfma_f32_16x16x32_bf16 v[96:99], a[172:175], v[172:175], v[96:99]
  ds_read_b128 v[164:167], v5 offset:34816
  s_add_u32 m0, s52, 2048
  v_mfma_f32_16x16x32_bf16 v[100:103], a[252:255], v[172:175], v[100:103]
  buffer_load_dwordx4 v2, s[8:11], s48 offen sc1 lds
  buffer_load_dwordx4 v2, s[8:11], s48 offen offset:1024 sc1 lds
  s_add_u32 s48, s48, 2048
  v_mfma_f32_16x16x32_bf16 v[104:107], a[172:175], v[176:179], v[104:107]
  ds_read_b128 v[168:171], v5 offset:36864
  v_mfma_f32_16x16x32_bf16 v[108:111], a[252:255], v[176:179], v[108:111]
  v_mfma_f32_16x16x32_bf16 v[112:115], a[172:175], v[180:183], v[112:115]
  ds_read_b128 v[172:175], v5 offset:38912
  v_mfma_f32_16x16x32_bf16 v[116:119], a[252:255], v[180:183], v[116:119]
  v_mfma_f32_16x16x32_bf16 v[120:123], a[172:175], v[184:187], v[120:123]
  ds_read_b128 v[176:179], v5 offset:40960
  v_mfma_f32_16x16x32_bf16 v[124:127], a[252:255], v[184:187], v[124:127]
  v_mfma_f32_16x16x32_bf16 v[128:131], a[172:175], v[188:191], v[128:131]
  ds_read_b128 v[180:183], v5 offset:43008
  v_mfma_f32_16x16x32_bf16 v[132:135], a[252:255], v[188:191], v[132:135]
  v_mfma_f32_16x16x32_bf16 v[136:139], a[172:175], v[152:155], v[136:139]
  ds_read_b128 v[184:187], v5 offset:45056
  v_mfma_f32_16x16x32_bf16 v[140:143], a[252:255], v[152:155], v[140:143]
  v_mfma_f32_16x16x32_bf16 v[144:147], a[172:175], v[156:159], v[144:147]
  ds_read_b128 v[188:191], v5 offset:47104
  v_mfma_f32_16x16x32_bf16 v[148:151], a[252:255], v[156:159], v[148:151]
  s_waitcnt lgkmcnt(6)
  v_mfma_f32_16x16x32_bf16 v[88:91], a[176:179], v[160:163], v[88:91]
  ds_read_b128 v[152:155], v6 offset:32768
  v_mfma_f32_16x16x32_bf16 v[92:95], v[192:195], v[160:163], v[92:95]
  v_mfma_f32_16x16x32_bf16 v[96:99], a[176:179], v[164:167], v[96:99]
  ds_read_b128 v[156:159], v6 offset:34816
  s_add_u32 m0, s52, 16384
  v_mfma_f32_16x16x32_bf16 v[100:103], v[192:195], v[164:167], v[100:103]
  buffer_load_dwordx4 v2, s[8:11], s46 offen sc1 lds
  buffer_load_dwordx4 v2, s[8:11], s46 offen offset:1024 sc1 lds
  s_add_u32 s46, s46, 2048
  s_waitcnt lgkmcnt(6)
  v_mfma_f32_16x16x32_bf16 v[104:107], a[176:179], v[168:171], v[104:107]
  ds_read_b128 v[160:163], v6 offset:36864
  v_mfma_f32_16x16x32_bf16 v[108:111], v[192:195], v[168:171], v[108:111]
  v_mfma_f32_16x16x32_bf16 v[112:115], a[176:179], v[172:175], v[112:115]
  ds_read_b128 v[164:167], v6 offset:38912
  s_add_u32 m0, s100, 4096
  s_add_u32 s60, s94, 4096
  v_mfma_f32_16x16x32_bf16 v[116:119], v[192:195], v[172:175], v[116:119]
  buffer_load_dwordx4 v2, s[4:7], s60 offen lds
  s_waitcnt lgkmcnt(6)
  v_mfma_f32_16x16x32_bf16 v[120:123], a[176:179], v[176:179], v[120:123]
  ds_read_b128 v[168:171], v6 offset:40960
  v_mfma_f32_16x16x32_bf16 v[124:127], v[192:195], v[176:179], v[124:127]
  v_mfma_f32_16x16x32_bf16 v[128:131], a[176:179], v[180:183], v[128:131]
  ds_read_b128 v[172:175], v6 offset:43008
  s_add_u32 m0, s100, 5120
  s_add_u32 s60, s94, 5120
  v_mfma_f32_16x16x32_bf16 v[132:135], v[192:195], v[180:183], v[132:135]
  buffer_load_dwordx4 v2, s[4:7], s60 offen lds
  s_waitcnt lgkmcnt(6)
  v_mfma_f32_16x16x32_bf16 v[136:139], a[176:179], v[184:187], v[136:139]
  ds_read_b128 v[176:179], v6 offset:45056
  v_mfma_f32_16x16x32_bf16 v[140:143], v[192:195], v[184:187], v[140:143]
  v_mfma_f32_16x16x32_bf16 v[144:147], a[176:179], v[188:191], v[144:147]
  ds_read_b128 v[180:183], v6 offset:47104
  v_mfma_f32_16x16x32_bf16 v[148:151], v[192:195], v[188:191], v[148:151]
  s_waitcnt vmcnt(10) lgkmcnt(0)
  s_barrier
  v_mfma_f32_16x16x32_bf16 v[88:91], a[180:183], v[152:155], v[88:91]
  ds_read_b128 v[184:187], v5 offset:49152
  v_mfma_f32_16x16x32_bf16 v[92:95], v[196:199], v[152:155], v[92:95]
  v_mfma_f32_16x16x32_bf16 v[96:99], a[180:183], v[156:159], v[96:99]
  ds_read_b128 v[188:191], v5 offset:51200
  s_add_u32 m0, s52, 18432
  v_mfma_f32_16x16x32_bf16 v[100:103], v[196:199], v[156:159], v[100:103]
  buffer_load_dwordx4 v2, s[8:11], s48 offen sc1 lds
  buffer_load_dwordx4 v2, s[8:11], s48 offen offset:1024 sc1 lds
  s_add_u32 s48, s48, 2048
  v_mfma_f32_16x16x32_bf16 v[104:107], a[180:183], v[160:163], v[104:107]
  ds_read_b128 v[152:155], v5 offset:53248
  v_mfma_f32_16x16x32_bf16 v[108:111], v[196:199], v[160:163], v[108:111]
  v_mfma_f32_16x16x32_bf16 v[112:115], a[180:183], v[164:167], v[112:115]
  ds_read_b128 v[156:159], v5 offset:55296
  v_mfma_f32_16x16x32_bf16 v[116:119], v[196:199], v[164:167], v[116:119]
  v_mfma_f32_16x16x32_bf16 v[120:123], a[180:183], v[168:171], v[120:123]
  ds_read_b128 v[160:163], v5 offset:57344
  v_mfma_f32_16x16x32_bf16 v[124:127], v[196:199], v[168:171], v[124:127]
  v_mfma_f32_16x16x32_bf16 v[128:131], a[180:183], v[172:175], v[128:131]
  ds_read_b128 v[164:167], v5 offset:59392
  v_mfma_f32_16x16x32_bf16 v[132:135], v[196:199], v[172:175], v[132:135]
  v_mfma_f32_16x16x32_bf16 v[136:139], a[180:183], v[176:179], v[136:139]
  ds_read_b128 v[168:171], v5 offset:61440
  v_mfma_f32_16x16x32_bf16 v[140:143], v[196:199], v[176:179], v[140:143]
  v_mfma_f32_16x16x32_bf16 v[144:147], a[180:183], v[180:183], v[144:147]
  ds_read_b128 v[172:175], v5 offset:63488
  v_mfma_f32_16x16x32_bf16 v[148:151], v[196:199], v[180:183], v[148:151]
  s_waitcnt lgkmcnt(6)
  v_mfma_f32_16x16x32_bf16 v[88:91], a[184:187], v[184:187], v[88:91]
  ds_read_b128 v[176:179], v6 offset:49152
  v_mfma_f32_16x16x32_bf16 v[92:95], v[200:203], v[184:187], v[92:95]
  v_mfma_f32_16x16x32_bf16 v[96:99], a[184:187], v[188:191], v[96:99]
  ds_read_b128 v[180:183], v6 offset:51200
  s_add_u32 m0, s52, 32768
  v_mfma_f32_16x16x32_bf16 v[100:103], v[200:203], v[188:191], v[100:103]
  buffer_load_dwordx4 v2, s[8:11], s46 offen sc1 lds
  buffer_load_dwordx4 v2, s[8:11], s46 offen offset:1024 sc1 lds
  s_add_u32 s46, s46, 2048
  s_waitcnt lgkmcnt(6)
  v_mfma_f32_16x16x32_bf16 v[104:107], a[184:187], v[152:155], v[104:107]
  ds_read_b128 v[184:187], v6 offset:53248
  v_mfma_f32_16x16x32_bf16 v[108:111], v[200:203], v[152:155], v[108:111]
  v_mfma_f32_16x16x32_bf16 v[112:115], a[184:187], v[156:159], v[112:115]
  ds_read_b128 v[188:191], v6 offset:55296
  s_add_u32 m0, s100, 6144
  s_add_u32 s60, s94, 6144
  v_mfma_f32_16x16x32_bf16 v[116:119], v[200:203], v[156:159], v[116:119]
  buffer_load_dwordx4 v2, s[4:7], s60 offen lds
  s_waitcnt lgkmcnt(6)
  v_mfma_f32_16x16x32_bf16 v[120:123], a[184:187], v[160:163], v[120:123]
  ds_read_b128 v[152:155], v6 offset:57344
  v_mfma_f32_16x16x32_bf16 v[124:127], v[200:203], v[160:163], v[124:127]
  v_mfma_f32_16x16x32_bf16 v[128:131], a[184:187], v[164:167], v[128:131]
  ds_read_b128 v[156:159], v6 offset:59392
  s_add_u32 m0, s100, 7168
  s_add_u32 s60, s94, 7168
  v_mfma_f32_16x16x32_bf16 v[132:135], v[200:203], v[164:167], v[132:135]
  buffer_load_dwordx4 v2, s[4:7], s60 offen lds
  s_waitcnt lgkmcnt(6)
  v_mfma_f32_16x16x32_bf16 v[136:139], a[184:187], v[168:171], v[136:139]
  ds_read_b128 v[160:163], v6 offset:61440
  v_mfma_f32_16x16x32_bf16 v[140:143], v[200:203], v[168:171], v[140:143]
  v_mfma_f32_16x16x32_bf16 v[144:147], a[184:187], v[172:175], v[144:147]
  ds_read_b128 v[164:167], v6 offset:63488
  v_mfma_f32_16x16x32_bf16 v[148:151], v[200:203], v[172:175], v[148:151]
  s_waitcnt vmcnt(10) lgkmcnt(0)
  s_barrier
  v_mfma_f32_16x16x32_bf16 v[88:91], a[188:191], v[176:179], v[88:91]
  ds_read_b128 v[168:171], v5 offset:0
  v_mfma_f32_16x16x32_bf16 v[92:95], v[204:207], v[176:179], v[92:95]
  v_mfma_f32_16x16x32_bf16 v[96:99], a[188:191], v[180:183], v[96:99]
  ds_read_b128 v[172:175], v5 offset:2048
  s_add_u32 m0, s52, 34816
  v_mfma_f32_16x16x32_bf16 v[100:103], v[204:207], v[180:183], v[100:103]
  buffer_load_dwordx4 v2, s[8:11], s48 offen sc1 lds
  buffer_load_dwordx4 v2, s[8:11], s48 offen offset:1024 sc1 lds
  s_add_u32 s48, s48, 2048
  v_mfma_f32_16x16x32_bf16 v[104:107], a[188:191], v[184:187], v[104:107]
  ds_read_b128 v[176:179], v5 offset:4096
  v_mfma_f32_16x16x32_bf16 v[108:111], v[204:207], v[184:187], v[108:111]
  v_mfma_f32_16x16x32_bf16 v[112:115], a[188:191], v[188:191], v[112:115]
  ds_read_b128 v[180:183], v5 offset:6144
  v_mfma_f32_16x16x32_bf16 v[116:119], v[204:207], v[188:191], v[116:119]
  v_mfma_f32_16x16x32_bf16 v[120:123], a[188:191], v[152:155], v[120:123]
  ds_read_b128 v[184:187], v5 offset:8192
  v_mfma_f32_16x16x32_bf16 v[124:127], v[204:207], v[152:155], v[124:127]
  v_mfma_f32_16x16x32_bf16 v[128:131], a[188:191], v[156:159], v[128:131]
  ds_read_b128 v[188:191], v5 offset:10240
  v_mfma_f32_16x16x32_bf16 v[132:135], v[204:207], v[156:159], v[132:135]
  v_mfma_f32_16x16x32_bf16 v[136:139], a[188:191], v[160:163], v[136:139]
  ds_read_b128 v[152:155], v5 offset:12288
  v_mfma_f32_16x16x32_bf16 v[140:143], v[204:207], v[160:163], v[140:143]
  v_mfma_f32_16x16x32_bf16 v[144:147], a[188:191], v[164:167], v[144:147]
  ds_read_b128 v[156:159], v5 offset:14336
  v_mfma_f32_16x16x32_bf16 v[148:151], v[204:207], v[164:167], v[148:151]
  s_waitcnt lgkmcnt(6)
  v_mfma_f32_16x16x32_bf16 v[88:91], a[192:195], v[168:171], v[88:91]
  ds_read_b128 v[160:163], v6 offset:0
  v_mfma_f32_16x16x32_bf16 v[92:95], v[208:211], v[168:171], v[92:95]
  v_mfma_f32_16x16x32_bf16 v[96:99], a[192:195], v[172:175], v[96:99]
  ds_read_b128 v[164:167], v6 offset:2048
  s_add_u32 m0, s52, 49152
  v_mfma_f32_16x16x32_bf16 v[100:103], v[208:211], v[172:175], v[100:103]
  buffer_load_dwordx4 v2, s[8:11], s46 offen sc1 lds
  buffer_load_dwordx4 v2, s[8:11], s46 offen offset:1024 sc1 lds
  s_add_u32 s46, s46, 2048
  s_waitcnt lgkmcnt(6)
  v_mfma_f32_16x16x32_bf16 v[104:107], a[192:195], v[176:179], v[104:107]
  ds_read_b128 v[168:171], v6 offset:4096
  v_mfma_f32_16x16x32_bf16 v[108:111], v[208:211], v[176:179], v[108:111]
  v_mfma_f32_16x16x32_bf16 v[112:115], a[192:195], v[180:183], v[112:115]
  ds_read_b128 v[172:175], v6 offset:6144
  s_add_u32 m0, s100, 8192
  s_add_u32 s60, s94, 8192
  v_mfma_f32_16x16x32_bf16 v[116:119], v[208:211], v[180:183], v[116:119]
  buffer_load_dwordx4 v2, s[4:7], s60 offen lds
  s_waitcnt lgkmcnt(6)
  v_mfma_f32_16x16x32_bf16 v[120:123], a[192:195], v[184:187], v[120:123]
  ds_read_b128 v[176:179], v6 offset:8192
  v_mfma_f32_16x16x32_bf16 v[124:127], v[208:211], v[184:187], v[124:127]
  v_mfma_f32_16x16x32_bf16 v[128:131], a[192:195], v[188:191], v[128:131]
  ds_read_b128 v[180:183], v6 offset:10240
  s_add_u32 m0, s100, 9216
  s_add_u32 s60, s94, 9216
  v_mfma_f32_16x16x32_bf16 v[132:135], v[208:211], v[188:191], v[132:135]
  buffer_load_dwordx4 v2, s[4:7], s60 offen lds
  s_waitcnt lgkmcnt(6)
  v_mfma_f32_16x16x32_bf16 v[136:139], a[192:195], v[152:155], v[136:139]
  ds_read_b128 v[184:187], v6 offset:12288
  v_mfma_f32_16x16x32_bf16 v[140:143], v[208:211], v[152:155], v[140:143]
  v_mfma_f32_16x16x32_bf16 v[144:147], a[192:195], v[156:159], v[144:147]
  ds_read_b128 v[188:191], v6 offset:14336
  v_mfma_f32_16x16x32_bf16 v[148:151], v[208:211], v[156:159], v[148:151]
  s_waitcnt vmcnt(10) lgkmcnt(0)
  s_barrier
  v_mfma_f32_16x16x32_bf16 v[88:91], a[196:199], v[160:163], v[88:91]
  ds_read_b128 v[152:155], v5 offset:16384
  v_mfma_f32_16x16x32_bf16 v[92:95], v[212:215], v[160:163], v[92:95]
  v_mfma_f32_16x16x32_bf16 v[96:99], a[196:199], v[164:167], v[96:99]
  ds_read_b128 v[156:159], v5 offset:18432
  s_add_u32 m0, s52, 51200
  v_mfma_f32_16x16x32_bf16 v[100:103], v[212:215], v[164:167], v[100:103]
  buffer_load_dwordx4 v2, s[8:11], s48 offen sc1 lds
  buffer_load_dwordx4 v2, s[8:11], s48 offen offset:1024 sc1 lds
  s_add_u32 s48, s48, 2048
  v_mfma_f32_16x16x32_bf16 v[104:107], a[196:199], v[168:171], v[104:107]
  ds_read_b128 v[160:163], v5 offset:20480
  v_mfma_f32_16x16x32_bf16 v[108:111], v[212:215], v[168:171], v[108:111]
  v_mfma_f32_16x16x32_bf16 v[112:115], a[196:199], v[172:175], v[112:115]
  ds_read_b128 v[164:167], v5 offset:22528
  v_mfma_f32_16x16x32_bf16 v[116:119], v[212:215], v[172:175], v[116:119]
  v_mfma_f32_16x16x32_bf16 v[120:123], a[196:199], v[176:179], v[120:123]
  ds_read_b128 v[168:171], v5 offset:24576
  v_mfma_f32_16x16x32_bf16 v[124:127], v[212:215], v[176:179], v[124:127]
  v_mfma_f32_16x16x32_bf16 v[128:131], a[196:199], v[180:183], v[128:131]
  ds_read_b128 v[172:175], v5 offset:26624
  v_mfma_f32_16x16x32_bf16 v[132:135], v[212:215], v[180:183], v[132:135]
  v_mfma_f32_16x16x32_bf16 v[136:139], a[196:199], v[184:187], v[136:139]
  ds_read_b128 v[176:179], v5 offset:28672
  v_mfma_f32_16x16x32_bf16 v[140:143], v[212:215], v[184:187], v[140:143]
  v_mfma_f32_16x16x32_bf16 v[144:147], a[196:199], v[188:191], v[144:147]
  ds_read_b128 v[180:183], v5 offset:30720
  v_mfma_f32_16x16x32_bf16 v[148:151], v[212:215], v[188:191], v[148:151]
  s_waitcnt lgkmcnt(6)
  v_mfma_f32_16x16x32_bf16 v[88:91], a[200:203], v[152:155], v[88:91]
  ds_read_b128 v[184:187], v6 offset:16384
  v_mfma_f32_16x16x32_bf16 v[92:95], v[216:219], v[152:155], v[92:95]
  v_mfma_f32_16x16x32_bf16 v[96:99], a[200:203], v[156:159], v[96:99]
  ds_read_b128 v[188:191], v6 offset:18432
  s_add_u32 m0, s52, 0
  v_mfma_f32_16x16x32_bf16 v[100:103], v[216:219], v[156:159], v[100:103]
  buffer_load_dwordx4 v2, s[8:11], s46 offen sc1 lds
  buffer_load_dwordx4 v2, s[8:11], s46 offen offset:1024 sc1 lds
  s_add_u32 s46, s46, 2048
  s_waitcnt lgkmcnt(6)
  v_mfma_f32_16x16x32_bf16 v[104:107], a[200:203], v[160:163], v[104:107]
  ds_read_b128 v[152:155], v6 offset:20480
  v_mfma_f32_16x16x32_bf16 v[108:111], v[216:219], v[160:163], v[108:111]
  v_mfma_f32_16x16x32_bf16 v[112:115], a[200:203], v[164:167], v[112:115]
  ds_read_b128 v[156:159], v6 offset:22528
  s_add_u32 m0, s100, 10240
  s_add_u32 s60, s94, 10240
  v_mfma_f32_16x16x32_bf16 v[116:119], v[216:219], v[164:167], v[116:119]
  buffer_load_dwordx4 v2, s[4:7], s60 offen lds
  s_waitcnt lgkmcnt(6)
  v_mfma_f32_16x16x32_bf16 v[120:123], a[200:203], v[168:171], v[120:123]
  ds_read_b128 v[160:163], v6 offset:24576
  v_mfma_f32_16x16x32_bf16 v[124:127], v[216:219], v[168:171], v[124:127]
  v_mfma_f32_16x16x32_bf16 v[128:131], a[200:203], v[172:175], v[128:131]
  ds_read_b128 v[164:167], v6 offset:26624
  s_add_u32 m0, s100, 11264
  s_add_u32 s60, s94, 11264
  v_mfma_f32_16x16x32_bf16 v[132:135], v[216:219], v[172:175], v[132:135]
  buffer_load_dwordx4 v2, s[4:7], s60 offen lds
  s_waitcnt lgkmcnt(6)
  v_mfma_f32_16x16x32_bf16 v[136:139], a[200:203], v[176:179], v[136:139]
  ds_read_b128 v[168:171], v6 offset:28672
  v_mfma_f32_16x16x32_bf16 v[140:143], v[216:219], v[176:179], v[140:143]
  v_mfma_f32_16x16x32_bf16 v[144:147], a[200:203], v[180:183], v[144:147]
  ds_read_b128 v[172:175], v6 offset:30720
  v_mfma_f32_16x16x32_bf16 v[148:151], v[216:219], v[180:183], v[148:151]
  s_waitcnt vmcnt(10) lgkmcnt(0)
  s_barrier
  v_mfma_f32_16x16x32_bf16 v[88:91], a[204:207], v[184:187], v[88:91]
  ds_read_b128 v[176:179], v5 offset:32768
  v_mfma_f32_16x16x32_bf16 v[92:95], v[220:223], v[184:187], v[92:95]
  v_mfma_f32_16x16x32_bf16 v[96:99], a[204:207], v[188:191], v[96:99]
  ds_read_b128 v[180:183], v5 offset:34816
  s_add_u32 m0, s52, 2048
  v_mfma_f32_16x16x32_bf16 v[100:103], v[220:223], v[188:191], v[100:103]
  buffer_load_dwordx4 v2, s[8:11], s48 offen sc1 lds
  buffer_load_dwordx4 v2, s[8:11], s48 offen offset:1024 sc1 lds
  s_add_u32 s48, s48, 2048
  v_mfma_f32_16x16x32_bf16 v[104:107], a[204:207], v[152:155], v[104:107]
  ds_read_b128 v[184:187], v5 offset:36864
  v_mfma_f32_16x16x32_bf16 v[108:111], v[220:223], v[152:155], v[108:111]
  v_mfma_f32_16x16x32_bf16 v[112:115], a[204:207], v[156:159], v[112:115]
  ds_read_b128 v[188:191], v5 offset:38912
  v_mfma_f32_16x16x32_bf16 v[116:119], v[220:223], v[156:159], v[116:119]
  v_mfma_f32_16x16x32_bf16 v[120:123], a[204:207], v[160:163], v[120:123]
  ds_read_b128 v[152:155], v5 offset:40960
  v_mfma_f32_16x16x32_bf16 v[124:127], v[220:223], v[160:163], v[124:127]
  v_mfma_f32_16x16x32_bf16 v[128:131], a[204:207], v[164:167], v[128:131]
  ds_read_b128 v[156:159], v5 offset:43008
  v_mfma_f32_16x16x32_bf16 v[132:135], v[220:223], v[164:167], v[132:135]
  v_mfma_f32_16x16x32_bf16 v[136:139], a[204:207], v[168:171], v[136:139]
  ds_read_b128 v[160:163], v5 offset:45056
  v_mfma_f32_16x16x32_bf16 v[140:143], v[220:223], v[168:171], v[140:143]
  v_mfma_f32_16x16x32_bf16 v[144:147], a[204:207], v[172:175], v[144:147]
  ds_read_b128 v[164:167], v5 offset:47104
  v_mfma_f32_16x16x32_bf16 v[148:151], v[220:223], v[172:175], v[148:151]
  s_waitcnt lgkmcnt(6)
  v_mfma_f32_16x16x32_bf16 v[88:91], a[208:211], v[176:179], v[88:91]
  ds_read_b128 v[168:171], v6 offset:32768
  v_mfma_f32_16x16x32_bf16 v[92:95], v[224:227], v[176:179], v[92:95]
  v_mfma_f32_16x16x32_bf16 v[96:99], a[208:211], v[180:183], v[96:99]
  ds_read_b128 v[172:175], v6 offset:34816
  s_add_u32 m0, s52, 16384
  v_mfma_f32_16x16x32_bf16 v[100:103], v[224:227], v[180:183], v[100:103]
  buffer_load_dwordx4 v2, s[8:11], s46 offen sc1 lds
  buffer_load_dwordx4 v2, s[8:11], s46 offen offset:1024 sc1 lds
  s_add_u32 s46, s46, 2048
  s_waitcnt lgkmcnt(6)
  v_mfma_f32_16x16x32_bf16 v[104:107], a[208:211], v[184:187], v[104:107]
  ds_read_b128 v[176:179], v6 offset:36864
  v_mfma_f32_16x16x32_bf16 v[108:111], v[224:227], v[184:187], v[108:111]
  v_mfma_f32_16x16x32_bf16 v[112:115], a[208:211], v[188:191], v[112:115]
  ds_read_b128 v[180:183], v6 offset:38912
  s_add_u32 m0, s100, 12288
  s_add_u32 s60, s94, 12288
  v_mfma_f32_16x16x32_bf16 v[116:119], v[224:227], v[188:191], v[116:119]
  buffer_load_dwordx4 v2, s[4:7], s60 offen lds
  s_waitcnt lgkmcnt(6)
  v_mfma_f32_16x16x32_bf16 v[120:123], a[208:211], v[152:155], v[120:123]
  ds_read_b128 v[184:187], v6 offset:40960
  v_mfma_f32_16x16x32_bf16 v[124:127], v[224:227], v[152:155], v[124:127]
  v_mfma_f32_16x16x32_bf16 v[128:131], a[208:211], v[156:159], v[128:131]
  ds_read_b128 v[188:191], v6 offset:43008
  s_add_u32 m0, s100, 13312
  s_add_u32 s60, s94, 13312
  v_mfma_f32_16x16x32_bf16 v[132:135], v[224:227], v[156:159], v[132:135]
  buffer_load_dwordx4 v2, s[4:7], s60 offen lds
  s_waitcnt lgkmcnt(6)
  v_mfma_f32_16x16x32_bf16 v[136:139], a[208:211], v[160:163], v[136:139]
  ds_read_b128 v[152:155], v6 offset:45056
  v_mfma_f32_16x16x32_bf16 v[140:143], v[224:227], v[160:163], v[140:143]
  v_mfma_f32_16x16x32_bf16 v[144:147], a[208:211], v[164:167], v[144:147]
  ds_read_b128 v[156:159], v6 offset:47104
  v_mfma_f32_16x16x32_bf16 v[148:151], v[224:227], v[164:167], v[148:151]
  s_waitcnt vmcnt(10) lgkmcnt(0)
  s_barrier
  v_mfma_f32_16x16x32_bf16 v[88:91], a[212:215], v[168:171], v[88:91]
  ds_read_b128 v[160:163], v5 offset:49152
  v_mfma_f32_16x16x32_bf16 v[92:95], v[228:231], v[168:171], v[92:95]
  v_mfma_f32_16x16x32_bf16 v[96:99], a[212:215], v[172:175], v[96:99]
  ds_read_b128 v[164:167], v5 offset:51200
  s_add_u32 m0, s52, 18432
  v_mfma_f32_16x16x32_bf16 v[100:103], v[228:231], v[172:175], v[100:103]
  buffer_load_dwordx4 v2, s[8:11], s48 offen sc1 lds
  buffer_load_dwordx4 v2, s[8:11], s48 offen offset:1024 sc1 lds
  s_add_u32 s48, s48, 2048
  v_mfma_f32_16x16x32_bf16 v[104:107], a[212:215], v[176:179], v[104:107]
  ds_read_b128 v[168:171], v5 offset:53248
  v_mfma_f32_16x16x32_bf16 v[108:111], v[228:231], v[176:179], v[108:111]
  v_mfma_f32_16x16x32_bf16 v[112:115], a[212:215], v[180:183], v[112:115]
  ds_read_b128 v[172:175], v5 offset:55296
  v_mfma_f32_16x16x32_bf16 v[116:119], v[228:231], v[180:183], v[116:119]
  v_mfma_f32_16x16x32_bf16 v[120:123], a[212:215], v[184:187], v[120:123]
  ds_read_b128 v[176:179], v5 offset:57344
  v_mfma_f32_16x16x32_bf16 v[124:127], v[228:231], v[184:187], v[124:127]
  v_mfma_f32_16x16x32_bf16 v[128:131], a[212:215], v[188:191], v[128:131]
  ds_read_b128 v[180:183], v5 offset:59392
  v_mfma_f32_16x16x32_bf16 v[132:135], v[228:231], v[188:191], v[132:135]
  v_mfma_f32_16x16x32_bf16 v[136:139], a[212:215], v[152:155], v[136:139]
  ds_read_b128 v[184:187], v5 offset:61440
  v_mfma_f32_16x16x32_bf16 v[140:143], v[228:231], v[152:155], v[140:143]
  v_mfma_f32_16x16x32_bf16 v[144:147], a[212:215], v[156:159], v[144:147]
  ds_read_b128 v[188:191], v5 offset:63488
  v_mfma_f32_16x16x32_bf16 v[148:151], v[228:231], v[156:159], v[148:151]
  s_waitcnt lgkmcnt(6)
  v_mfma_f32_16x16x32_bf16 v[88:91], a[216:219], v[160:163], v[88:91]
  ds_read_b128 v[152:155], v6 offset:49152
  v_mfma_f32_16x16x32_bf16 v[92:95], v[232:235], v[160:163], v[92:95]
  v_mfma_f32_16x16x32_bf16 v[96:99], a[216:219], v[164:167], v[96:99]
  ds_read_b128 v[156:159], v6 offset:51200
  s_add_u32 m0, s100, 14336
  s_add_u32 s60, s94, 14336
  v_mfma_f32_16x16x32_bf16 v[100:103], v[232:235], v[164:167], v[100:103]
  buffer_load_dwordx4 v2, s[4:7], s60 offen lds
  s_waitcnt lgkmcnt(6)
  v_mfma_f32_16x16x32_bf16 v[104:107], a[216:219], v[168:171], v[104:107]
  ds_read_b128 v[160:163], v6 offset:53248
  v_mfma_f32_16x16x32_bf16 v[108:111], v[232:235], v[168:171], v[108:111]
  v_mfma_f32_16x16x32_bf16 v[112:115], a[216:219], v[172:175], v[112:115]
  ds_read_b128 v[164:167], v6 offset:55296
  s_add_u32 m0, s100, 15360
  s_add_u32 s60, s94, 15360
  v_mfma_f32_16x16x32_bf16 v[116:119], v[232:235], v[172:175], v[116:119]
  buffer_load_dwordx4 v2, s[4:7], s60 offen lds
  s_waitcnt lgkmcnt(6)
  v_mfma_f32_16x16x32_bf16 v[120:123], a[216:219], v[176:179], v[120:123]
  ds_read_b128 v[168:171], v6 offset:57344
  v_mfma_f32_16x16x32_bf16 v[124:127], v[232:235], v[176:179], v[124:127]
  v_mfma_f32_16x16x32_bf16 v[128:131], a[216:219], v[180:183], v[128:131]
  ds_read_b128 v[172:175], v6 offset:59392
  v_mfma_f32_16x16x32_bf16 v[132:135], v[232:235], v[180:183], v[132:135]
  s_waitcnt lgkmcnt(6)
  v_mfma_f32_16x16x32_bf16 v[136:139], a[216:219], v[184:187], v[136:139]
  ds_read_b128 v[176:179], v6 offset:61440
  v_mfma_f32_16x16x32_bf16 v[140:143], v[232:235], v[184:187], v[140:143]
  v_mfma_f32_16x16x32_bf16 v[144:147], a[216:219], v[188:191], v[144:147]
  ds_read_b128 v[180:183], v6 offset:63488
  v_mfma_f32_16x16x32_bf16 v[148:151], v[232:235], v[188:191], v[148:151]
  s_waitcnt vmcnt(8) lgkmcnt(0)
  s_barrier
  v_mfma_f32_16x16x32_bf16 v[88:91], a[220:223], v[152:155], v[88:91]
  ds_read_b128 v[184:187], v5 offset:0
  v_mfma_f32_16x16x32_bf16 v[92:95], v[236:239], v[152:155], v[92:95]
  v_mfma_f32_16x16x32_bf16 v[96:99], a[220:223], v[156:159], v[96:99]
  ds_read_b128 v[188:191], v5 offset:2048
  v_mfma_f32_16x16x32_bf16 v[100:103], v[236:239], v[156:159], v[100:103]
  v_mfma_f32_16x16x32_bf16 v[104:107], a[220:223], v[160:163], v[104:107]
  ds_read_b128 v[152:155], v5 offset:4096
  v_mfma_f32_16x16x32_bf16 v[108:111], v[236:239], v[160:163], v[108:111]
  v_mfma_f32_16x16x32_bf16 v[112:115], a[220:223], v[164:167], v[112:115]
  ds_read_b128 v[156:159], v5 offset:6144
  v_mfma_f32_16x16x32_bf16 v[116:119], v[236:239], v[164:167], v[116:119]
  v_mfma_f32_16x16x32_bf16 v[120:123], a[220:223], v[168:171], v[120:123]
  ds_read_b128 v[160:163], v5 offset:8192
  v_mfma_f32_16x16x32_bf16 v[124:127], v[236:239], v[168:171], v[124:127]
  v_mfma_f32_16x16x32_bf16 v[128:131], a[220:223], v[172:175], v[128:131]
  ds_read_b128 v[164:167], v5 offset:10240
  v_mfma_f32_16x16x32_bf16 v[132:135], v[236:239], v[172:175], v[132:135]
  v_mfma_f32_16x16x32_bf16 v[136:139], a[220:223], v[176:179], v[136:139]
  ds_read_b128 v[168:171], v5 offset:12288
  v_mfma_f32_16x16x32_bf16 v[140:143], v[236:239], v[176:179], v[140:143]
  v_mfma_f32_16x16x32_bf16 v[144:147], a[220:223], v[180:183], v[144:147]
  ds_read_b128 v[172:175], v5 offset:14336
  v_mfma_f32_16x16x32_bf16 v[148:151], v[236:239], v[180:183], v[148:151]
  s_waitcnt lgkmcnt(6)
  v_mfma_f32_16x16x32_bf16 v[88:91], a[224:227], v[184:187], v[88:91]
  ds_read_b128 v[176:179], v6 offset:0
  v_mfma_f32_16x16x32_bf16 v[92:95], v[240:243], v[184:187], v[92:95]
  v_mfma_f32_16x16x32_bf16 v[96:99], a[224:227], v[188:191], v[96:99]
  ds_read_b128 v[180:183], v6 offset:2048
  s_add_u32 m0, s100, 16384
  s_add_u32 s60, s94, 16384
  v_mfma_f32_16x16x32_bf16 v[100:103], v[240:243], v[188:191], v[100:103]
  buffer_load_dwordx4 v2, s[4:7], s60 offen lds
  s_waitcnt lgkmcnt(6)
  v_mfma_f32_16x16x32_bf16 v[104:107], a[224:227], v[152:155], v[104:107]
  ds_read_b128 v[184:187], v6 offset:4096
  v_mfma_f32_16x16x32_bf16 v[108:111], v[240:243], v[152:155], v[108:111]
  v_mfma_f32_16x16x32_bf16 v[112:115], a[224:227], v[156:159], v[112:115]
  ds_read_b128 v[188:191], v6 offset:6144
  s_add_u32 m0, s100, 17408
  s_add_u32 s60, s94, 17408
  v_mfma_f32_16x16x32_bf16 v[116:119], v[240:243], v[156:159], v[116:119]
  buffer_load_dwordx4 v2, s[4:7], s60 offen lds
  s_waitcnt lgkmcnt(6)
  v_mfma_f32_16x16x32_bf16 v[120:123], a[224:227], v[160:163], v[120:123]
  ds_read_b128 v[152:155], v6 offset:8192
  v_mfma_f32_16x16x32_bf16 v[124:127], v[240:243], v[160:163], v[124:127]
  v_mfma_f32_16x16x32_bf16 v[128:131], a[224:227], v[164:167], v[128:131]
  ds_read_b128 v[156:159], v6 offset:10240
  v_mfma_f32_16x16x32_bf16 v[132:135], v[240:243], v[164:167], v[132:135]
  s_waitcnt lgkmcnt(6)
  v_mfma_f32_16x16x32_bf16 v[136:139], a[224:227], v[168:171], v[136:139]
  ds_read_b128 v[160:163], v6 offset:12288
  v_mfma_f32_16x16x32_bf16 v[140:143], v[240:243], v[168:171], v[140:143]
  v_mfma_f32_16x16x32_bf16 v[144:147], a[224:227], v[172:175], v[144:147]
  ds_read_b128 v[164:167], v6 offset:14336
  v_mfma_f32_16x16x32_bf16 v[148:151], v[240:243], v[172:175], v[148:151]
  s_waitcnt vmcnt(4) lgkmcnt(0)
  s_barrier
  v_mfma_f32_16x16x32_bf16 v[88:91], a[228:231], v[176:179], v[88:91]
  ds_read_b128 v[168:171], v5 offset:16384
  v_mfma_f32_16x16x32_bf16 v[92:95], v[244:247], v[176:179], v[92:95]
  v_mfma_f32_16x16x32_bf16 v[96:99], a[228:231], v[180:183], v[96:99]
  ds_read_b128 v[172:175], v5 offset:18432
  v_mfma_f32_16x16x32_bf16 v[100:103], v[244:247], v[180:183], v[100:103]
  v_mfma_f32_16x16x32_bf16 v[104:107], a[228:231], v[184:187], v[104:107]
  ds_read_b128 v[176:179], v5 offset:20480
  v_mfma_f32_16x16x32_bf16 v[108:111], v[244:247], v[184:187], v[108:111]
  v_mfma_f32_16x16x32_bf16 v[112:115], a[228:231], v[188:191], v[112:115]
  ds_read_b128 v[180:183], v5 offset:22528
  v_mfma_f32_16x16x32_bf16 v[116:119], v[244:247], v[188:191], v[116:119]
  v_mfma_f32_16x16x32_bf16 v[120:123], a[228:231], v[152:155], v[120:123]
  ds_read_b128 v[184:187], v5 offset:24576
  v_mfma_f32_16x16x32_bf16 v[124:127], v[244:247], v[152:155], v[124:127]
  v_mfma_f32_16x16x32_bf16 v[128:131], a[228:231], v[156:159], v[128:131]
  ds_read_b128 v[188:191], v5 offset:26624
  v_mfma_f32_16x16x32_bf16 v[132:135], v[244:247], v[156:159], v[132:135]
  v_mfma_f32_16x16x32_bf16 v[136:139], a[228:231], v[160:163], v[136:139]
  ds_read_b128 v[152:155], v5 offset:28672
  v_mfma_f32_16x16x32_bf16 v[140:143], v[244:247], v[160:163], v[140:143]
  v_mfma_f32_16x16x32_bf16 v[144:147], a[228:231], v[164:167], v[144:147]
  ds_read_b128 v[156:159], v5 offset:30720
  v_mfma_f32_16x16x32_bf16 v[148:151], v[244:247], v[164:167], v[148:151]
  s_waitcnt lgkmcnt(6)
  v_mfma_f32_16x16x32_bf16 v[88:91], a[232:235], v[168:171], v[88:91]
  ds_read_b128 v[160:163], v6 offset:16384
  v_mfma_f32_16x16x32_bf16 v[92:95], v[248:251], v[168:171], v[92:95]
  v_mfma_f32_16x16x32_bf16 v[96:99], a[232:235], v[172:175], v[96:99]
  ds_read_b128 v[164:167], v6 offset:18432
  v_mfma_f32_16x16x32_bf16 v[100:103], v[248:251], v[172:175], v[100:103]
  s_waitcnt lgkmcnt(6)
  v_mfma_f32_16x16x32_bf16 v[104:107], a[232:235], v[176:179], v[104:107]
  ds_read_b128 v[168:171], v6 offset:20480
  v_mfma_f32_16x16x32_bf16 v[108:111], v[248:251], v[176:179], v[108:111]
  v_mfma_f32_16x16x32_bf16 v[112:115], a[232:235], v[180:183], v[112:115]
  ds_read_b128 v[172:175], v6 offset:22528
  v_mfma_f32_16x16x32_bf16 v[116:119], v[248:251], v[180:183], v[116:119]
  s_waitcnt lgkmcnt(6)
  v_mfma_f32_16x16x32_bf16 v[120:123], a[232:235], v[184:187], v[120:123]
  ds_read_b128 v[176:179], v6 offset:24576
  v_mfma_f32_16x16x32_bf16 v[124:127], v[248:251], v[184:187], v[124:127]
  v_mfma_f32_16x16x32_bf16 v[128:131], a[232:235], v[188:191], v[128:131]
  ds_read_b128 v[180:183], v6 offset:26624
  v_mfma_f32_16x16x32_bf16 v[132:135], v[248:251], v[188:191], v[132:135]
  s_waitcnt lgkmcnt(6)
  v_mfma_f32_16x16x32_bf16 v[136:139], a[232:235], v[152:155], v[136:139]
  ds_read_b128 v[184:187], v6 offset:28672
  v_mfma_f32_16x16x32_bf16 v[140:143], v[248:251], v[152:155], v[140:143]
  v_mfma_f32_16x16x32_bf16 v[144:147], a[232:235], v[156:159], v[144:147]
  ds_read_b128 v[188:191], v6 offset:30720
  v_mfma_f32_16x16x32_bf16 v[148:151], v[248:251], v[156:159], v[148:151]
  s_waitcnt lgkmcnt(6)
  v_mfma_f32_16x16x32_bf16 v[88:91], a[236:239], v[160:163], v[88:91]
  v_mfma_f32_16x16x32_bf16 v[92:95], v[252:255], v[160:163], v[92:95]
  v_mfma_f32_16x16x32_bf16 v[96:99], a[236:239], v[164:167], v[96:99]
  v_mfma_f32_16x16x32_bf16 v[100:103], v[252:255], v[164:167], v[100:103]
  s_waitcnt lgkmcnt(4)
  v_mfma_f32_16x16x32_bf16 v[104:107], a[236:239], v[168:171], v[104:107]
  v_mfma_f32_16x16x32_bf16 v[108:111], v[252:255], v[168:171], v[108:111]
  v_mfma_f32_16x16x32_bf16 v[112:115], a[236:239], v[172:175], v[112:115]
  v_mfma_f32_16x16x32_bf16 v[116:119], v[252:255], v[172:175], v[116:119]
  s_waitcnt lgkmcnt(2)
  v_mfma_f32_16x16x32_bf16 v[120:123], a[236:239], v[176:179], v[120:123]
  v_mfma_f32_16x16x32_bf16 v[124:127], v[252:255], v[176:179], v[124:127]
  v_mfma_f32_16x16x32_bf16 v[128:131], a[236:239], v[180:183], v[128:131]
  v_mfma_f32_16x16x32_bf16 v[132:135], v[252:255], v[180:183], v[132:135]
  s_waitcnt lgkmcnt(0)
  v_mfma_f32_16x16x32_bf16 v[136:139], a[236:239], v[184:187], v[136:139]
  v_mfma_f32_16x16x32_bf16 v[140:143], v[252:255], v[184:187], v[140:143]
  v_mfma_f32_16x16x32_bf16 v[144:147], a[236:239], v[188:191], v[144:147]
  v_mfma_f32_16x16x32_bf16 v[148:151], v[252:255], v[188:191], v[148:151]
L_b_epi:
  ds_read_b64 v[162:163], v59 offset:128
  ds_read_b64 v[164:165], v59 offset:256
  ds_read_b64 v[166:167], v59 offset:384
  ds_read_b64 v[168:169], v59 offset:512
  ds_read_b64 v[170:171], v59 offset:640
  ds_read_b64 v[172:173], v59 offset:768
  ds_read_b64 v[174:175], v59 offset:896
  ds_read_b64 v[176:177], v59 offset:1024
  s_waitcnt lgkmcnt(0)
  v_mul_f32 v180, v163, v10
  v_mul_f32 v182, v163, v11
  v_mul_f32 v184, v165, v10
  v_mul_f32 v186, v165, v11
  v_pk_fma_f32 v[88:89], v[70:71], v[162:163], v[88:89] op_sel:[0,0,0] op_sel_hi:[1,0,1] neg_lo:[0,1,0] neg_hi:[0,1,0]
  v_pk_fma_f32 v[92:93], v[74:75], v[162:163], v[92:93] op_sel:[0,0,0] op_sel_hi:[1,0,1] neg_lo:[0,1,0] neg_hi:[0,1,0]
  v_pk_fma_f32 v[96:97], v[70:71], v[164:165], v[96:97] op_sel:[0,0,0] op_sel_hi:[1,0,1] neg_lo:[0,1,0] neg_hi:[0,1,0]
  v_pk_fma_f32 v[100:101], v[74:75], v[164:165], v[100:101] op_sel:[0,0,0] op_sel_hi:[1,0,1] neg_lo:[0,1,0] neg_hi:[0,1,0]
  v_pk_fma_f32 v[90:91], v[72:73], v[162:163], v[90:91] op_sel:[0,0,0] op_sel_hi:[1,0,1] neg_lo:[0,1,0] neg_hi:[0,1,0]
  v_pk_fma_f32 v[94:95], v[76:77], v[162:163], v[94:95] op_sel:[0,0,0] op_sel_hi:[1,0,1] neg_lo:[0,1,0] neg_hi:[0,1,0]
  v_pk_fma_f32 v[98:99], v[72:73], v[164:165], v[98:99] op_sel:[0,0,0] op_sel_hi:[1,0,1] neg_lo:[0,1,0] neg_hi:[0,1,0]
  v_pk_fma_f32 v[102:103], v[76:77], v[164:165], v[102:103] op_sel:[0,0,0] op_sel_hi:[1,0,1] neg_lo:[0,1,0] neg_hi:[0,1,0]
  v_pk_mul_f32 v[88:89], v[88:89], v[180:181] op_sel:[0,0] op_sel_hi:[1,0]
  v_pk_fma_f32 v[92:93], v[92:93], v[182:183], v[12:13] op_sel:[0,0,0] op_sel_hi:[1,0,1]
  v_pk_mul_f32 v[96:97], v[96:97], v[184:185] op_sel:[0,0] op_sel_hi:[1,0]
  v_pk_fma_f32 v[100:101], v[100:101], v[186:187], v[12:13] op_sel:[0,0,0] op_sel_hi:[1,0,1]
  v_pk_mul_f32 v[90:91], v[90:91], v[180:181] op_sel:[0,0] op_sel_hi:[1,0]
  v_pk_mul_f32 v[94:95], v[94:95], v[182:183] op_sel:[0,0] op_sel_hi:[1,0]
  v_pk_mul_f32 v[98:99], v[98:99], v[184:185] op_sel:[0,0] op_sel_hi:[1,0]
  v_pk_mul_f32 v[102:103], v[102:103], v[186:187] op_sel:[0,0] op_sel_hi:[1,0]
  v_cvt_pk_bf16_f32 v88, v88, v89
  v_cvt_pk_bf16_f32 v92, v92, v93
  v_cvt_pk_bf16_f32 v96, v96, v97
  v_cvt_pk_bf16_f32 v100, v100, v101
  v_cvt_pk_bf16_f32 v89, v90, v91
  v_cvt_pk_bf16_f32 v93, v94, v95
  v_cvt_pk_bf16_f32 v97, v98, v99
  v_cvt_pk_bf16_f32 v101, v102, v103
  v_mul_f32 v180, v167, v10
  v_mul_f32 v182, v167, v11
  v_mul_f32 v184, v169, v10
  v_mul_f32 v186, v169, v11
  v_pk_fma_f32 v[104:105], v[70:71], v[166:167], v[104:105] op_sel:[0,0,0] op_sel_hi:[1,0,1] neg_lo:[0,1,0] neg_hi:[0,1,0]
  v_pk_fma_f32 v[108:109], v[74:75], v[166:167], v[108:109] op_sel:[0,0,0] op_sel_hi:[1,0,1] neg_lo:[0,1,0] neg_hi:[0,1,0]
  v_pk_fma_f32 v[112:113], v[70:71], v[168:169], v[112:113] op_sel:[0,0,0] op_sel_hi:[1,0,1] neg_lo:[0,1,0] neg_hi:[0,1,0]
  v_pk_fma_f32 v[116:117], v[74:75], v[168:169], v[116:117] op_sel:[0,0,0] op_sel_hi:[1,0,1] neg_lo:[0,1,0] neg_hi:[0,1,0]
  v_pk_fma_f32 v[106:107], v[72:73], v[166:167], v[106:107] op_sel:[0,0,0] op_sel_hi:[1,0,1] neg_lo:[0,1,0] neg_hi:[0,1,0]
  v_pk_fma_f32 v[110:111], v[76:77], v[166:167], v[110:111] op_sel:[0,0,0] op_sel_hi:[1,0,1] neg_lo:[0,1,0] neg_hi:[0,1,0]
  v_pk_fma_f32 v[114:115], v[72:73], v[168:169], v[114:115] op_sel:[0,0,0] op_sel_hi:[1,0,1] neg_lo:[0,1,0] neg_hi:[0,1,0]
  v_pk_fma_f32 v[118:119], v[76:77], v[168:169], v[118:119] op_sel:[0,0,0] op_sel_hi:[1,0,1] neg_lo:[0,1,0] neg_hi:[0,1,0]
  v_pk_mul_f32 v[104:105], v[104:105], v[180:181] op_sel:[0,0] op_sel_hi:[1,0]
  v_pk_fma_f32 v[108:109], v[108:109], v[182:183], v[12:13] op_sel:[0,0,0] op_sel_hi:[1,0,1]
  v_pk_mul_f32 v[112:113], v[112:113], v[184:185] op_sel:[0,0] op_sel_hi:[1,0]
  v_pk_fma_f32 v[116:117], v[116:117], v[186:187], v[12:13] op_sel:[0,0,0] op_sel_hi:[1,0,1]
  v_pk_mul_f32 v[106:107], v[106:107], v[180:181] op_sel:[0,0] op_sel_hi:[1,0]
  v_pk_mul_f32 v[110:111], v[110:111], v[182:183] op_sel:[0,0] op_sel_hi:[1,0]
  v_pk_mul_f32 v[114:115], v[114:115], v[184:185] op_sel:[0,0] op_sel_hi:[1,0]
  v_pk_mul_f32 v[118:119], v[118:119], v[186:187] op_sel:[0,0] op_sel_hi:[1,0]
  v_cvt_pk_bf16_f32 v104, v104, v105
  v_cvt_pk_bf16_f32 v108, v108, v109
  v_cvt_pk_bf16_f32 v112, v112, v113
  v_cvt_pk_bf16_f32 v116, v116, v117
  v_cvt_pk_bf16_f32 v105, v106, v107
  v_cvt_pk_bf16_f32 v109, v110, v111
  v_cvt_pk_bf16_f32 v113, v114, v115
  v_cvt_pk_bf16_f32 v117, v118, v119
  s_barrier
  v_mul_f32 v180, v171, v10
  v_mul_f32 v182, v171, v11
  v_mul_f32 v184, v173, v10
  v_mul_f32 v186, v173, v11
  v_pk_fma_f32 v[120:121], v[70:71], v[170:171], v[120:121] op_sel:[0,0,0] op_sel_hi:[1,0,1] neg_lo:[0,1,0] neg_hi:[0,1,0]
  v_pk_fma_f32 v[124:125], v[74:75], v[170:171], v[124:125] op_sel:[0,0,0] op_sel_hi:[1,0,1] neg_lo:[0,1,0] neg_hi:[0,1,0]
  ds_write_b64 v8, v[88:89] offset:768
  v_pk_fma_f32 v[128:129], v[70:71], v[172:173], v[128:129] op_sel:[0,0,0] op_sel_hi:[1,0,1] neg_lo:[0,1,0] neg_hi:[0,1,0]
  v_pk_fma_f32 v[132:133], v[74:75], v[172:173], v[132:133] op_sel:[0,0,0] op_sel_hi:[1,0,1] neg_lo:[0,1,0] neg_hi:[0,1,0]
  v_pk_fma_f32 v[122:123], v[72:73], v[170:171], v[122:123] op_sel:[0,0,0] op_sel_hi:[1,0,1] neg_lo:[0,1,0] neg_hi:[0,1,0]
  v_pk_fma_f32 v[126:127], v[76:77], v[170:171], v[126:127] op_sel:[0,0,0] op_sel_hi:[1,0,1] neg_lo:[0,1,0] neg_hi:[0,1,0]
  v_pk_fma_f32 v[130:131], v[72:73], v[172:173], v[130:131] op_sel:[0,0,0] op_sel_hi:[1,0,1] neg_lo:[0,1,0] neg_hi:[0,1,0]
  v_pk_fma_f32 v[134:135], v[76:77], v[172:173], v[134:135] op_sel:[0,0,0] op_sel_hi:[1,0,1] neg_lo:[0,1,0] neg_hi:[0,1,0]
  ds_write_b64 v9, v[92:93] offset:768
  v_pk_mul_f32 v[120:121], v[120:121], v[180:181] op_sel:[0,0] op_sel_hi:[1,0]
  v_pk_fma_f32 v[124:125], v[124:125], v[182:183], v[12:13] op_sel:[0,0,0] op_sel_hi:[1,0,1]
  v_pk_mul_f32 v[128:129], v[128:129], v[184:185] op_sel:[0,0] op_sel_hi:[1,0]
  v_pk_fma_f32 v[132:133], v[132:133], v[186:187], v[12:13] op_sel:[0,0,0] op_sel_hi:[1,0,1]
  v_pk_mul_f32 v[122:123], v[122:123], v[180:181] op_sel:[0,0] op_sel_hi:[1,0]
  v_pk_mul_f32 v[126:127], v[126:127], v[182:183] op_sel:[0,0] op_sel_hi:[1,0]
  ds_write_b64 v8, v[96:97] offset:1536
  v_pk_mul_f32 v[130:131], v[130:131], v[184:185] op_sel:[0,0] op_sel_hi:[1,0]
  v_pk_mul_f32 v[134:135], v[134:135], v[186:187] op_sel:[0,0] op_sel_hi:[1,0]
  v_cvt_pk_bf16_f32 v120, v120, v121
  v_cvt_pk_bf16_f32 v124, v124, v125
  v_cvt_pk_bf16_f32 v128, v128, v129
  v_cvt_pk_bf16_f32 v132, v132, v133
  ds_write_b64 v9, v[100:101] offset:1536
  v_cvt_pk_bf16_f32 v121, v122, v123
  v_cvt_pk_bf16_f32 v125, v126, v127
  v_cvt_pk_bf16_f32 v129, v130, v131
  v_cvt_pk_bf16_f32 v133, v134, v135
  v_mul_f32 v180, v175, v10
  v_mul_f32 v182, v175, v11
  ds_write_b64 v8, v[104:105] offset:2304
  v_mul_f32 v184, v177, v10
  v_mul_f32 v186, v177, v11
  v_pk_fma_f32 v[136:137], v[70:71], v[174:175], v[136:137] op_sel:[0,0,0] op_sel_hi:[1,0,1] neg_lo:[0,1,0] neg_hi:[0,1,0]
  v_pk_fma_f32 v[140:141], v[74:75], v[174:175], v[140:141] op_sel:[0,0,0] op_sel_hi:[1,0,1] neg_lo:[0,1,0] neg_hi:[0,1,0]
  v_pk_fma_f32 v[144:145], v[70:71], v[176:177], v[144:145] op_sel:[0,0,0] op_sel_hi:[1,0,1] neg_lo:[0,1,0] neg_hi:[0,1,0]
  v_pk_fma_f32 v[148:149], v[74:75], v[176:177], v[148:149] op_sel:[0,0,0] op_sel_hi:[1,0,1] neg_lo:[0,1,0] neg_hi:[0,1,0]
  ds_write_b64 v9, v[108:109] offset:2304
  v_pk_fma_f32 v[138:139], v[72:73], v[174:175], v[138:139] op_sel:[0,0,0] op_sel_hi:[1,0,1] neg_lo:[0,1,0] neg_hi:[0,1,0]
  v_pk_fma_f32 v[142:143], v[76:77], v[174:175], v[142:143] op_sel:[0,0,0] op_sel_hi:[1,0,1] neg_lo:[0,1,0] neg_hi:[0,1,0]
  v_pk_fma_f32 v[146:147], v[72:73], v[176:177], v[146:147] op_sel:[0,0,0] op_sel_hi:[1,0,1] neg_lo:[0,1,0] neg_hi:[0,1,0]
  v_pk_fma_f32 v[150:151], v[76:77], v[176:177], v[150:151] op_sel:[0,0,0] op_sel_hi:[1,0,1] neg_lo:[0,1,0] neg_hi:[0,1,0]
  v_pk_mul_f32 v[136:137], v[136:137], v[180:181] op_sel:[0,0] op_sel_hi:[1,0]
  v_pk_fma_f32 v[140:141], v[140:141], v[182:183], v[12:13] op_sel:[0,0,0] op_sel_hi:[1,0,1]
  ds_write_b64 v8, v[112:113] offset:3072
  v_pk_mul_f32 v[144:145], v[144:145], v[184:185] op_sel:[0,0] op_sel_hi:[1,0]
  v_pk_fma_f32 v[148:149], v[148:149], v[186:187], v[12:13] op_sel:[0,0,0] op_sel_hi:[1,0,1]
  v_pk_mul_f32 v[138:139], v[138:139], v[180:181] op_sel:[0,0] op_sel_hi:[1,0]
  v_pk_mul_f32 v[142:143], v[142:143], v[182:183] op_sel:[0,0] op_sel_hi:[1,0]
  v_pk_mul_f32 v[146:147], v[146:147], v[184:185] op_sel:[0,0] op_sel_hi:[1,0]
  v_pk_mul_f32 v[150:151], v[150:151], v[186:187] op_sel:[0,0] op_sel_hi:[1,0]
  ds_write_b64 v9, v[116:117] offset:3072
  v_cvt_pk_bf16_f32 v136, v136, v137
  v_cvt_pk_bf16_f32 v140, v140, v141
  v_cvt_pk_bf16_f32 v144, v144, v145
  v_cvt_pk_bf16_f32 v148, v148, v149
  v_cvt_pk_bf16_f32 v137, v138, v139
  v_cvt_pk_bf16_f32 v141, v142, v143
  v_cvt_pk_bf16_f32 v145, v146, v147
  v_cvt_pk_bf16_f32 v149, v150, v151
  ds_write_b64 v8, v[120:121] offset:3840
  ds_write_b64 v9, v[124:125] offset:3840
  ds_write_b64 v8, v[128:129] offset:4608
  ds_write_b64 v9, v[132:133] offset:4608
  ds_write_b64 v8, v[136:137] offset:5376
  ds_write_b64 v9, v[140:141] offset:5376
  ds_write_b64 v8, v[144:145] offset:6144
  ds_write_b64 v9, v[148:149] offset:6144
  s_waitcnt lgkmcnt(0)
  s_barrier
  s_mul_i32 s56, s24, 18432
  s_add_u32 s56, s56, 12288
  v_add_u32 v78, s56, v2
  ds_read_b128 v[128:131], v78 offset:0
  ds_read_b128 v[132:135], v78 offset:1024
  ds_read_b128 v[136:139], v78 offset:2048
  ds_read_b128 v[140:143], v78 offset:3072
  ds_read_b128 v[144:147], v78 offset:4096
  ds_read_b128 v[148:151], v78 offset:5120
  s_lshl_b32 s56, s25, 4
  s_add_u32 s56, s56, s26
  s_mul_i32 s56, s56, 24576
  s_add_u32 s56, s56, s87
  s_mul_i32 s57, s24, 6144
  s_add_u32 s60, s56, s57
  s_add_u32 s61, s60, 4096
  s_waitcnt lgkmcnt(5)
  buffer_store_dwordx4 v[128:131], v2, s[4:7], s60 offen offset:0 sc1
  s_waitcnt lgkmcnt(4)
  buffer_store_dwordx4 v[132:135], v2, s[4:7], s60 offen offset:1024 sc1
  s_waitcnt lgkmcnt(3)
  buffer_store_dwordx4 v[136:139], v2, s[4:7], s60 offen offset:2048 sc1
  s_waitcnt lgkmcnt(2)
  buffer_store_dwordx4 v[140:143], v2, s[4:7], s60 offen offset:3072 sc1
  s_waitcnt lgkmcnt(1)
  buffer_store_dwordx4 v[144:147], v2, s[4:7], s61 offen offset:0 sc1
  s_waitcnt lgkmcnt(0)
  buffer_store_dwordx4 v[148:151], v2, s[4:7], s61 offen offset:1024 sc1
  s_and_b32 s68, s24, 1
  s_and_b32 s69, s24, 2
  s_add_u32 s97, s69, 9
  s_lshl_b32 s56, s25, 2
  s_sub_u32 s56, 8, s56
  s_cmp_ge_u32 s25, 2
  s_cselect_b32 s56, s69, s56
  s_sub_u32 s97, s97, s56
  s_mov_b32 s96, 0
  s_mul_i32 s56, s69, 1536
  s_mul_i32 s57, s68, 18432
  s_mul_i32 s58, s68, 6912
  v_lshrrev_b32 v86, 5, v1
  v_and_b32 v84, 31, v1
  v_mul_u32_u24 v84, 48, v84
  v_add_u32 v84, s56, v84
  v_lshl_add_u32 v87, v86, 3, v84
  v_add_u32 v87, s58, v87
  v_add_u32 v87, 74496, v87
  v_lshl_add_u32 v82, v86, 4, v84
  v_add_u32 v82, s58, v82
  v_add_u32 v82, 74496, v82
  v_add_u32 v84, s57, v84
  v_mul_u32_u24 v85, 36872, v86
  v_add_u32 v85, 13856, v85
  v_add_u32 v85, v85, v84
  v_lshl_add_u32 v84, v86, 4, v84
  v_add_u32 v84, 13824, v84
  v_bfe_u32 v83, v1, 2, 2
  v_lshl_add_u32 v86, v86, 2, v83
  v_mul_u32_u24 v86, 48, v86
  v_bfe_u32 v83, v1, 4, 1
  v_lshl_add_u32 v86, v83, 5, v86
  v_and_b32 v83, 3, v1
  v_lshl_add_u32 v86, v83, 3, v86
  s_add_u32 s56, s56, s57
  v_add_u32 v86, s56, v86
  v_add_u32 v86, 50688, v86
  ds_read_b128 v[88:91], v82
  ds_read_b128 v[94:97], v82 offset:1536
  v_lshrrev_b32 v83, 5, v1
  v_lshlrev_b32 v83, 4, v83
  v_sub_u32 v82, v82, v83
  ds_read_b64 v[92:93], v82 offset:32
  ds_read_b64 v[98:99], v82 offset:1568
  ds_read_b128 v[100:103], v84
  ds_read_b64 v[104:105], v85
  v_subrev_u32 v82, 1536, v84
  v_subrev_u32 v83, 1536, v85
  ds_read_b128 v[112:115], v82
  ds_read_b64 v[116:117], v83
  v_lshrrev_b32 v82, 5, v1
  v_lshlrev_b32 v82, 2, v82
  v_and_b32 v83, 31, v1
  v_sub_u32 v83, v83, v82
  v_mov_b32 v82, 0xf149f2ca
  v_cmp_le_i32 vcc, 0, v83
  s_nop 1
  v_cndmask_b32 v32, v82, 0, vcc
  v_cmp_le_i32 vcc, 1, v83
  s_nop 1
  v_cndmask_b32 v33, v82, 0, vcc
  v_cmp_le_i32 vcc, 2, v83
  s_nop 1
  v_cndmask_b32 v34, v82, 0, vcc
  v_cmp_le_i32 vcc, 3, v83
  s_nop 1
  v_cndmask_b32 v35, v82, 0, vcc
  v_cmp_le_i32 vcc, 8, v83
  s_nop 1
  v_cndmask_b32 v36, v82, 0, vcc
  v_cmp_le_i32 vcc, 9, v83
  s_nop 1
  v_cndmask_b32 v37, v82, 0, vcc
  v_cmp_le_i32 vcc, 10, v83
  s_nop 1
  v_cndmask_b32 v38, v82, 0, vcc
  v_cmp_le_i32 vcc, 11, v83
  s_nop 1
  v_cndmask_b32 v39, v82, 0, vcc
  v_cmp_le_i32 vcc, 16, v83
  s_nop 1
  v_cndmask_b32 v40, v82, 0, vcc
  v_cmp_le_i32 vcc, 17, v83
  s_nop 1
  v_cndmask_b32 v41, v82, 0, vcc
  v_cmp_le_i32 vcc, 18, v83
  s_nop 1
  v_cndmask_b32 v42, v82, 0, vcc
  v_cmp_le_i32 vcc, 19, v83
  s_nop 1
  v_cndmask_b32 v43, v82, 0, vcc
  v_cmp_le_i32 vcc, 24, v83
  s_nop 1
  v_cndmask_b32 v44, v82, 0, vcc
  v_cmp_le_i32 vcc, 25, v83
  s_nop 1
  v_cndmask_b32 v45, v82, 0, vcc
  v_cmp_le_i32 vcc, 26, v83
  s_nop 1
  v_cndmask_b32 v46, v82, 0, vcc
  v_cmp_le_i32 vcc, 27, v83
  s_nop 1
  v_cndmask_b32 v47, v82, 0, vcc
  s_waitcnt lgkmcnt(0)
  v_cmp_gt_u32 vcc, 32, v1
  s_nop 1
  v_cndmask_b32 v92, 0, v92, vcc
  v_cndmask_b32 v93, 0, v93, vcc
  v_cndmask_b32 v98, 0, v98, vcc
  v_cndmask_b32 v99, 0, v99, vcc
  v_mfma_f32_32x32x16_bf16 v[144:159], v[100:103], v[94:97], v[32:47]
  s_nop 0
  v_mfma_f32_32x32x8_bf16 v[144:159], v[104:105], v[98:99], v[144:159]
  v_mfma_f32_32x32x16_bf16 v[128:143], v[112:115], v[88:91], v[32:47]
  v_mfma_f32_32x32x8_bf16 v[128:143], v[116:117], v[92:93], v[128:143]
  s_nop 11
  v_max3_f32 v80, v128, v129, v130
  v_max3_f32 v81, v144, v145, v146
  v_max3_f32 v80, v131, v132, v80
  v_max3_f32 v81, v147, v148, v81
  v_max3_f32 v80, v133, v134, v80
  v_max3_f32 v81, v149, v150, v81
  v_max3_f32 v80, v135, v136, v80
  v_max3_f32 v81, v151, v152, v81
  v_max3_f32 v80, v137, v138, v80
  v_max3_f32 v81, v153, v154, v81
  v_max3_f32 v80, v139, v140, v80
  v_max3_f32 v81, v155, v156, v81
  v_max3_f32 v80, v141, v142, v80
  v_max3_f32 v81, v157, v158, v81
  v_max_f32 v80, v80, v143
  v_max_f32 v81, v81, v159
  v_mov_b32 v82, v80
  v_mov_b32 v83, v81
  s_nop 0
  v_permlane32_swap_b32 v80, v82
  v_permlane32_swap_b32 v81, v83
  v_max_f32 v80, v80, v82
  v_max_f32 v81, v81, v83
L_b_main:
  v_sub_f32 v82, 0, v80
  v_cvt_pk_bf16_f32 v83, v82, v82
  v_lshlrev_b32 v83, 16, v83
  v_sub_f32 v83, v82, v83
  v_cvt_pk_bf16_f32 v82, v82, v83
  v_cmp_gt_u32 vcc, 32, v1
  s_nop 1
  v_cndmask_b32 v92, v82, v92, vcc
  v_sub_f32 v82, 0, v81
  v_cvt_pk_bf16_f32 v83, v82, v82
  v_lshlrev_b32 v83, 16, v83
  v_sub_f32 v83, v82, v83
  v_cvt_pk_bf16_f32 v82, v82, v83
  v_cmp_gt_u32 vcc, 32, v1
  s_nop 1
  v_cndmask_b32 v98, v82, v98, vcc
  v_mfma_f32_32x32x16_bf16 v[144:159], v[100:103], v[94:97], v[32:47]
  s_nop 0
  v_mfma_f32_32x32x8_bf16 v[144:159], v[104:105], v[98:99], v[144:159]
  ds_read_b64_tr_b16 v[112:113], v86 offset:0
  ds_read_b64_tr_b16 v[114:115], v86 offset:384
  ds_read_b64_tr_b16 v[116:117], v86 offset:768
  ds_read_b64_tr_b16 v[118:119], v86 offset:1152
  v_subrev_u32 v84, 1536, v84
  v_subrev_u32 v85, 1536, v85
  ds_read_b128 v[100:103], v84
  ds_read_b64 v[104:105], v85
  s_cmp_eq_u32 s96, 1
  s_cbranch_scc1 L_b_nf0_17
  s_waitcnt vmcnt(0)
  s_lshl_b32 s56, s25, 8
  s_lshl_b32 s57, s26, 4
  s_add_u32 s56, s56, s57
  s_lshl_b32 s57, s24, 2
  s_add_u32 s56, s56, s57
  s_add_u32 s56, s56, 0x3410000
  s_sub_u32 s88, s27, 1
  v_mov_b32 v78, s88
  v_mov_b32 v79, s56
  s_mov_b64 exec, 1
  buffer_store_dword v78, v79, s[4:7], 0 offen sc1
  s_mov_b64 exec, -1
  s_cmp_lt_u32 s24, 2
  s_cbranch_scc1 L_b_nt_18
  s_lshl_b32 s56, s25, 3
  s_lshl_b32 s57, s24, 1
  s_add_u32 s56, s56, s57
  s_mul_i32 s56, s56, 20480
  s_mul_i32 s57, s26, 1280
  s_add_u32 s56, s56, s57
  s_add_u32 s56, s56, s84
  s_mov_b32 exec_lo, 0xfffff
  s_mov_b32 exec_hi, 0
  buffer_load_dword v64, v63, s[4:7], s56 offen
  s_cmp_eq_u32 s27, 4
  s_cbranch_scc1 L_ot_19
  v_lshlrev_b32 v65, 7, v1
  s_mul_i32 s56, s90, 20480
  s_and_b32 s57, s26, 7
  s_mul_i32 s57, s57, 2560
  s_add_u32 s56, s56, s57
  s_add_u32 s56, s56, s82
  s_lshl_b32 s57, s90, 10
  s_add_u32 s57, s57, s83
  buffer_load_dword v64, v65, s[12:15], s56 offen
  s_mov_b32 exec_lo, 0xff
  buffer_load_dword v64, v65, s[4:7], s57 offen
L_ot_19:
  s_mov_b64 exec, -1
  s_sub_u32 s24, s24, 2
  s_sub_u32 s90, s90, 2
  s_lshl_b32 s56, s25, 3
  s_lshl_b32 s57, s24, 1
  s_add_u32 s56, s56, s57
  s_mul_i32 s56, s56, 20480
  s_mul_i32 s57, s26, 1280
  s_add_u32 s56, s56, s57
  s_add_u32 s56, s56, s84
  s_mov_b32 exec_lo, 0xfffff
  s_mov_b32 exec_hi, 0
  buffer_load_dword v64, v63, s[4:7], s56 offen
  s_cmp_eq_u32 s27, 4
  s_cbranch_scc1 L_ot_20
  v_lshlrev_b32 v65, 7, v1
  s_mul_i32 s56, s90, 20480
  s_and_b32 s57, s26, 7
  s_mul_i32 s57, s57, 2560
  s_add_u32 s56, s56, s57
  s_add_u32 s56, s56, s82
  s_lshl_b32 s57, s90, 10
  s_add_u32 s57, s57, s83
  buffer_load_dword v64, v65, s[12:15], s56 offen
  s_mov_b32 exec_lo, 0xff
  buffer_load_dword v64, v65, s[4:7], s57 offen
L_ot_20:
  s_mov_b64 exec, -1
  s_add_u32 s24, s24, 2
  s_add_u32 s90, s90, 2
L_b_nt_18:
L_b_nf0_17:
  s_nop 1
  s_waitcnt lgkmcnt(0)
  v_exp_f32 v144, v144
  v_exp_f32 v145, v145
  v_exp_f32 v146, v146
  v_exp_f32 v147, v147
  v_cvt_pk_bf16_f32 v144, v144, v145
  v_exp_f32 v148, v148
  v_exp_f32 v149, v149
  v_cvt_pk_bf16_f32 v145, v146, v147
  v_exp_f32 v150, v150
  v_exp_f32 v151, v151
  v_cvt_pk_bf16_f32 v146, v148, v149
  v_exp_f32 v152, v152
  v_exp_f32 v153, v153
  v_cvt_pk_bf16_f32 v147, v150, v151
  v_exp_f32 v154, v154
  v_exp_f32 v155, v155
  v_cvt_pk_bf16_f32 v148, v152, v153
  v_exp_f32 v156, v156
  v_exp_f32 v157, v157
  v_cvt_pk_bf16_f32 v149, v154, v155
  v_exp_f32 v158, v158
  v_exp_f32 v159, v159
  v_cvt_pk_bf16_f32 v150, v156, v157
  v_cvt_pk_bf16_f32 v151, v158, v159
  v_mfma_f32_32x32x16_bf16 v[128:143], v[100:103], v[88:91], v[32:47]
  v_mfma_f32_32x32x8_bf16 v[128:143], v[104:105], v[92:93], v[128:143]
  v_mov_b32 v160, 0
  v_mov_b32 v161, 0
  v_mov_b32 v162, 0
  v_mov_b32 v163, 0
  v_mov_b32 v164, 0
  v_mov_b32 v165, 0
  v_mov_b32 v166, 0
  v_mov_b32 v167, 0
  v_mov_b32 v168, 0
  v_mov_b32 v169, 0
  v_mov_b32 v170, 0
  v_mov_b32 v171, 0
  v_mov_b32 v172, 0
  v_mov_b32 v173, 0
  v_mov_b32 v174, 0
  v_mov_b32 v175, 0
  v_mfma_f32_32x32x16_bf16 v[176:191], v[112:115], v[144:147], 0
  v_mfma_f32_32x32x16_bf16 v[176:191], v[116:119], v[148:151], v[176:191]
  v_mfma_f32_32x32x16_bf16 v[144:159], v[100:103], v[94:97], 0
  v_mfma_f32_32x32x8_bf16 v[144:159], v[104:105], v[98:99], v[144:159]
  v_xor_b32 v32, 0xf149f2ca, v32
  v_xor_b32 v33, 0xf149f2ca, v33
  v_xor_b32 v34, 0xf149f2ca, v34
  v_xor_b32 v35, 0xf149f2ca, v35
  v_xor_b32 v36, 0xf149f2ca, v36
  v_xor_b32 v37, 0xf149f2ca, v37
  v_xor_b32 v38, 0xf149f2ca, v38
  v_xor_b32 v39, 0xf149f2ca, v39
  v_xor_b32 v40, 0xf149f2ca, v40
  v_xor_b32 v41, 0xf149f2ca, v41
  v_xor_b32 v42, 0xf149f2ca, v42
  v_xor_b32 v43, 0xf149f2ca, v43
  v_xor_b32 v44, 0xf149f2ca, v44
  v_xor_b32 v45, 0xf149f2ca, v45
  v_xor_b32 v46, 0xf149f2ca, v46
  v_xor_b32 v47, 0xf149f2ca, v47
  v_subrev_u32 v86, 1536, v86
  s_mov_b32 s101, 1
  s_add_u32 s66, s69, 1
  s_mov_b32 s67, 1
L_b_seg:
  v_exp_f32 v128, v128
  v_exp_f32 v129, v129
  v_exp_f32 v130, v130
  v_exp_f32 v131, v131
  v_cvt_pk_bf16_f32 v128, v128, v129
  v_exp_f32 v132, v132
  ds_read_b64_tr_b16 v[112:113], v86 offset:0
  ds_read_b64_tr_b16 v[114:115], v86 offset:384
  ds_read_b64_tr_b16 v[116:117], v86 offset:768
  ds_read_b64_tr_b16 v[118:119], v86 offset:1152
  v_exp_f32 v133, v133
  v_cvt_pk_bf16_f32 v129, v130, v131
  v_exp_f32 v134, v134
  v_exp_f32 v135, v135
  v_cvt_pk_bf16_f32 v130, v132, v133
  v_exp_f32 v136, v136
  v_exp_f32 v137, v137
  v_cvt_pk_bf16_f32 v131, v134, v135
  v_subrev_u32 v84, 1536, v84
  v_subrev_u32 v85, 1536, v85
  ds_read_b128 v[100:103], v84
  ds_read_b64 v[104:105], v85
  v_exp_f32 v138, v138
  v_exp_f32 v139, v139
  v_cvt_pk_bf16_f32 v132, v136, v137
  v_exp_f32 v140, v140
  v_exp_f32 v141, v141
  v_cvt_pk_bf16_f32 v133, v138, v139
  v_exp_f32 v142, v142
  v_exp_f32 v143, v143
  v_cvt_pk_bf16_f32 v134, v140, v141
  v_cvt_pk_bf16_f32 v135, v142, v143
L_b_loop:
  s_min_u32 s70, s66, 7
  s_cmp_ge_u32 s101, s66
  s_cbranch_scc1 L_b_last
  s_cmp_eq_u32 s101, 7
  s_cbranch_scc1 L_b_k7
L_b_body:
  s_waitcnt lgkmcnt(0)
  v_mfma_f32_32x32x16_bf16 v[160:175], v[112:115], v[128:131], v[160:175]
  v_exp_f32 v144, v144
  v_exp_f32 v145, v145
  v_exp_f32 v146, v146
  v_exp_f32 v147, v147
  v_mfma_f32_32x32x16_bf16 v[160:175], v[116:119], v[132:135], v[160:175]
  v_cvt_pk_bf16_f32 v144, v144, v145
  v_exp_f32 v148, v148
  v_exp_f32 v149, v149
  v_cvt_pk_bf16_f32 v145, v146, v147
  v_mfma_f32_32x32x16_bf16 v[128:143], v[100:103], v[88:91], 0
  v_exp_f32 v150, v150
  v_exp_f32 v151, v151
  v_cvt_pk_bf16_f32 v146, v148, v149
  v_exp_f32 v152, v152
  v_mfma_f32_32x32x8_bf16 v[128:143], v[104:105], v[92:93], v[128:143]
  v_exp_f32 v153, v153
  v_cvt_pk_bf16_f32 v147, v150, v151
  v_exp_f32 v154, v154
  v_exp_f32 v155, v155
  v_cvt_pk_bf16_f32 v148, v152, v153
  v_exp_f32 v156, v156
  v_exp_f32 v157, v157
  v_cvt_pk_bf16_f32 v149, v154, v155
  v_exp_f32 v158, v158
  v_exp_f32 v159, v159
  v_cvt_pk_bf16_f32 v150, v156, v157
  v_cvt_pk_bf16_f32 v151, v158, v159
  v_mfma_f32_32x32x16_bf16 v[176:191], v[112:115], v[144:147], v[176:191]
  v_exp_f32 v128, v128
  v_exp_f32 v129, v129
  v_exp_f32 v130, v130
  v_exp_f32 v131, v131
  v_mfma_f32_32x32x16_bf16 v[176:191], v[116:119], v[148:151], v[176:191]
  v_cvt_pk_bf16_f32 v128, v128, v129
  v_exp_f32 v132, v132
  v_subrev_u32 v86, 1536, v86
  ds_read_b64_tr_b16 v[112:113], v86 offset:0
  ds_read_b64_tr_b16 v[114:115], v86 offset:384
  ds_read_b64_tr_b16 v[116:117], v86 offset:768
  ds_read_b64_tr_b16 v[118:119], v86 offset:1152
  v_exp_f32 v133, v133
  v_cvt_pk_bf16_f32 v129, v130, v131
  v_mfma_f32_32x32x16_bf16 v[144:159], v[100:103], v[94:97], 0
  v_exp_f32 v134, v134
  v_exp_f32 v135, v135
  v_cvt_pk_bf16_f32 v130, v132, v133
  v_exp_f32 v136, v136
  v_mfma_f32_32x32x8_bf16 v[144:159], v[104:105], v[98:99], v[144:159]
  v_exp_f32 v137, v137
  v_cvt_pk_bf16_f32 v131, v134, v135
  v_subrev_u32 v84, 1536, v84
  v_subrev_u32 v85, 1536, v85
  ds_read_b128 v[100:103], v84
  ds_read_b64 v[104:105], v85
  v_exp_f32 v138, v138
  v_exp_f32 v139, v139
  v_cvt_pk_bf16_f32 v132, v136, v137
  v_exp_f32 v140, v140
  v_exp_f32 v141, v141
  v_cvt_pk_bf16_f32 v133, v138, v139
  v_exp_f32 v142, v142
  v_exp_f32 v143, v143
  v_cvt_pk_bf16_f32 v134, v140, v141
  v_cvt_pk_bf16_f32 v135, v142, v143
  s_add_u32 s101, s101, 1
  s_cmp_lt_u32 s101, s70
  s_cbranch_scc1 L_b_body
  s_cmp_ge_u32 s101, s66
  s_cbranch_scc1 L_b_last
L_b_k7:
  s_waitcnt lgkmcnt(0)
  v_mfma_f32_32x32x16_bf16 v[160:175], v[112:115], v[128:131], v[160:175]
  v_exp_f32 v144, v144
  v_exp_f32 v145, v145
  v_exp_f32 v146, v146
  v_exp_f32 v147, v147
  v_mfma_f32_32x32x16_bf16 v[160:175], v[116:119], v[132:135], v[160:175]
  v_cvt_pk_bf16_f32 v144, v144, v145
  v_exp_f32 v148, v148
  v_exp_f32 v149, v149
  v_cvt_pk_bf16_f32 v145, v146, v147
  v_mfma_f32_32x32x16_bf16 v[128:143], v[100:103], v[88:91], 0
  v_exp_f32 v150, v150
  v_exp_f32 v151, v151
  v_cvt_pk_bf16_f32 v146, v148, v149
  v_exp_f32 v152, v152
  v_mfma_f32_32x32x8_bf16 v[128:143], v[104:105], v[92:93], v[128:143]
  v_exp_f32 v153, v153
  v_cvt_pk_bf16_f32 v147, v150, v151
  v_exp_f32 v154, v154
  v_exp_f32 v155, v155
  v_cvt_pk_bf16_f32 v148, v152, v153
  v_exp_f32 v156, v156
  v_exp_f32 v157, v157
  v_cvt_pk_bf16_f32 v149, v154, v155
  v_exp_f32 v158, v158
  v_exp_f32 v159, v159
  v_cvt_pk_bf16_f32 v150, v156, v157
  v_cvt_pk_bf16_f32 v151, v158, v159
  v_mfma_f32_32x32x16_bf16 v[176:191], v[112:115], v[144:147], v[176:191]
  v_exp_f32 v128, v128
  v_exp_f32 v129, v129
  v_exp_f32 v130, v130
  v_exp_f32 v131, v131
  v_mfma_f32_32x32x16_bf16 v[176:191], v[116:119], v[148:151], v[176:191]
  v_cvt_pk_bf16_f32 v128, v128, v129
  v_exp_f32 v132, v132
  v_subrev_u32 v86, 1536, v86
  ds_read_b64_tr_b16 v[112:113], v86 offset:0
  ds_read_b64_tr_b16 v[114:115], v86 offset:384
  ds_read_b64_tr_b16 v[116:117], v86 offset:768
  ds_read_b64_tr_b16 v[118:119], v86 offset:1152
  v_exp_f32 v133, v133
  v_cvt_pk_bf16_f32 v129, v130, v131
  v_mfma_f32_32x32x16_bf16 v[144:159], v[100:103], v[94:97], v[32:47]
  v_exp_f32 v134, v134
  v_exp_f32 v135, v135
  v_cvt_pk_bf16_f32 v130, v132, v133
  v_exp_f32 v136, v136
  v_mfma_f32_32x32x8_bf16 v[144:159], v[104:105], v[98:99], v[144:159]
  v_exp_f32 v137, v137
  v_cvt_pk_bf16_f32 v131, v134, v135
  v_subrev_u32 v84, 1536, v84
  v_subrev_u32 v85, 1536, v85
  ds_read_b128 v[100:103], v84
  ds_read_b64 v[104:105], v85
  v_exp_f32 v138, v138
  v_exp_f32 v139, v139
  v_cvt_pk_bf16_f32 v132, v136, v137
  v_exp_f32 v140, v140
  v_exp_f32 v141, v141
  v_cvt_pk_bf16_f32 v133, v138, v139
  v_exp_f32 v142, v142
  v_exp_f32 v143, v143
  v_cvt_pk_bf16_f32 v134, v140, v141
  v_cvt_pk_bf16_f32 v135, v142, v143
  s_add_u32 s101, s101, 1
L_b_k8:
  s_waitcnt lgkmcnt(0)
  v_mfma_f32_32x32x16_bf16 v[160:175], v[112:115], v[128:131], v[160:175]
  v_exp_f32 v144, v144
  v_exp_f32 v145, v145
  v_exp_f32 v146, v146
  v_exp_f32 v147, v147
  v_mfma_f32_32x32x16_bf16 v[160:175], v[116:119], v[132:135], v[160:175]
  v_cvt_pk_bf16_f32 v144, v144, v145
  v_exp_f32 v148, v148
  v_exp_f32 v149, v149
  v_cvt_pk_bf16_f32 v145, v146, v147
  v_mfma_f32_32x32x16_bf16 v[128:143], v[100:103], v[88:91], v[32:47]
  v_exp_f32 v150, v150
  v_exp_f32 v151, v151
  v_cvt_pk_bf16_f32 v146, v148, v149
  v_exp_f32 v152, v152
  v_mfma_f32_32x32x8_bf16 v[128:143], v[104:105], v[92:93], v[128:143]
  v_exp_f32 v153, v153
  v_cvt_pk_bf16_f32 v147, v150, v151
  v_exp_f32 v154, v154
  v_exp_f32 v155, v155
  v_cvt_pk_bf16_f32 v148, v152, v153
  v_exp_f32 v156, v156
  v_exp_f32 v157, v157
  v_cvt_pk_bf16_f32 v149, v154, v155
  v_exp_f32 v158, v158
  v_exp_f32 v159, v159
  v_cvt_pk_bf16_f32 v150, v156, v157
  v_cvt_pk_bf16_f32 v151, v158, v159
  v_mfma_f32_32x32x16_bf16 v[176:191], v[112:115], v[144:147], v[176:191]
  v_exp_f32 v128, v128
  v_exp_f32 v129, v129
  v_exp_f32 v130, v130
  v_exp_f32 v131, v131
  v_mfma_f32_32x32x16_bf16 v[176:191], v[116:119], v[148:151], v[176:191]
  v_cvt_pk_bf16_f32 v128, v128, v129
  v_exp_f32 v132, v132
  v_subrev_u32 v86, 1536, v86
  ds_read_b64_tr_b16 v[112:113], v86 offset:0
  ds_read_b64_tr_b16 v[114:115], v86 offset:384
  ds_read_b64_tr_b16 v[116:117], v86 offset:768
  ds_read_b64_tr_b16 v[118:119], v86 offset:1152
  v_exp_f32 v133, v133
  v_cvt_pk_bf16_f32 v129, v130, v131
  v_exp_f32 v134, v134
  v_exp_f32 v135, v135
  v_cvt_pk_bf16_f32 v130, v132, v133
  v_exp_f32 v136, v136
  v_exp_f32 v137, v137
  v_cvt_pk_bf16_f32 v131, v134, v135
  v_exp_f32 v138, v138
  v_exp_f32 v139, v139
  v_cvt_pk_bf16_f32 v132, v136, v137
  v_exp_f32 v140, v140
  v_exp_f32 v141, v141
  v_cvt_pk_bf16_f32 v133, v138, v139
  v_exp_f32 v142, v142
  v_exp_f32 v143, v143
  v_cvt_pk_bf16_f32 v134, v140, v141
  v_cvt_pk_bf16_f32 v135, v142, v143
  s_waitcnt lgkmcnt(0)
  v_mfma_f32_32x32x16_bf16 v[160:175], v[112:115], v[128:131], v[160:175]
  v_mfma_f32_32x32x16_bf16 v[160:175], v[116:119], v[132:135], v[160:175]
  s_branch L_b_done
L_b_last:
  s_waitcnt lgkmcnt(0)
  v_mfma_f32_32x32x16_bf16 v[160:175], v[112:115], v[128:131], v[160:175]
  v_exp_f32 v144, v144
  v_exp_f32 v145, v145
  v_exp_f32 v146, v146
  v_exp_f32 v147, v147
  v_mfma_f32_32x32x16_bf16 v[160:175], v[116:119], v[132:135], v[160:175]
  v_cvt_pk_bf16_f32 v144, v144, v145
  v_exp_f32 v148, v148
  v_exp_f32 v149, v149
  v_cvt_pk_bf16_f32 v145, v146, v147
  v_exp_f32 v150, v150
  v_exp_f32 v151, v151
  v_cvt_pk_bf16_f32 v146, v148, v149
  v_exp_f32 v152, v152
  v_exp_f32 v153, v153
  v_cvt_pk_bf16_f32 v147, v150, v151
  v_exp_f32 v154, v154
  v_exp_f32 v155, v155
  v_cvt_pk_bf16_f32 v148, v152, v153
  v_exp_f32 v156, v156
  v_exp_f32 v157, v157
  v_cvt_pk_bf16_f32 v149, v154, v155
  v_exp_f32 v158, v158
  v_exp_f32 v159, v159
  v_cvt_pk_bf16_f32 v150, v156, v157
  v_cvt_pk_bf16_f32 v151, v158, v159
  v_mfma_f32_32x32x16_bf16 v[176:191], v[112:115], v[144:147], v[176:191]
  s_nop 0
  v_mfma_f32_32x32x16_bf16 v[176:191], v[116:119], v[148:151], v[176:191]
  v_subrev_u32 v86, 1536, v86
  s_add_u32 s101, s101, 1
  s_cmp_eq_u32 s67, 2
  s_cbranch_scc1 L_b_done
  s_cmp_eq_u32 s96, 1
  s_cbranch_scc1 L_b_nf_21
  s_cmp_ge_u32 s24, 2
  s_cbranch_scc1 L_kvskip_22
  s_add_u32 s62, s24, 1
  s_cmp_lt_u32 s25, s62
  s_cbranch_scc1 L_kvskip_22
  s_sub_u32 s63, s25, s62
  s_lshl_b32 s56, s63, 8
  s_lshl_b32 s57, s26, 4
  s_add_u32 s56, s56, s57
  s_add_u32 s56, s56, 0x3410000
  s_sub_u32 s88, s27, 1
  v_lshlrev_b32 v79, 2, v1
  v_add_u32 v79, s56, v79
  s_mov_b32 exec_lo, 0xf
  s_mov_b32 exec_hi, 0x0
  s_mov_b32 s95, 0
L_poll_23:
  buffer_load_dword v78, v79, s[4:7], 0 offen sc1
  s_waitcnt vmcnt(0)
  v_cmp_le_u32 vcc, s88, v78
  s_nop 1
  s_nop 0
  s_cmp_eq_u64 vcc, exec
  s_cbranch_scc1 L_pd_24
  s_add_u32 s95, s95, 1
  s_cmp_lt_u32 s95, 0x20000
  s_cbranch_scc1 L_poll_23
L_pd_24:
  s_mov_b64 exec, -1
  s_lshl_b32 s56, s63, 4
  s_add_u32 s56, s56, s26
  s_mul_i32 s56, s56, 24576
  s_add_u32 s60, s56, s87
  s_sub_u32 s61, 2, s62
  s_mul_i32 s61, s61, 6144
  s_add_u32 m0, s61, 0
  s_nop 0
  buffer_load_dwordx4 v2, s[4:7], s60 offen offset:0 sc1 lds
  buffer_load_dwordx4 v2, s[4:7], s60 offen offset:1024 sc1 lds
  buffer_load_dwordx4 v2, s[4:7], s60 offen offset:2048 sc1 lds
  buffer_load_dwordx4 v2, s[4:7], s60 offen offset:3072 sc1 lds
  s_add_u32 s60, s60, 4096
  s_add_u32 m0, s61, 4096
  s_nop 0
  buffer_load_dwordx4 v2, s[4:7], s60 offen offset:0 sc1 lds
  buffer_load_dwordx4 v2, s[4:7], s60 offen offset:1024 sc1 lds
  s_add_u32 s60, s60, 2048
  s_add_u32 m0, s61, 18432
  s_nop 0
  buffer_load_dwordx4 v2, s[4:7], s60 offen offset:0 sc1 lds
  buffer_load_dwordx4 v2, s[4:7], s60 offen offset:1024 sc1 lds
  buffer_load_dwordx4 v2, s[4:7], s60 offen offset:2048 sc1 lds
  buffer_load_dwordx4 v2, s[4:7], s60 offen offset:3072 sc1 lds
  s_add_u32 s60, s60, 4096
  s_add_u32 m0, s61, 22528
  s_nop 0
  buffer_load_dwordx4 v2, s[4:7], s60 offen offset:0 sc1 lds
  buffer_load_dwordx4 v2, s[4:7], s60 offen offset:1024 sc1 lds
  s_add_u32 s60, s60, 2048
  s_add_u32 m0, s61, 36864
  s_nop 0
  buffer_load_dwordx4 v2, s[4:7], s60 offen offset:0 sc1 lds
  buffer_load_dwordx4 v2, s[4:7], s60 offen offset:1024 sc1 lds
  buffer_load_dwordx4 v2, s[4:7], s60 offen offset:2048 sc1 lds
  buffer_load_dwordx4 v2, s[4:7], s60 offen offset:3072 sc1 lds
  s_add_u32 s60, s60, 4096
  s_add_u32 m0, s61, 40960
  s_nop 0
  buffer_load_dwordx4 v2, s[4:7], s60 offen offset:0 sc1 lds
  buffer_load_dwordx4 v2, s[4:7], s60 offen offset:1024 sc1 lds
  s_add_u32 s60, s60, 2048
  s_add_u32 m0, s61, 55296
  s_nop 0
  buffer_load_dwordx4 v2, s[4:7], s60 offen offset:0 sc1 lds
  buffer_load_dwordx4 v2, s[4:7], s60 offen offset:1024 sc1 lds
  buffer_load_dwordx4 v2, s[4:7], s60 offen offset:2048 sc1 lds
  buffer_load_dwordx4 v2, s[4:7], s60 offen offset:3072 sc1 lds
  s_add_u32 s60, s60, 4096
  s_add_u32 m0, s61, 59392
  s_nop 0
  buffer_load_dwordx4 v2, s[4:7], s60 offen offset:0 sc1 lds
  buffer_load_dwordx4 v2, s[4:7], s60 offen offset:1024 sc1 lds
  s_add_u32 s60, s60, 2048
L_kvskip_22:
  s_waitcnt vmcnt(0)
  s_barrier
L_b_nf_21:
  s_cmp_gt_u32 s101, s97
  s_cbranch_scc1 L_b_done
  ds_read_b128 v[100:103], v84
  ds_read_b64 v[104:105], v85
  s_waitcnt lgkmcnt(0)
  v_mfma_f32_32x32x16_bf16 v[128:143], v[100:103], v[88:91], 0
  v_mfma_f32_32x32x8_bf16 v[128:143], v[104:105], v[92:93], v[128:143]
  v_mfma_f32_32x32x16_bf16 v[144:159], v[100:103], v[94:97], 0
  v_mfma_f32_32x32x8_bf16 v[144:159], v[104:105], v[98:99], v[144:159]
  s_mov_b32 s66, s97
  s_mov_b32 s67, 2
  s_nop 7
  s_branch L_b_seg
L_b_done:
  s_nop 7
  s_nop 7
  v_max_f32 v82, v168, v184
  v_mov_b32 v83, 0x5f800000
  v_cmp_nlt_f32 vcc, v82, v83
  v_cmp_u_f32 s[56:57], v168, v184
  s_nop 2
  s_or_b64 vcc, vcc, s[56:57]
  s_cmp_eq_u32 vcc_hi, 0
  s_cbranch_scc1 L_b_ok
  s_cmp_eq_u32 s96, 1
  s_cbranch_scc1 L_b_ok
  s_mov_b32 s96, 1
  v_cmp_gt_u32 vcc, 32, v1
  s_nop 1
  v_cndmask_b32 v92, 0, v92, vcc
  v_mov_b32 v80, 0xf149f2ca
  v_cndmask_b32 v98, 0, v98, vcc
  v_mov_b32 v81, 0xf149f2ca
  s_mul_i32 s56, s69, 1536
  s_mul_i32 s57, s68, 18432
  s_mul_i32 s58, s68, 6912
  v_lshrrev_b32 v86, 5, v1
  v_and_b32 v84, 31, v1
  v_mul_u32_u24 v84, 48, v84
  v_add_u32 v84, s56, v84
  v_lshl_add_u32 v87, v86, 3, v84
  v_add_u32 v87, s58, v87
  v_add_u32 v87, 74496, v87
  v_lshl_add_u32 v82, v86, 4, v84
  v_add_u32 v82, s58, v82
  v_add_u32 v82, 74496, v82
  v_add_u32 v84, s57, v84
  v_mul_u32_u24 v85, 36872, v86
  v_add_u32 v85, 13856, v85
  v_add_u32 v85, v85, v84
  v_lshl_add_u32 v84, v86, 4, v84
  v_add_u32 v84, 13824, v84
  v_bfe_u32 v83, v1, 2, 2
  v_lshl_add_u32 v86, v86, 2, v83
  v_mul_u32_u24 v86, 48, v86
  v_bfe_u32 v83, v1, 4, 1
  v_lshl_add_u32 v86, v83, 5, v86
  v_and_b32 v83, 3, v1
  v_lshl_add_u32 v86, v83, 3, v86
  s_add_u32 s56, s56, s57
  v_add_u32 v86, s56, v86
  v_add_u32 v86, 50688, v86
  s_mov_b32 s101, 0
L_b_tm:
  ds_read_b128 v[100:103], v84
  ds_read_b64 v[104:105], v85
  s_waitcnt lgkmcnt(0)
  s_cmp_eq_u32 s101, 0
  s_cbranch_scc1 L_tm0_25
  s_cmp_eq_u32 s101, 1
  s_cbranch_scc1 L_tm1_26
  s_cmp_eq_u32 s101, 8
  s_cbranch_scc1 L_tm8_27
  s_cmp_eq_u32 s101, 9
  s_cbranch_scc1 L_tm9_28
  v_mfma_f32_32x32x16_bf16 v[128:143], v[100:103], v[88:91], 0
  v_mfma_f32_32x32x8_bf16 v[128:143], v[104:105], v[92:93], v[128:143]
  v_mfma_f32_32x32x16_bf16 v[144:159], v[100:103], v[94:97], 0
  v_mfma_f32_32x32x8_bf16 v[144:159], v[104:105], v[98:99], v[144:159]
  s_nop 15
  v_max3_f32 v80, v128, v129, v80
  v_max3_f32 v80, v130, v131, v80
  v_max3_f32 v80, v132, v133, v80
  v_max3_f32 v80, v134, v135, v80
  v_max3_f32 v80, v136, v137, v80
  v_max3_f32 v80, v138, v139, v80
  v_max3_f32 v80, v140, v141, v80
  v_max3_f32 v80, v142, v143, v80
  s_nop 15
  v_max3_f32 v81, v144, v145, v81
  v_max3_f32 v81, v146, v147, v81
  v_max3_f32 v81, v148, v149, v81
  v_max3_f32 v81, v150, v151, v81
  v_max3_f32 v81, v152, v153, v81
  v_max3_f32 v81, v154, v155, v81
  v_max3_f32 v81, v156, v157, v81
  v_max3_f32 v81, v158, v159, v81
  s_branch L_tmn_29
L_tm0_25:
  v_xor_b32 v32, 0xf149f2ca, v32
  v_xor_b32 v33, 0xf149f2ca, v33
  v_xor_b32 v34, 0xf149f2ca, v34
  v_xor_b32 v35, 0xf149f2ca, v35
  v_xor_b32 v36, 0xf149f2ca, v36
  v_xor_b32 v37, 0xf149f2ca, v37
  v_xor_b32 v38, 0xf149f2ca, v38
  v_xor_b32 v39, 0xf149f2ca, v39
  v_xor_b32 v40, 0xf149f2ca, v40
  v_xor_b32 v41, 0xf149f2ca, v41
  v_xor_b32 v42, 0xf149f2ca, v42
  v_xor_b32 v43, 0xf149f2ca, v43
  v_xor_b32 v44, 0xf149f2ca, v44
  v_xor_b32 v45, 0xf149f2ca, v45
  v_xor_b32 v46, 0xf149f2ca, v46
  v_xor_b32 v47, 0xf149f2ca, v47
  s_nop 1
  v_mfma_f32_32x32x16_bf16 v[144:159], v[100:103], v[94:97], v[32:47]
  v_mfma_f32_32x32x8_bf16 v[144:159], v[104:105], v[98:99], v[144:159]
  s_nop 15
  v_max3_f32 v81, v144, v145, v81
  v_max3_f32 v81, v146, v147, v81
  v_max3_f32 v81, v148, v149, v81
  v_max3_f32 v81, v150, v151, v81
  v_max3_f32 v81, v152, v153, v81
  v_max3_f32 v81, v154, v155, v81
  v_max3_f32 v81, v156, v157, v81
  v_max3_f32 v81, v158, v159, v81
  s_branch L_tmn_29
L_tm1_26:
  v_mfma_f32_32x32x16_bf16 v[128:143], v[100:103], v[88:91], v[32:47]
  v_mfma_f32_32x32x8_bf16 v[128:143], v[104:105], v[92:93], v[128:143]
  v_mfma_f32_32x32x16_bf16 v[144:159], v[100:103], v[94:97], 0
  v_mfma_f32_32x32x8_bf16 v[144:159], v[104:105], v[98:99], v[144:159]
  s_nop 15
  v_max3_f32 v80, v128, v129, v80
  v_max3_f32 v80, v130, v131, v80
  v_max3_f32 v80, v132, v133, v80
  v_max3_f32 v80, v134, v135, v80
  v_max3_f32 v80, v136, v137, v80
  v_max3_f32 v80, v138, v139, v80
  v_max3_f32 v80, v140, v141, v80
  v_max3_f32 v80, v142, v143, v80
  s_nop 15
  v_max3_f32 v81, v144, v145, v81
  v_max3_f32 v81, v146, v147, v81
  v_max3_f32 v81, v148, v149, v81
  v_max3_f32 v81, v150, v151, v81
  v_max3_f32 v81, v152, v153, v81
  v_max3_f32 v81, v154, v155, v81
  v_max3_f32 v81, v156, v157, v81
  v_max3_f32 v81, v158, v159, v81
  v_xor_b32 v32, 0xf149f2ca, v32
  v_xor_b32 v33, 0xf149f2ca, v33
  v_xor_b32 v34, 0xf149f2ca, v34
  v_xor_b32 v35, 0xf149f2ca, v35
  v_xor_b32 v36, 0xf149f2ca, v36
  v_xor_b32 v37, 0xf149f2ca, v37
  v_xor_b32 v38, 0xf149f2ca, v38
  v_xor_b32 v39, 0xf149f2ca, v39
  v_xor_b32 v40, 0xf149f2ca, v40
  v_xor_b32 v41, 0xf149f2ca, v41
  v_xor_b32 v42, 0xf149f2ca, v42
  v_xor_b32 v43, 0xf149f2ca, v43
  v_xor_b32 v44, 0xf149f2ca, v44
  v_xor_b32 v45, 0xf149f2ca, v45
  v_xor_b32 v46, 0xf149f2ca, v46
  v_xor_b32 v47, 0xf149f2ca, v47
  s_branch L_tmn_29
L_tm8_27:
  v_mfma_f32_32x32x16_bf16 v[128:143], v[100:103], v[88:91], 0
  v_mfma_f32_32x32x8_bf16 v[128:143], v[104:105], v[92:93], v[128:143]
  v_mfma_f32_32x32x16_bf16 v[144:159], v[100:103], v[94:97], v[32:47]
  v_mfma_f32_32x32x8_bf16 v[144:159], v[104:105], v[98:99], v[144:159]
  s_nop 15
  v_max3_f32 v80, v128, v129, v80
  v_max3_f32 v80, v130, v131, v80
  v_max3_f32 v80, v132, v133, v80
  v_max3_f32 v80, v134, v135, v80
  v_max3_f32 v80, v136, v137, v80
  v_max3_f32 v80, v138, v139, v80
  v_max3_f32 v80, v140, v141, v80
  v_max3_f32 v80, v142, v143, v80
  s_nop 15
  v_max3_f32 v81, v144, v145, v81
  v_max3_f32 v81, v146, v147, v81
  v_max3_f32 v81, v148, v149, v81
  v_max3_f32 v81, v150, v151, v81
  v_max3_f32 v81, v152, v153, v81
  v_max3_f32 v81, v154, v155, v81
  v_max3_f32 v81, v156, v157, v81
  v_max3_f32 v81, v158, v159, v81
  s_branch L_tmn_29
L_tm9_28:
  v_mfma_f32_32x32x16_bf16 v[128:143], v[100:103], v[88:91], v[32:47]
  v_mfma_f32_32x32x8_bf16 v[128:143], v[104:105], v[92:93], v[128:143]
  s_nop 15
  v_max3_f32 v80, v128, v129, v80
  v_max3_f32 v80, v130, v131, v80
  v_max3_f32 v80, v132, v133, v80
  v_max3_f32 v80, v134, v135, v80
  v_max3_f32 v80, v136, v137, v80
  v_max3_f32 v80, v138, v139, v80
  v_max3_f32 v80, v140, v141, v80
  v_max3_f32 v80, v142, v143, v80
L_tmn_29:
  v_subrev_u32 v84, 1536, v84
  v_subrev_u32 v85, 1536, v85
  s_add_u32 s101, s101, 1
  s_cmp_le_u32 s101, s97
  s_cbranch_scc1 L_b_tm
  v_mov_b32 v82, v80
  s_nop 1
  v_permlane32_swap_b32 v80, v82
  v_max_f32 v80, v80, v82
  v_mov_b32 v82, v81
  s_nop 1
  v_permlane32_swap_b32 v81, v82
  v_max_f32 v81, v81, v82
  v_xor_b32 v32, 0xf149f2ca, v32
  v_xor_b32 v33, 0xf149f2ca, v33
  v_xor_b32 v34, 0xf149f2ca, v34
  v_xor_b32 v35, 0xf149f2ca, v35
  v_xor_b32 v36, 0xf149f2ca, v36
  v_xor_b32 v37, 0xf149f2ca, v37
  v_xor_b32 v38, 0xf149f2ca, v38
  v_xor_b32 v39, 0xf149f2ca, v39
  v_xor_b32 v40, 0xf149f2ca, v40
  v_xor_b32 v41, 0xf149f2ca, v41
  v_xor_b32 v42, 0xf149f2ca, v42
  v_xor_b32 v43, 0xf149f2ca, v43
  v_xor_b32 v44, 0xf149f2ca, v44
  v_xor_b32 v45, 0xf149f2ca, v45
  v_xor_b32 v46, 0xf149f2ca, v46
  v_xor_b32 v47, 0xf149f2ca, v47
  s_mul_i32 s56, s69, 1536
  s_mul_i32 s57, s68, 18432
  s_mul_i32 s58, s68, 6912
  v_lshrrev_b32 v86, 5, v1
  v_and_b32 v84, 31, v1
  v_mul_u32_u24 v84, 48, v84
  v_add_u32 v84, s56, v84
  v_lshl_add_u32 v87, v86, 3, v84
  v_add_u32 v87, s58, v87
  v_add_u32 v87, 74496, v87
  v_lshl_add_u32 v82, v86, 4, v84
  v_add_u32 v82, s58, v82
  v_add_u32 v82, 74496, v82
  v_add_u32 v84, s57, v84
  v_mul_u32_u24 v85, 36872, v86
  v_add_u32 v85, 13856, v85
  v_add_u32 v85, v85, v84
  v_lshl_add_u32 v84, v86, 4, v84
  v_add_u32 v84, 13824, v84
  v_bfe_u32 v83, v1, 2, 2
  v_lshl_add_u32 v86, v86, 2, v83
  v_mul_u32_u24 v86, 48, v86
  v_bfe_u32 v83, v1, 4, 1
  v_lshl_add_u32 v86, v83, 5, v86
  v_and_b32 v83, 3, v1
  v_lshl_add_u32 v86, v83, 3, v86
  s_add_u32 s56, s56, s57
  v_add_u32 v86, s56, v86
  v_add_u32 v86, 50688, v86
  ds_read_b128 v[100:103], v84
  ds_read_b64 v[104:105], v85
  s_waitcnt lgkmcnt(0)
  s_branch L_b_main
L_b_ok:
  v_mov_b32 v100, v168
  v_mov_b32 v102, v184
  v_mov_b32 v101, v168
  v_mov_b32 v103, v184
  s_nop 0
  v_permlane32_swap_b32 v100, v101
  v_permlane32_swap_b32 v102, v103
  v_rcp_f32 v101, v101
  v_rcp_f32 v103, v103
  v_pk_mul_f32 v[160:161], v[160:161], v[100:101] op_sel:[0,1] op_sel_hi:[1,1]
  v_pk_mul_f32 v[176:177], v[176:177], v[102:103] op_sel:[0,1] op_sel_hi:[1,1]
  v_pk_mul_f32 v[162:163], v[162:163], v[100:101] op_sel:[0,1] op_sel_hi:[1,1]
  v_pk_mul_f32 v[178:179], v[178:179], v[102:103] op_sel:[0,1] op_sel_hi:[1,1]
  v_pk_mul_f32 v[164:165], v[164:165], v[100:101] op_sel:[0,1] op_sel_hi:[1,1]
  v_pk_mul_f32 v[180:181], v[180:181], v[102:103] op_sel:[0,1] op_sel_hi:[1,1]
  v_pk_mul_f32 v[166:167], v[166:167], v[100:101] op_sel:[0,1] op_sel_hi:[1,1]
  v_pk_mul_f32 v[182:183], v[182:183], v[102:103] op_sel:[0,1] op_sel_hi:[1,1]
  v_pk_mul_f32 v[168:169], v[168:169], v[100:101] op_sel:[0,1] op_sel_hi:[1,1]
  v_pk_mul_f32 v[184:185], v[184:185], v[102:103] op_sel:[0,1] op_sel_hi:[1,1]
  v_pk_mul_f32 v[170:171], v[170:171], v[100:101] op_sel:[0,1] op_sel_hi:[1,1]
  v_pk_mul_f32 v[186:187], v[186:187], v[102:103] op_sel:[0,1] op_sel_hi:[1,1]
  v_cvt_pk_bf16_f32 v128, v160, v161
  v_cvt_pk_bf16_f32 v144, v176, v177
  v_cvt_pk_bf16_f32 v129, v162, v163
  v_cvt_pk_bf16_f32 v145, v178, v179
  v_cvt_pk_bf16_f32 v130, v164, v165
  v_cvt_pk_bf16_f32 v146, v180, v181
  v_cvt_pk_bf16_f32 v131, v166, v167
  v_cvt_pk_bf16_f32 v147, v182, v183
  v_cvt_pk_bf16_f32 v132, v168, v169
  v_cvt_pk_bf16_f32 v148, v184, v185
  v_cvt_pk_bf16_f32 v133, v170, v171
  v_cvt_pk_bf16_f32 v149, v186, v187
  ds_write_b64 v87, v[128:129] offset:0
  ds_write_b64 v87, v[144:145] offset:1536
  ds_write_b64 v87, v[130:131] offset:16
  ds_write_b64 v87, v[146:147] offset:1552
  s_mov_b32 exec_hi, 0
  ds_write_b64 v87, v[132:133] offset:32
  ds_write_b64 v87, v[148:149] offset:1568
  s_mov_b64 exec, -1
  s_waitcnt lgkmcnt(0)
  s_barrier
L_join:
  s_waitcnt lgkmcnt(0)
  ds_read_b64 v[88:89], v50
  ds_read_b64 v[90:91], v53
  ds_read_b64 v[92:93], v51
  ds_read_b64 v[94:95], v54
  ds_read_b64 v[96:97], v52
  ds_read_b64 v[98:99], v55
  s_lshl_b32 s56, s25, 3
  s_lshl_b32 s57, s24, 1
  s_add_u32 s56, s56, s57
  s_mul_i32 s56, s56, 20480
  s_mul_i32 s57, s26, 1280
  s_add_u32 s56, s56, s57
  s_add_u32 s56, s56, s84
  s_waitcnt lgkmcnt(0)
  s_cmp_eq_u32 s92, 1
  s_cbranch_scc0 L_hs_30
  buffer_store_dwordx4 v[88:91], v56, s[4:7], s56 offen
  buffer_store_dwordx4 v[92:95], v57, s[4:7], s56 offen
L_hd_31:
  s_mov_b32 exec_hi, 0
  s_cmp_eq_u32 s92, 1
  s_cbranch_scc0 L_hs_32
  buffer_store_dwordx4 v[96:99], v58, s[4:7], s56 offen
L_hd_33:
  s_mov_b64 exec, -1
  s_lshl_b32 s88, s27, 1
  s_sub_u32 s88, s88, 1
  s_waitcnt vmcnt(0)
  s_lshl_b32 s64, s25, 8
  s_add_u32 s64, s64, 0x3400000
  s_lshl_b32 s65, s26, 4
  s_add_u32 s64, s64, s65
  s_lshl_b32 s65, s24, 2
  s_add_u32 s64, s64, s65
  v_mov_b32 v78, s88
  v_mov_b32 v79, s64
  s_mov_b64 exec, 1
  s_cmp_eq_u32 s92, 1
  s_cbranch_scc0 L_hs_34
  buffer_store_dword v78, v79, s[4:7], 0 offen
L_hd_35:
  s_mov_b64 exec, -1
  s_mul_i32 s61, s24, 7168
  s_add_u32 s60, s86, s61
  s_add_u32 s60, s60, 73728
  s_add_u32 s62, s60, 4096
  s_add_u32 m0, s61, 0
  s_nop 0
  buffer_load_dwordx4 v2, s[4:7], s60 offen offset:0 lds
  buffer_load_dwordx4 v2, s[4:7], s60 offen offset:1024 lds
  buffer_load_dwordx4 v2, s[4:7], s60 offen offset:2048 lds
  buffer_load_dwordx4 v2, s[4:7], s60 offen offset:3072 lds
  s_add_u32 m0, s61, 4096
  s_nop 0
  buffer_load_dwordx4 v2, s[4:7], s62 offen offset:0 lds
  buffer_load_dwordx4 v2, s[4:7], s62 offen offset:1024 lds
  buffer_load_dwordx4 v2, s[4:7], s62 offen offset:2048 lds
  v_lshlrev_b32 v88, 16, v22
  v_and_b32 v89, 0xffff0000, v22
  v_lshlrev_b32 v90, 16, v23
  v_and_b32 v91, 0xffff0000, v23
  v_lshlrev_b32 v92, 16, v24
  v_and_b32 v93, 0xffff0000, v24
  v_lshlrev_b32 v94, 16, v25
  v_and_b32 v95, 0xffff0000, v25
  v_lshlrev_b32 v96, 16, v26
  v_and_b32 v97, 0xffff0000, v26
  v_lshlrev_b32 v98, 16, v27
  v_and_b32 v99, 0xffff0000, v27
  v_lshlrev_b32 v100, 16, v28
  v_and_b32 v101, 0xffff0000, v28
  v_lshlrev_b32 v102, 16, v29
  v_and_b32 v103, 0xffff0000, v29
  v_lshlrev_b32 v104, 16, v30
  v_and_b32 v105, 0xffff0000, v30
  v_lshlrev_b32 v106, 16, v31
  v_and_b32 v107, 0xffff0000, v31
  v_add_u32 v80, 87552, v2
  v_add_u32 v81, 153088, v2
  s_lshl_b32 s56, s25, 8
  s_add_u32 s56, s56, 0x3400000
  v_lshlrev_b32 v79, 2, v1
  v_add_u32 v79, s56, v79
  s_mov_b32 exec_lo, 0xffffffff
  s_mov_b32 exec_hi, 0xffffffff
  s_mov_b32 s95, 0
L_poll_36:
  buffer_load_dword v78, v79, s[4:7], 0 offen sc1
  s_waitcnt vmcnt(0)
  v_cmp_le_u32 vcc, s88, v78
  s_nop 1
  s_nop 0
  s_cmp_eq_u64 vcc, exec
  s_cbranch_scc1 L_pd_37
  s_add_u32 s95, s95, 1
  s_cmp_lt_u32 s95, 0x20000
  s_cbranch_scc1 L_poll_36
L_pd_37:
  s_mov_b64 exec, -1
  s_mul_i32 s56, s90, 20480
  s_add_u32 s56, s56, s84
  s_add_u32 s57, s56, 0
  buffer_load_dwordx4 v[156:159], v2, s[4:7], s57 offen offset:0 sc1
  s_add_u32 s57, s56, 0
  buffer_load_dwordx4 v[160:163], v2, s[4:7], s57 offen offset:1024 sc1
  s_add_u32 s57, s56, 0
  buffer_load_dwordx4 v[164:167], v2, s[4:7], s57 offen offset:2048 sc1
  s_add_u32 s57, s56, 0
  buffer_load_dwordx4 v[168:171], v2, s[4:7], s57 offen offset:3072 sc1
  s_add_u32 s57, s56, 4096
  buffer_load_dwordx4 v[172:175], v2, s[4:7], s57 offen offset:0 sc1
  s_add_u32 s57, s56, 4096
  buffer_load_dwordx4 v[176:179], v2, s[4:7], s57 offen offset:1024 sc1
  s_add_u32 s57, s56, 4096
  buffer_load_dwordx4 v[180:183], v2, s[4:7], s57 offen offset:2048 sc1
  s_add_u32 s57, s56, 4096
  buffer_load_dwordx4 v[184:187], v2, s[4:7], s57 offen offset:3072 sc1
  s_add_u32 s57, s56, 8192
  buffer_load_dwordx4 v[188:191], v2, s[4:7], s57 offen offset:0 sc1
  s_barrier
  ds_read_b128 v[108:111], v80 offset:0
  ds_read_b128 v[112:115], v80 offset:1024
  ds_read_b128 v[116:119], v80 offset:2048
  ds_read_b128 v[120:123], v80 offset:3072
  ds_read_b128 v[124:127], v80 offset:4096
  ds_read_b128 v[128:131], v80 offset:5120
  ds_read_b128 v[132:135], v80 offset:6144
  ds_read_b128 v[136:139], v80 offset:7168
  ds_read_b128 v[140:143], v80 offset:8192
  ds_read_b128 v[144:147], v80 offset:9216
  ds_read_b128 v[148:151], v80 offset:10240
  s_waitcnt vmcnt(8) lgkmcnt(9)
  v_mfma_f32_16x16x32_bf16 v[88:91], v[108:111], v[156:159], v[88:91]
  ds_read_b128 v[152:155], v80 offset:11264
  v_mfma_f32_16x16x32_bf16 v[92:95], v[112:115], v[156:159], v[92:95]
  ds_read_b128 v[108:111], v80 offset:12288
  s_waitcnt lgkmcnt(9)
  v_mfma_f32_16x16x32_bf16 v[96:99], v[116:119], v[156:159], v[96:99]
  ds_read_b128 v[112:115], v80 offset:13312
  v_mfma_f32_16x16x32_bf16 v[100:103], v[120:123], v[156:159], v[100:103]
  ds_read_b128 v[116:119], v80 offset:14336
  s_waitcnt lgkmcnt(9)
  v_mfma_f32_16x16x32_bf16 v[104:107], v[124:127], v[156:159], v[104:107]
  ds_read_b128 v[120:123], v80 offset:15360
  s_add_u32 s57, s56, 8192
  buffer_load_dwordx4 v[156:159], v2, s[4:7], s57 offen offset:1024 sc1
  s_waitcnt vmcnt(8)
  v_mfma_f32_16x16x32_bf16 v[88:91], v[128:131], v[160:163], v[88:91]
  ds_read_b128 v[124:127], v80 offset:16384
  s_waitcnt lgkmcnt(9)
  v_mfma_f32_16x16x32_bf16 v[92:95], v[132:135], v[160:163], v[92:95]
  ds_read_b128 v[128:131], v80 offset:17408
  v_mfma_f32_16x16x32_bf16 v[96:99], v[136:139], v[160:163], v[96:99]
  ds_read_b128 v[132:135], v80 offset:18432
  s_waitcnt lgkmcnt(9)
  v_mfma_f32_16x16x32_bf16 v[100:103], v[140:143], v[160:163], v[100:103]
  ds_read_b128 v[136:139], v80 offset:19456
  v_mfma_f32_16x16x32_bf16 v[104:107], v[144:147], v[160:163], v[104:107]
  ds_read_b128 v[140:143], v80 offset:20480
  s_add_u32 s57, s56, 8192
  buffer_load_dwordx4 v[160:163], v2, s[4:7], s57 offen offset:2048 sc1
  s_waitcnt vmcnt(8) lgkmcnt(9)
  v_mfma_f32_16x16x32_bf16 v[88:91], v[148:151], v[164:167], v[88:91]
  ds_read_b128 v[144:147], v80 offset:21504
  v_mfma_f32_16x16x32_bf16 v[92:95], v[152:155], v[164:167], v[92:95]
  ds_read_b128 v[148:151], v80 offset:22528
  s_waitcnt lgkmcnt(9)
  v_mfma_f32_16x16x32_bf16 v[96:99], v[108:111], v[164:167], v[96:99]
  ds_read_b128 v[152:155], v80 offset:23552
  v_mfma_f32_16x16x32_bf16 v[100:103], v[112:115], v[164:167], v[100:103]
  ds_read_b128 v[108:111], v80 offset:24576
  s_waitcnt lgkmcnt(9)
  v_mfma_f32_16x16x32_bf16 v[104:107], v[116:119], v[164:167], v[104:107]
  ds_read_b128 v[112:115], v80 offset:25600
  s_add_u32 s57, s56, 8192
  buffer_load_dwordx4 v[164:167], v2, s[4:7], s57 offen offset:3072 sc1
  s_waitcnt vmcnt(8)
  v_mfma_f32_16x16x32_bf16 v[88:91], v[120:123], v[168:171], v[88:91]
  ds_read_b128 v[116:119], v80 offset:26624
  s_waitcnt lgkmcnt(9)
  v_mfma_f32_16x16x32_bf16 v[92:95], v[124:127], v[168:171], v[92:95]
  ds_read_b128 v[120:123], v80 offset:27648
  v_mfma_f32_16x16x32_bf16 v[96:99], v[128:131], v[168:171], v[96:99]
  ds_read_b128 v[124:127], v80 offset:28672
  s_waitcnt lgkmcnt(9)
  v_mfma_f32_16x16x32_bf16 v[100:103], v[132:135], v[168:171], v[100:103]
  ds_read_b128 v[128:131], v80 offset:29696
  v_mfma_f32_16x16x32_bf16 v[104:107], v[136:139], v[168:171], v[104:107]
  ds_read_b128 v[132:135], v80 offset:30720
  s_add_u32 s57, s56, 12288
  buffer_load_dwordx4 v[168:171], v2, s[4:7], s57 offen offset:0 sc1
  s_waitcnt vmcnt(8) lgkmcnt(9)
  v_mfma_f32_16x16x32_bf16 v[88:91], v[140:143], v[172:175], v[88:91]
  ds_read_b128 v[136:139], v80 offset:31744
  v_mfma_f32_16x16x32_bf16 v[92:95], v[144:147], v[172:175], v[92:95]
  ds_read_b128 v[140:143], v80 offset:32768
  s_waitcnt lgkmcnt(9)
  v_mfma_f32_16x16x32_bf16 v[96:99], v[148:151], v[172:175], v[96:99]
  ds_read_b128 v[144:147], v80 offset:33792
  v_mfma_f32_16x16x32_bf16 v[100:103], v[152:155], v[172:175], v[100:103]
  ds_read_b128 v[148:151], v80 offset:34816
  s_waitcnt lgkmcnt(9)
  v_mfma_f32_16x16x32_bf16 v[104:107], v[108:111], v[172:175], v[104:107]
  ds_read_b128 v[152:155], v80 offset:35840
  s_add_u32 s57, s56, 12288
  buffer_load_dwordx4 v[172:175], v2, s[4:7], s57 offen offset:1024 sc1
  s_waitcnt vmcnt(8)
  v_mfma_f32_16x16x32_bf16 v[88:91], v[112:115], v[176:179], v[88:91]
  ds_read_b128 v[108:111], v80 offset:36864
  s_waitcnt lgkmcnt(9)
  v_mfma_f32_16x16x32_bf16 v[92:95], v[116:119], v[176:179], v[92:95]
  ds_read_b128 v[112:115], v80 offset:37888
  v_mfma_f32_16x16x32_bf16 v[96:99], v[120:123], v[176:179], v[96:99]
  ds_read_b128 v[116:119], v80 offset:38912
  s_waitcnt lgkmcnt(9)
  v_mfma_f32_16x16x32_bf16 v[100:103], v[124:127], v[176:179], v[100:103]
  ds_read_b128 v[120:123], v80 offset:39936
  v_mfma_f32_16x16x32_bf16 v[104:107], v[128:131], v[176:179], v[104:107]
  ds_read_b128 v[124:127], v80 offset:40960
  s_add_u32 s57, s56, 12288
  buffer_load_dwordx4 v[176:179], v2, s[4:7], s57 offen offset:2048 sc1
  s_waitcnt vmcnt(8) lgkmcnt(9)
  v_mfma_f32_16x16x32_bf16 v[88:91], v[132:135], v[180:183], v[88:91]
  ds_read_b128 v[128:131], v80 offset:41984
  v_mfma_f32_16x16x32_bf16 v[92:95], v[136:139], v[180:183], v[92:95]
  ds_read_b128 v[132:135], v80 offset:43008
  s_waitcnt lgkmcnt(9)
  v_mfma_f32_16x16x32_bf16 v[96:99], v[140:143], v[180:183], v[96:99]
  ds_read_b128 v[136:139], v80 offset:44032
  v_mfma_f32_16x16x32_bf16 v[100:103], v[144:147], v[180:183], v[100:103]
  ds_read_b128 v[140:143], v80 offset:45056
  s_waitcnt lgkmcnt(9)
  v_mfma_f32_16x16x32_bf16 v[104:107], v[148:151], v[180:183], v[104:107]
  ds_read_b128 v[144:147], v80 offset:46080
  s_add_u32 s57, s56, 12288
  buffer_load_dwordx4 v[180:183], v2, s[4:7], s57 offen offset:3072 sc1
  s_waitcnt vmcnt(8)
  v_mfma_f32_16x16x32_bf16 v[88:91], v[152:155], v[184:187], v[88:91]
  ds_read_b128 v[148:151], v80 offset:47104
  s_waitcnt lgkmcnt(9)
  v_mfma_f32_16x16x32_bf16 v[92:95], v[108:111], v[184:187], v[92:95]
  ds_read_b128 v[152:155], v80 offset:48128
  v_mfma_f32_16x16x32_bf16 v[96:99], v[112:115], v[184:187], v[96:99]
  ds_read_b128 v[108:111], v80 offset:49152
  s_waitcnt lgkmcnt(9)
  v_mfma_f32_16x16x32_bf16 v[100:103], v[116:119], v[184:187], v[100:103]
  ds_read_b128 v[112:115], v80 offset:50176
  v_mfma_f32_16x16x32_bf16 v[104:107], v[120:123], v[184:187], v[104:107]
  ds_read_b128 v[116:119], v80 offset:51200
  s_add_u32 s57, s56, 16384
  buffer_load_dwordx4 v[184:187], v2, s[4:7], s57 offen offset:0 sc1
  s_waitcnt vmcnt(8) lgkmcnt(9)
  v_mfma_f32_16x16x32_bf16 v[88:91], v[124:127], v[188:191], v[88:91]
  ds_read_b128 v[120:123], v80 offset:52224
  v_mfma_f32_16x16x32_bf16 v[92:95], v[128:131], v[188:191], v[92:95]
  ds_read_b128 v[124:127], v80 offset:53248
  s_waitcnt lgkmcnt(9)
  v_mfma_f32_16x16x32_bf16 v[96:99], v[132:135], v[188:191], v[96:99]
  ds_read_b128 v[128:131], v80 offset:54272
  v_mfma_f32_16x16x32_bf16 v[100:103], v[136:139], v[188:191], v[100:103]
  ds_read_b128 v[132:135], v80 offset:55296
  s_waitcnt lgkmcnt(9)
  v_mfma_f32_16x16x32_bf16 v[104:107], v[140:143], v[188:191], v[104:107]
  ds_read_b128 v[136:139], v80 offset:56320
  s_add_u32 s57, s56, 16384
  buffer_load_dwordx4 v[188:191], v2, s[4:7], s57 offen offset:1024 sc1
  s_waitcnt vmcnt(8)
  v_mfma_f32_16x16x32_bf16 v[88:91], v[144:147], v[156:159], v[88:91]
  ds_read_b128 v[140:143], v80 offset:57344
  s_waitcnt lgkmcnt(9)
  v_mfma_f32_16x16x32_bf16 v[92:95], v[148:151], v[156:159], v[92:95]
  ds_read_b128 v[144:147], v80 offset:58368
  v_mfma_f32_16x16x32_bf16 v[96:99], v[152:155], v[156:159], v[96:99]
  ds_read_b128 v[148:151], v80 offset:59392
  s_waitcnt lgkmcnt(9)
  v_mfma_f32_16x16x32_bf16 v[100:103], v[108:111], v[156:159], v[100:103]
  ds_read_b128 v[152:155], v80 offset:60416
  v_mfma_f32_16x16x32_bf16 v[104:107], v[112:115], v[156:159], v[104:107]
  ds_read_b128 v[108:111], v80 offset:61440
  s_add_u32 s57, s56, 16384
  buffer_load_dwordx4 v[156:159], v2, s[4:7], s57 offen offset:2048 sc1
  s_waitcnt vmcnt(8) lgkmcnt(9)
  v_mfma_f32_16x16x32_bf16 v[88:91], v[116:119], v[160:163], v[88:91]
  ds_read_b128 v[112:115], v80 offset:62464
  v_mfma_f32_16x16x32_bf16 v[92:95], v[120:123], v[160:163], v[92:95]
  ds_read_b128 v[116:119], v80 offset:63488
  s_waitcnt lgkmcnt(9)
  v_mfma_f32_16x16x32_bf16 v[96:99], v[124:127], v[160:163], v[96:99]
  ds_read_b128 v[120:123], v80 offset:64512
  v_mfma_f32_16x16x32_bf16 v[100:103], v[128:131], v[160:163], v[100:103]
  ds_read_b128 v[124:127], v81 offset:0
  s_waitcnt lgkmcnt(9)
  v_mfma_f32_16x16x32_bf16 v[104:107], v[132:135], v[160:163], v[104:107]
  ds_read_b128 v[128:131], v81 offset:1024
  s_add_u32 s57, s56, 16384
  buffer_load_dwordx4 v[160:163], v2, s[4:7], s57 offen offset:3072 sc1
  s_waitcnt vmcnt(8)
  v_mfma_f32_16x16x32_bf16 v[88:91], v[136:139], v[164:167], v[88:91]
  ds_read_b128 v[132:135], v81 offset:2048
  s_waitcnt lgkmcnt(9)
  v_mfma_f32_16x16x32_bf16 v[92:95], v[140:143], v[164:167], v[92:95]
  ds_read_b128 v[136:139], v81 offset:3072
  v_mfma_f32_16x16x32_bf16 v[96:99], v[144:147], v[164:167], v[96:99]
  ds_read_b128 v[140:143], v81 offset:4096
  s_waitcnt lgkmcnt(9)
  v_mfma_f32_16x16x32_bf16 v[100:103], v[148:151], v[164:167], v[100:103]
  ds_read_b128 v[144:147], v81 offset:5120
  v_mfma_f32_16x16x32_bf16 v[104:107], v[152:155], v[164:167], v[104:107]
  ds_read_b128 v[148:151], v81 offset:6144
  s_waitcnt vmcnt(7) lgkmcnt(9)
  v_mfma_f32_16x16x32_bf16 v[88:91], v[108:111], v[168:171], v[88:91]
  ds_read_b128 v[152:155], v81 offset:7168
  v_mfma_f32_16x16x32_bf16 v[92:95], v[112:115], v[168:171], v[92:95]
  ds_read_b128 v[108:111], v2 offset:0
  s_waitcnt lgkmcnt(9)
  v_mfma_f32_16x16x32_bf16 v[96:99], v[116:119], v[168:171], v[96:99]
  ds_read_b128 v[112:115], v2 offset:1024
  v_mfma_f32_16x16x32_bf16 v[100:103], v[120:123], v[168:171], v[100:103]
  ds_read_b128 v[116:119], v2 offset:2048
  s_waitcnt lgkmcnt(9)
  v_mfma_f32_16x16x32_bf16 v[104:107], v[124:127], v[168:171], v[104:107]
  ds_read_b128 v[120:123], v2 offset:3072
  s_waitcnt vmcnt(6)
  v_mfma_f32_16x16x32_bf16 v[88:91], v[128:131], v[172:175], v[88:91]
  ds_read_b128 v[124:127], v2 offset:4096
  s_waitcnt lgkmcnt(9)
  v_mfma_f32_16x16x32_bf16 v[92:95], v[132:135], v[172:175], v[92:95]
  ds_read_b128 v[128:131], v2 offset:5120
  v_mfma_f32_16x16x32_bf16 v[96:99], v[136:139], v[172:175], v[96:99]
  ds_read_b128 v[132:135], v2 offset:6144
  s_waitcnt lgkmcnt(9)
  v_mfma_f32_16x16x32_bf16 v[100:103], v[140:143], v[172:175], v[100:103]
  ds_read_b128 v[136:139], v2 offset:7168
  v_mfma_f32_16x16x32_bf16 v[104:107], v[144:147], v[172:175], v[104:107]
  ds_read_b128 v[140:143], v2 offset:8192
  s_waitcnt vmcnt(5) lgkmcnt(9)
  v_mfma_f32_16x16x32_bf16 v[88:91], v[148:151], v[176:179], v[88:91]
  ds_read_b128 v[144:147], v2 offset:9216
  v_mfma_f32_16x16x32_bf16 v[92:95], v[152:155], v[176:179], v[92:95]
  ds_read_b128 v[148:151], v2 offset:10240
  s_waitcnt lgkmcnt(9)
  v_mfma_f32_16x16x32_bf16 v[96:99], v[108:111], v[176:179], v[96:99]
  ds_read_b128 v[152:155], v2 offset:11264
  v_mfma_f32_16x16x32_bf16 v[100:103], v[112:115], v[176:179], v[100:103]
  ds_read_b128 v[108:111], v2 offset:12288
  s_waitcnt lgkmcnt(9)
  v_mfma_f32_16x16x32_bf16 v[104:107], v[116:119], v[176:179], v[104:107]
  ds_read_b128 v[112:115], v2 offset:13312
  s_waitcnt vmcnt(4)
  v_mfma_f32_16x16x32_bf16 v[88:91], v[120:123], v[180:183], v[88:91]
  ds_read_b128 v[116:119], v2 offset:14336
  s_waitcnt lgkmcnt(9)
  v_mfma_f32_16x16x32_bf16 v[92:95], v[124:127], v[180:183], v[92:95]
  ds_read_b128 v[120:123], v2 offset:15360
  v_mfma_f32_16x16x32_bf16 v[96:99], v[128:131], v[180:183], v[96:99]
  ds_read_b128 v[124:127], v2 offset:16384
  s_waitcnt lgkmcnt(9)
  v_mfma_f32_16x16x32_bf16 v[100:103], v[132:135], v[180:183], v[100:103]
  ds_read_b128 v[128:131], v2 offset:17408
  v_mfma_f32_16x16x32_bf16 v[104:107], v[136:139], v[180:183], v[104:107]
  ds_read_b128 v[132:135], v2 offset:18432
  s_waitcnt vmcnt(3) lgkmcnt(9)
  v_mfma_f32_16x16x32_bf16 v[88:91], v[140:143], v[184:187], v[88:91]
  ds_read_b128 v[136:139], v2 offset:19456
  v_mfma_f32_16x16x32_bf16 v[92:95], v[144:147], v[184:187], v[92:95]
  ds_read_b128 v[140:143], v2 offset:20480
  s_waitcnt lgkmcnt(9)
  v_mfma_f32_16x16x32_bf16 v[96:99], v[148:151], v[184:187], v[96:99]
  ds_read_b128 v[144:147], v2 offset:21504
  v_mfma_f32_16x16x32_bf16 v[100:103], v[152:155], v[184:187], v[100:103]
  ds_read_b128 v[148:151], v2 offset:22528
  s_waitcnt lgkmcnt(9)
  v_mfma_f32_16x16x32_bf16 v[104:107], v[108:111], v[184:187], v[104:107]
  ds_read_b128 v[152:155], v2 offset:23552
  s_waitcnt vmcnt(2)
  v_mfma_f32_16x16x32_bf16 v[88:91], v[112:115], v[188:191], v[88:91]
  ds_read_b128 v[108:111], v2 offset:24576
  s_waitcnt lgkmcnt(9)
  v_mfma_f32_16x16x32_bf16 v[92:95], v[116:119], v[188:191], v[92:95]
  ds_read_b128 v[112:115], v2 offset:25600
  v_mfma_f32_16x16x32_bf16 v[96:99], v[120:123], v[188:191], v[96:99]
  ds_read_b128 v[116:119], v2 offset:26624
  s_waitcnt lgkmcnt(9)
  v_mfma_f32_16x16x32_bf16 v[100:103], v[124:127], v[188:191], v[100:103]
  ds_read_b128 v[120:123], v2 offset:27648
  v_mfma_f32_16x16x32_bf16 v[104:107], v[128:131], v[188:191], v[104:107]
  s_waitcnt vmcnt(1) lgkmcnt(8)
  v_mfma_f32_16x16x32_bf16 v[88:91], v[132:135], v[156:159], v[88:91]
  v_mfma_f32_16x16x32_bf16 v[92:95], v[136:139], v[156:159], v[92:95]
  s_waitcnt lgkmcnt(6)
  v_mfma_f32_16x16x32_bf16 v[96:99], v[140:143], v[156:159], v[96:99]
  v_mfma_f32_16x16x32_bf16 v[100:103], v[144:147], v[156:159], v[100:103]
  s_waitcnt lgkmcnt(4)
  v_mfma_f32_16x16x32_bf16 v[104:107], v[148:151], v[156:159], v[104:107]
  s_waitcnt vmcnt(0)
  v_mfma_f32_16x16x32_bf16 v[88:91], v[152:155], v[160:163], v[88:91]
  s_waitcnt lgkmcnt(2)
  v_mfma_f32_16x16x32_bf16 v[92:95], v[108:111], v[160:163], v[92:95]
  v_mfma_f32_16x16x32_bf16 v[96:99], v[112:115], v[160:163], v[96:99]
  s_waitcnt lgkmcnt(0)
  v_mfma_f32_16x16x32_bf16 v[100:103], v[116:119], v[160:163], v[100:103]
  v_mfma_f32_16x16x32_bf16 v[104:107], v[120:123], v[160:163], v[104:107]
  s_barrier
  s_nop 0
  v_cvt_pk_bf16_f32 v22, v88, v89
  v_pk_mul_f32 v[118:119], v[88:89], v[88:89]
  v_cvt_pk_bf16_f32 v23, v90, v91
  v_pk_fma_f32 v[118:119], v[90:91], v[90:91], v[118:119]
  v_cvt_pk_bf16_f32 v24, v92, v93
  v_pk_add_f32 v[116:117], v[90:91], v[88:89]
  v_cvt_pk_bf16_f32 v25, v94, v95
  v_pk_fma_f32 v[118:119], v[92:93], v[92:93], v[118:119]
  v_cvt_pk_bf16_f32 v26, v96, v97
  v_pk_add_f32 v[116:117], v[92:93], v[116:117]
  v_cvt_pk_bf16_f32 v27, v98, v99
  v_pk_fma_f32 v[118:119], v[94:95], v[94:95], v[118:119]
  v_cvt_pk_bf16_f32 v28, v100, v101
  v_pk_add_f32 v[116:117], v[94:95], v[116:117]
  v_cvt_pk_bf16_f32 v29, v102, v103
  v_pk_fma_f32 v[118:119], v[96:97], v[96:97], v[118:119]
  v_cvt_pk_bf16_f32 v30, v104, v105
  v_pk_add_f32 v[116:117], v[96:97], v[116:117]
  v_cvt_pk_bf16_f32 v31, v106, v107
  v_pk_fma_f32 v[118:119], v[98:99], v[98:99], v[118:119]
  v_pk_add_f32 v[116:117], v[98:99], v[116:117]
  v_pk_fma_f32 v[118:119], v[100:101], v[100:101], v[118:119]
  v_pk_add_f32 v[116:117], v[100:101], v[116:117]
  v_pk_fma_f32 v[118:119], v[102:103], v[102:103], v[118:119]
  v_pk_add_f32 v[116:117], v[102:103], v[116:117]
  v_pk_fma_f32 v[118:119], v[104:105], v[104:105], v[118:119]
  v_pk_add_f32 v[116:117], v[104:105], v[116:117]
  v_pk_fma_f32 v[118:119], v[106:107], v[106:107], v[118:119]
  v_pk_add_f32 v[116:117], v[106:107], v[116:117]
  v_add_f32 v112, v116, v117
  v_add_f32 v113, v118, v119
  s_cmp_eq_u32 s27, 4
  s_cbranch_scc1 L_fin_38
  s_mul_i32 s56, s90, 20480
  s_add_u32 s56, s56, s82
  s_mul_i32 s59, s25, 20480
  s_add_u32 s59, s59, 0x3200000
  s_cmp_eq_u32 s92, 1
  s_cbranch_scc0 L_hs_40
  buffer_store_dwordx2 v[22:23], v66, s[12:15], s56 offen offset:0
  buffer_store_dwordx2 v[24:25], v66, s[12:15], s56 offen offset:512
  buffer_store_dwordx2 v[26:27], v66, s[12:15], s56 offen offset:1024
  buffer_store_dwordx2 v[28:29], v66, s[12:15], s56 offen offset:1536
  buffer_store_dwordx2 v[30:31], v66, s[12:15], s56 offen offset:2048
L_hd_41:
  v_mov_b32 v114, v112
  v_mov_b32 v115, v113
  s_nop 0
  v_permlane16_swap_b32 v112, v114
  v_permlane16_swap_b32 v113, v115
  v_add_f32 v112, v112, v114
  v_add_f32 v113, v113, v115
  v_mov_b32 v114, v112
  v_mov_b32 v115, v113
  s_nop 0
  v_permlane32_swap_b32 v112, v114
  v_permlane32_swap_b32 v113, v115
  v_add_f32 v112, v112, v114
  v_add_f32 v113, v113, v115
  s_lshl_b32 s56, s90, 10
  s_add_u32 s56, s56, s83
  s_mov_b64 exec, 0xffff
  s_cmp_eq_u32 s92, 1
  s_cbranch_scc0 L_hs_42
  buffer_store_dwordx2 v[112:113], v68, s[4:7], s56 offen
L_hd_43:
  s_mov_b64 exec, -1
  s_branch L_p3d_39
L_fin_38:
  s_mul_i32 s56, s24, 2560
  v_mul_u32_u24 v128, 160, v3
  v_lshl_add_u32 v128, v4, 3, v128
  v_add_u32 v128, s56, v128
  ds_write_b64 v128, v[22:23] offset:0
  ds_write_b64 v128, v[24:25] offset:32
  ds_write_b64 v128, v[26:27] offset:64
  ds_write_b64 v128, v[28:29] offset:96
  ds_write_b64 v128, v[30:31] offset:128
  s_lshl_b32 s57, s90, 4
  s_mul_i32 s57, s57, 1280
  s_and_b32 s58, s26, 7
  s_mul_i32 s58, s58, 160
  s_add_u32 s57, s57, s58
  v_add_u32 v129, 0, v1
  v_mul_u32_u24 v130, 6554, v129
  v_lshrrev_b32 v130, 16, v130
  v_mul_u32_u24 v131, 10, v130
  v_sub_u32 v131, v129, v131
  v_lshlrev_b32 v131, 4, v131
  v_mul_u32_u24 v132, 160, v130
  v_add_u32 v132, v132, v131
  v_add_u32 v132, s56, v132
  v_mul_u32_u24 v133, 1280, v130
  v_add_u32 v133, v133, v131
  v_add_u32 v129, 64, v1
  v_mul_u32_u24 v130, 6554, v129
  v_lshrrev_b32 v130, 16, v130
  v_mul_u32_u24 v131, 10, v130
  v_sub_u32 v131, v129, v131
  v_lshlrev_b32 v131, 4, v131
  v_mul_u32_u24 v134, 160, v130
  v_add_u32 v134, v134, v131
  v_add_u32 v134, s56, v134
  v_mul_u32_u24 v135, 1280, v130
  v_add_u32 v135, v135, v131
  v_add_u32 v129, 128, v1
  v_mul_u32_u24 v130, 6554, v129
  v_lshrrev_b32 v130, 16, v130
  v_mul_u32_u24 v131, 10, v130
  v_sub_u32 v131, v129, v131
  v_lshlrev_b32 v131, 4, v131
  v_mul_u32_u24 v136, 160, v130
  v_add_u32 v136, v136, v131
  v_add_u32 v136, s56, v136
  v_mul_u32_u24 v137, 1280, v130
  v_add_u32 v137, v137, v131
  s_waitcnt lgkmcnt(0)
  ds_read_b128 v[140:143], v132
  ds_read_b128 v[144:147], v134
  ds_read_b128 v[148:151], v136
  s_waitcnt lgkmcnt(2)
  buffer_store_dwordx4 v[140:143], v133, s[12:15], s57 offen
  s_waitcnt lgkmcnt(1)
  buffer_store_dwordx4 v[144:147], v135, s[12:15], s57 offen
  s_mov_b32 exec_hi, 0
  s_waitcnt lgkmcnt(0)
  buffer_store_dwordx4 v[148:151], v137, s[12:15], s57 offen
  s_mov_b64 exec, -1
L_p3d_39:
  s_cmp_eq_u32 s27, 4
  s_cbranch_scc1 L_fin_all
  s_mov_b32 s96, s93
  s_add_u32 s27, s27, 1
  s_and_b32 s89, s27, 1
  s_xor_b32 s89, s89, 1
  s_mov_b32 s82, 0x0
  s_cmp_eq_u32 s27, 3
  s_cselect_b32 s82, 0x0, s82
  s_cmp_eq_u32 s27, 4
  s_cselect_b32 s82, 0x0, s82
  s_mov_b32 s83, 0x3100000
  s_cmp_eq_u32 s27, 3
  s_cselect_b32 s83, 0x3100000, s83
  s_cmp_eq_u32 s27, 4
  s_cselect_b32 s83, 0x0, s83
  s_mov_b32 s84, 0x1000000
  s_cmp_eq_u32 s27, 3
  s_cselect_b32 s84, 0x1000000, s84
  s_cmp_eq_u32 s27, 4
  s_cselect_b32 s84, 0x1000000, s84
  s_mov_b32 s87, 0x2000000
  s_cmp_eq_u32 s27, 3
  s_cselect_b32 s87, 0x0, s87
  s_cmp_eq_u32 s27, 4
  s_cselect_b32 s87, 0x2800000, s87
  s_mov_b32 s86, 0x4700000
  s_cmp_eq_u32 s27, 3
  s_cselect_b32 s86, 0x4600000, s86
  s_cmp_eq_u32 s27, 4
  s_cselect_b32 s86, 0x4700000, s86
  s_and_b32 s56, s26, 7
  s_mul_i32 s56, s56, 102400
  s_add_u32 s86, s86, s56
  s_mul_i32 s56, s24, 18432
  s_add_u32 s94, s86, s56
  s_add_u32 s100, s56, 87552
  s_cmp_eq_u32 s27, 2
  s_cselect_b32 s56, 1, 0
  s_cmp_eq_u32 s24, 3
  s_cselect_b32 s56, s56, 0
  s_cmp_ge_u32 s26, 8
  s_cselect_b32 s93, s56, 0
  s_mov_b32 s8, s12
  s_mov_b32 s9, s13
  s_mov_b32 s10, 0x280000
  s_mov_b32 s11, 0x20000
  s_mov_b32 s54, 0x3100000
  s_cmp_eq_u32 s27, 3
  s_cselect_b32 s54, 0x3100000, s54
  s_cmp_eq_u32 s27, 4
  s_cselect_b32 s54, 0x3100000, s54
  s_lshl_b32 s56, s25, 13
  s_add_u32 s54, s54, s56
  s_max_u32 s56, s25, 1
  s_sub_u32 s56, s56, 1
  s_lshl_b32 s55, s56, 10
  s_add_u32 s55, s55, 0x3280000
  s_mul_i32 s53, s56, 20480
  s_add_u32 s53, s53, 0x3200000
  s_lshl_b32 s56, s25, 3
  s_lshl_b32 s57, s24, 1
  s_add_u32 s57, s57, s56
  s_mul_i32 s46, s57, 20480
  s_add_u32 s48, s46, 20480
  s_lshl_b32 s52, s24, 12
  s_lshl_b32 s88, s27, 1
  s_sub_u32 s88, s88, 2
  s_waitcnt vmcnt(0)
  s_lshl_b32 s64, s25, 8
  s_add_u32 s64, s64, 0x3400000
  s_lshl_b32 s65, s26, 4
  s_add_u32 s64, s64, s65
  s_lshl_b32 s65, s24, 2
  s_add_u32 s64, s64, s65
  v_mov_b32 v96, s88
  v_mov_b32 v97, s64
  s_mov_b64 exec, 1
  s_cmp_eq_u32 s92, 1
  s_cbranch_scc0 L_hs_44
  buffer_store_dword v96, v97, s[4:7], 0 offen
L_hd_45:
  s_mov_b64 exec, -1
  s_cmp_eq_u32 s96, 1
  s_cbranch_scc0 L_nxc_46
  s_mul_i32 s59, s25, 20480
  s_add_u32 s59, s59, 0x3200000
  buffer_store_dwordx2 v[22:23], v66, s[4:7], s59 offen offset:0 sc1
  buffer_store_dwordx2 v[24:25], v66, s[4:7], s59 offen offset:512 sc1
  buffer_store_dwordx2 v[26:27], v66, s[4:7], s59 offen offset:1024 sc1
  buffer_store_dwordx2 v[28:29], v66, s[4:7], s59 offen offset:1536 sc1
  buffer_store_dwordx2 v[30:31], v66, s[4:7], s59 offen offset:2048 sc1
  s_lshl_b32 s59, s25, 10
  s_add_u32 s59, s59, 0x3280000
  s_mov_b64 exec, 0xffff
  buffer_store_dwordx2 v[112:113], v68, s[4:7], s59 offen sc1
  s_mov_b64 exec, -1
L_nxc_46:
  s_cmp_eq_u32 s27, 3
  s_cbranch_scc0 L_nosa_47
  v_lshlrev_b32 v88, 2, v4
  v_mov_b32 v91, 0xf149f2ca
  v_add_u32 v89, 0, v88
  v_sub_u32 v90, v89, v3
  v_and_b32 v92, 1, v90
  v_cmp_eq_u32 vcc, 0, v92
  v_cmp_le_i32 s[56:57], 2, v90
  s_nop 2
  s_and_b64 s[56:57], s[56:57], vcc
  v_cndmask_b32 v32, v91, 0, s[56:57]
  v_cmp_ge_i32 s[56:57], 0, v90
  s_nop 2
  s_and_b64 s[56:57], s[56:57], vcc
  v_cndmask_b32 v36, v91, 0, s[56:57]
  v_add_u32 v89, 1, v88
  v_sub_u32 v90, v89, v3
  v_and_b32 v92, 1, v90
  v_cmp_eq_u32 vcc, 0, v92
  v_cmp_le_i32 s[56:57], 2, v90
  s_nop 2
  s_and_b64 s[56:57], s[56:57], vcc
  v_cndmask_b32 v33, v91, 0, s[56:57]
  v_cmp_ge_i32 s[56:57], 0, v90
  s_nop 2
  s_and_b64 s[56:57], s[56:57], vcc
  v_cndmask_b32 v37, v91, 0, s[56:57]
  v_add_u32 v89, 2, v88
  v_sub_u32 v90, v89, v3
  v_and_b32 v92, 1, v90
  v_cmp_eq_u32 vcc, 0, v92
  v_cmp_le_i32 s[56:57], 2, v90
  s_nop 2
  s_and_b64 s[56:57], s[56:57], vcc
  v_cndmask_b32 v34, v91, 0, s[56:57]
  v_cmp_ge_i32 s[56:57], 0, v90
  s_nop 2
  s_and_b64 s[56:57], s[56:57], vcc
  v_cndmask_b32 v38, v91, 0, s[56:57]
  v_add_u32 v89, 3, v88
  v_sub_u32 v90, v89, v3
  v_and_b32 v92, 1, v90
  v_cmp_eq_u32 vcc, 0, v92
  v_cmp_le_i32 s[56:57], 2, v90
  s_nop 2
  s_and_b64 s[56:57], s[56:57], vcc
  v_cndmask_b32 v35, v91, 0, s[56:57]
  v_cmp_ge_i32 s[56:57], 0, v90
  s_nop 2
  s_and_b64 s[56:57], s[56:57], vcc
  v_cndmask_b32 v39, v91, 0, s[56:57]
  s_or_b32 s56, s25, s24
  s_cmp_eq_u32 s56, 0
  s_cselect_b64 vcc, -1, 0
  v_cndmask_b32 v40, v32, v91, vcc
  v_cndmask_b32 v41, v33, v91, vcc
  v_cndmask_b32 v42, v34, v91, vcc
  v_cndmask_b32 v43, v35, v91, vcc
  v_cmp_gt_u32 vcc, 2, v4
  s_nop 1
  v_cndmask_b32 v44, 0, -1, vcc
  v_cmp_gt_u32 vcc, 3, v4
  s_nop 1
  v_cndmask_b32 v45, 0, -1, vcc
  v_min_u32 v88, 2, v4
  v_lshlrev_b32 v88, 4, v88
  v_mul_u32_u24 v89, 48, v3
  v_add_u32 v88, v88, v89
  s_mul_i32 s56, s24, 1536
  v_add_u32 v88, s56, v88
  v_add_u32 v46, 74496, v88
  v_add_u32 v47, 11520, v88
L_nosa_47:
  s_branch L_layer
L_fin_all:
L_end:
  s_endpgm
L_hs_30:
  buffer_store_dwordx4 v[88:91], v56, s[4:7], s56 offen sc1
  buffer_store_dwordx4 v[92:95], v57, s[4:7], s56 offen sc1
  s_branch L_hd_31
L_hs_32:
  buffer_store_dwordx4 v[96:99], v58, s[4:7], s56 offen sc1
  s_branch L_hd_33
L_hs_34:
  buffer_store_dword v78, v79, s[4:7], 0 offen sc1
  s_branch L_hd_35
L_hs_40:
  buffer_store_dwordx2 v[22:23], v66, s[12:15], s56 offen offset:0 sc1
  buffer_store_dwordx2 v[24:25], v66, s[12:15], s56 offen offset:512 sc1
  buffer_store_dwordx2 v[26:27], v66, s[12:15], s56 offen offset:1024 sc1
  buffer_store_dwordx2 v[28:29], v66, s[12:15], s56 offen offset:1536 sc1
  buffer_store_dwordx2 v[30:31], v66, s[12:15], s56 offen offset:2048 sc1
  s_branch L_hd_41
L_hs_42:
  buffer_store_dwordx2 v[112:113], v68, s[4:7], s56 offen sc1
  s_branch L_hd_43
L_hs_44:
  buffer_store_dword v96, v97, s[4:7], 0 offen sc1
  s_branch L_hd_45
L_code_end:
.globl prep_kernel
.p2align 8
.type prep_kernel,@function
prep_kernel:
  s_cmp_ge_u32 s2, 368
  s_cbranch_scc1 P_end
  s_load_dwordx4 s[28:31], s[0:1], 0
  s_load_dwordx2 s[32:33], s[0:1], 16
  s_load_dwordx4 s[36:39], s[0:1], 32
  s_load_dwordx2 s[44:45], s[0:1], 64
  v_and_b32 v1, 63, v0
  v_lshrrev_b32 v5, 6, v0
  v_lshlrev_b32 v2, 4, v1
  v_readfirstlane_b32 s24, v5
  v_and_b32 v3, 15, v1
  v_lshrrev_b32 v4, 4, v1
  s_waitcnt lgkmcnt(0)
  s_mov_b32 s4, s44
  s_mov_b32 s5, s45
  s_mov_b32 s6, 0x10000000
  s_mov_b32 s7, 0x20000
  s_cmp_ge_u32 s2, 240
  s_cbranch_scc1 P_x
  s_cmp_ge_u32 s2, 160
  s_cbranch_scc1 P_wo
  s_mul_i32 s56, s2, 820
  s_lshr_b32 s56, s56, 16
  s_mul_i32 s57, s56, 80
  s_sub_u32 s57, s2, s57
  s_lshr_b32 s58, s57, 2
  s_and_b32 s59, s57, 3
  s_cmp_eq_u32 s56, 0
  s_cselect_b32 s20, s30, s36
  s_cselect_b32 s21, s31, s37
  s_mov_b32 s22, 2457600
  s_mov_b32 s23, 0x20000
  v_mul_u32_u24 v8, 3277, v1
  v_lshrrev_b32 v8, 16, v8
  v_mul_u32_u24 v9, 20, v8
  v_sub_u32 v9, v1, v9
  v_mul_u32_u24 v8, 1280, v8
  v_lshl_add_u32 v8, v9, 4, v8
  s_lshl_b32 s60, s58, 5
  s_lshl_b32 s61, s24, 3
  s_add_u32 s60, s60, s61
  s_mul_i32 s60, s60, 3840
  s_mul_i32 s61, s59, 320
  s_add_u32 s60, s60, s61
  s_mov_b32 exec_hi, 0xfffffff
  buffer_load_dwordx4 v[16:19], v8, s[20:23], s60 offen
  s_add_u32 s60, s60, 3840
  buffer_load_dwordx4 v[20:23], v8, s[20:23], s60 offen
  s_add_u32 s60, s60, 3840
  buffer_load_dwordx4 v[24:27], v8, s[20:23], s60 offen
  s_add_u32 s60, s60, 3840
  buffer_load_dwordx4 v[28:31], v8, s[20:23], s60 offen
  s_add_u32 s60, s60, 3840
  buffer_load_dwordx4 v[32:35], v8, s[20:23], s60 offen
  s_add_u32 s60, s60, 3840
  buffer_load_dwordx4 v[36:39], v8, s[20:23], s60 offen
  s_add_u32 s60, s60, 3840
  buffer_load_dwordx4 v[40:43], v8, s[20:23], s60 offen
  s_add_u32 s60, s60, 3840
  buffer_load_dwordx4 v[44:47], v8, s[20:23], s60 offen
  s_mul_i32 s61, s24, 7808
  v_add_u32 v9, s61, v2
  s_waitcnt vmcnt(7)
  ds_write_b128 v9, v[16:19] offset:0
  s_waitcnt vmcnt(6)
  ds_write_b128 v9, v[20:23] offset:976
  s_waitcnt vmcnt(5)
  ds_write_b128 v9, v[24:27] offset:1952
  s_waitcnt vmcnt(4)
  ds_write_b128 v9, v[28:31] offset:2928
  s_waitcnt vmcnt(3)
  ds_write_b128 v9, v[32:35] offset:3904
  s_waitcnt vmcnt(2)
  ds_write_b128 v9, v[36:39] offset:4880
  s_waitcnt vmcnt(1)
  ds_write_b128 v9, v[40:43] offset:5856
  s_waitcnt vmcnt(0)
  ds_write_b128 v9, v[44:47] offset:6832
  s_mov_b64 exec, -1
  v_bfe_u32 v8, v1, 2, 2
  v_lshl_add_u32 v8, v4, 3, v8
  v_mul_u32_u24 v8, 976, v8
  s_mul_i32 s61, s24, 80
  v_add_u32 v8, s61, v8
  v_and_b32 v9, 3, v1
  v_cmp_gt_u32 vcc, 8, v3
  s_nop 1
  v_cndmask_b32 v10, 0, -1, vcc
  s_lshl_b32 s61, s59, 2
  s_add_u32 s61, s61, s24
  s_mul_i32 s61, s61, 163840
  s_lshl_b32 s62, s58, 10
  s_add_u32 s61, s61, s62
  s_mul_i32 s62, s56, 0x280000
  s_add_u32 s61, s61, s62
  s_add_u32 s61, s61, 0x4000000
  s_waitcnt lgkmcnt(0)
  s_barrier
  v_add_u32 v11, 0, v9
  v_mul_u32_u24 v12, 26, v11
  v_lshrrev_b32 v12, 8, v12
  v_min_u32 v12, 2, v12
  v_mul_u32_u24 v12, 240, v12
  v_lshl_add_u32 v12, v11, 3, v12
  v_add_u32 v12, v12, v8
  ds_read_b64_tr_b16 v[16:17], v12
  ds_read_b64_tr_b16 v[18:19], v12 offset:3904
  v_add_u32 v11, 4, v9
  v_mul_u32_u24 v12, 26, v11
  v_lshrrev_b32 v12, 8, v12
  v_min_u32 v12, 2, v12
  v_mul_u32_u24 v12, 240, v12
  v_lshl_add_u32 v12, v11, 3, v12
  v_add_u32 v12, v12, v8
  ds_read_b64_tr_b16 v[20:21], v12
  ds_read_b64_tr_b16 v[22:23], v12 offset:3904
  v_add_u32 v11, 8, v9
  v_mul_u32_u24 v12, 26, v11
  v_lshrrev_b32 v12, 8, v12
  v_min_u32 v12, 2, v12
  v_mul_u32_u24 v12, 240, v12
  v_lshl_add_u32 v12, v11, 3, v12
  v_add_u32 v12, v12, v8
  ds_read_b64_tr_b16 v[24:25], v12
  ds_read_b64_tr_b16 v[26:27], v12 offset:3904
  v_add_u32 v11, 12, v9
  v_mul_u32_u24 v12, 26, v11
  v_lshrrev_b32 v12, 8, v12
  v_min_u32 v12, 2, v12
  v_mul_u32_u24 v12, 240, v12
  v_lshl_add_u32 v12, v11, 3, v12
  v_add_u32 v12, v12, v8
  ds_read_b64_tr_b16 v[28:29], v12
  ds_read_b64_tr_b16 v[30:31], v12 offset:3904
  v_add_u32 v11, 16, v9
  v_mul_u32_u24 v12, 26, v11
  v_lshrrev_b32 v12, 8, v12
  v_min_u32 v12, 2, v12
  v_mul_u32_u24 v12, 240, v12
  v_lshl_add_u32 v12, v11, 3, v12
  v_add_u32 v12, v12, v8
  ds_read_b64_tr_b16 v[32:33], v12
  ds_read_b64_tr_b16 v[34:35], v12 offset:3904
  v_add_u32 v11, 20, v9
  v_mul_u32_u24 v12, 26, v11
  v_lshrrev_b32 v12, 8, v12
  v_min_u32 v12, 2, v12
  v_mul_u32_u24 v12, 240, v12
  v_lshl_add_u32 v12, v11, 3, v12
  v_add_u32 v12, v12, v8
  ds_read_b64_tr_b16 v[36:37], v12
  ds_read_b64_tr_b16 v[38:39], v12 offset:3904
  v_add_u32 v11, 24, v9
  v_mul_u32_u24 v12, 26, v11
  v_lshrrev_b32 v12, 8, v12
  v_min_u32 v12, 2, v12
  v_mul_u32_u24 v12, 240, v12
  v_lshl_add_u32 v12, v11, 3, v12
  v_add_u32 v12, v12, v8
  ds_read_b64_tr_b16 v[40:41], v12
  ds_read_b64_tr_b16 v[42:43], v12 offset:3904
  v_add_u32 v11, 28, v9
  v_mul_u32_u24 v12, 26, v11
  v_lshrrev_b32 v12, 8, v12
  v_min_u32 v12, 2, v12
  v_mul_u32_u24 v12, 240, v12
  v_lshl_add_u32 v12, v11, 3, v12
  v_add_u32 v12, v12, v8
  ds_read_b64_tr_b16 v[44:45], v12
  ds_read_b64_tr_b16 v[46:47], v12 offset:3904
  s_waitcnt lgkmcnt(0)
  v_and_b32 v44, v44, v10
  v_and_b32 v45, v45, v10
  v_and_b32 v46, v46, v10
  v_and_b32 v47, v47, v10
  buffer_store_dwordx4 v[16:19], v2, s[4:7], s61 offen
  s_add_u32 s61, s61, 20480
  buffer_store_dwordx4 v[20:23], v2, s[4:7], s61 offen
  s_add_u32 s61, s61, 20480
  buffer_store_dwordx4 v[24:27], v2, s[4:7], s61 offen
  s_add_u32 s61, s61, 20480
  buffer_store_dwordx4 v[28:31], v2, s[4:7], s61 offen
  s_add_u32 s61, s61, 20480
  buffer_store_dwordx4 v[32:35], v2, s[4:7], s61 offen
  s_add_u32 s61, s61, 20480
  buffer_store_dwordx4 v[36:39], v2, s[4:7], s61 offen
  s_add_u32 s61, s61, 20480
  buffer_store_dwordx4 v[40:43], v2, s[4:7], s61 offen
  s_add_u32 s61, s61, 20480
  buffer_store_dwordx4 v[44:47], v2, s[4:7], s61 offen
  s_branch P_end
P_wo:
  s_sub_u32 s63, s2, 160
  s_mul_i32 s56, s63, 1639
  s_lshr_b32 s56, s56, 16
  s_mul_i32 s57, s56, 40
  s_sub_u32 s57, s63, s57
  s_lshr_b32 s58, s57, 1
  s_and_b32 s59, s57, 1
  s_cmp_eq_u32 s56, 0
  s_cselect_b32 s20, s32, s38
  s_cselect_b32 s21, s33, s39
  s_mov_b32 s22, 819200
  s_mov_b32 s23, 0x20000
  s_lshl_b32 s64, s58, 5
  s_lshl_b32 s65, s24, 3
  s_add_u32 s64, s64, s65
  s_mul_i32 s64, s64, 1280
  s_mul_i32 s65, s59, 640
  s_add_u32 s64, s64, s65
  s_mov_b32 exec_hi, 0xff
  buffer_load_dwordx4 v[16:19], v2, s[20:23], s64 offen
  s_add_u32 s64, s64, 1280
  buffer_load_dwordx4 v[20:23], v2, s[20:23], s64 offen
  s_add_u32 s64, s64, 1280
  buffer_load_dwordx4 v[24:27], v2, s[20:23], s64 offen
  s_add_u32 s64, s64, 1280
  buffer_load_dwordx4 v[28:31], v2, s[20:23], s64 offen
  s_add_u32 s64, s64, 1280
  buffer_load_dwordx4 v[32:35], v2, s[20:23], s64 offen
  s_add_u32 s64, s64, 1280
  buffer_load_dwordx4 v[36:39], v2, s[20:23], s64 offen
  s_add_u32 s64, s64, 1280
  buffer_load_dwordx4 v[40:43], v2, s[20:23], s64 offen
  s_add_u32 s64, s64, 1280
  buffer_load_dwordx4 v[44:47], v2, s[20:23], s64 offen
  s_mul_i32 s61, s24, 5248
  v_add_u32 v9, s61, v2
  s_waitcnt vmcnt(7)
  ds_write_b128 v9, v[16:19] offset:0
  s_waitcnt vmcnt(6)
  ds_write_b128 v9, v[20:23] offset:656
  s_waitcnt vmcnt(5)
  ds_write_b128 v9, v[24:27] offset:1312
  s_waitcnt vmcnt(4)
  ds_write_b128 v9, v[28:31] offset:1968
  s_waitcnt vmcnt(3)
  ds_write_b128 v9, v[32:35] offset:2624
  s_waitcnt vmcnt(2)
  ds_write_b128 v9, v[36:39] offset:3280
  s_waitcnt vmcnt(1)
  ds_write_b128 v9, v[40:43] offset:3936
  s_waitcnt vmcnt(0)
  ds_write_b128 v9, v[44:47] offset:4592
  s_mov_b64 exec, -1
  v_bfe_u32 v8, v1, 2, 2
  v_lshl_add_u32 v8, v4, 3, v8
  v_mul_u32_u24 v8, 656, v8
  s_mul_i32 s61, s24, 160
  v_add_u32 v8, s61, v8
  v_and_b32 v9, 3, v1
  v_lshl_add_u32 v11, v9, 3, v8
  s_lshl_b32 s61, s59, 2
  s_add_u32 s61, s61, s24
  s_mul_i32 s61, s61, 20
  s_add_u32 s61, s61, s58
  s_mul_i32 s61, s61, 5120
  s_mul_i32 s62, s56, 0x100000
  s_add_u32 s61, s61, s62
  s_add_u32 s61, s61, 0x4600000
  s_add_u32 s62, s61, 4096
  s_waitcnt lgkmcnt(0)
  s_barrier
  ds_read_b64_tr_b16 v[16:17], v11 offset:0
  ds_read_b64_tr_b16 v[18:19], v11 offset:2624
  ds_read_b64_tr_b16 v[20:21], v11 offset:32
  ds_read_b64_tr_b16 v[22:23], v11 offset:2656
  ds_read_b64_tr_b16 v[24:25], v11 offset:64
  ds_read_b64_tr_b16 v[26:27], v11 offset:2688
  ds_read_b64_tr_b16 v[28:29], v11 offset:96
  ds_read_b64_tr_b16 v[30:31], v11 offset:2720
  ds_read_b64_tr_b16 v[32:33], v11 offset:128
  ds_read_b64_tr_b16 v[34:35], v11 offset:2752
  s_waitcnt lgkmcnt(0)
  buffer_store_dwordx4 v[16:19], v2, s[4:7], s61 offen offset:0
  buffer_store_dwordx4 v[20:23], v2, s[4:7], s61 offen offset:1024
  buffer_store_dwordx4 v[24:27], v2, s[4:7], s61 offen offset:2048
  buffer_store_dwordx4 v[28:31], v2, s[4:7], s61 offen offset:3072
  buffer_store_dwordx4 v[32:35], v2, s[4:7], s62 offen
  s_branch P_end
P_x:
  s_sub_u32 s56, s2, 240
  s_mov_b32 s20, s28
  s_mov_b32 s21, s29
  s_mov_b32 s22, 0x280000
  s_mov_b32 s23, 0x20000
  v_lshl_add_u32 v8, s24, 2, v4
  s_lshl_b32 s57, s56, 4
  v_add_u32 v9, s57, v8
  v_mul_u32_u24 v10, 1280, v9
  v_lshl_add_u32 v10, v3, 4, v10
  buffer_load_dwordx4 v[16:19], v10, s[20:23], 0 offen offset:0
  buffer_load_dwordx4 v[20:23], v10, s[20:23], 0 offen offset:256
  buffer_load_dwordx4 v[24:27], v10, s[20:23], 0 offen offset:512
  buffer_load_dwordx4 v[28:31], v10, s[20:23], 0 offen offset:768
  buffer_load_dwordx4 v[32:35], v10, s[20:23], 0 offen offset:1024
  s_cmp_eq_u32 s2, 240
  s_cbranch_scc0 P_nz_1
  v_lshlrev_b32 v11, 4, v0
  v_mov_b32 v36, 0
  v_mov_b32 v37, 0
  v_mov_b32 v38, 0
  v_mov_b32 v39, 0
  s_mov_b32 s58, 0x3400000
  buffer_store_dwordx4 v[36:39], v11, s[4:7], s58 offen
  s_mov_b32 s58, 0x3410000
  buffer_store_dwordx4 v[36:39], v11, s[4:7], s58 offen
  s_mov_b32 s58, 0x3418000
  buffer_store_dwordx4 v[36:39], v11, s[4:7], s58 offen
P_nz_1:
  v_lshlrev_b32 v11, 8, v3
  v_lshl_add_u32 v11, v8, 4, v11
  s_mul_i32 s58, s56, 20480
  s_add_u32 s58, s58, 0x4800000
  s_waitcnt vmcnt(0)
  buffer_store_dwordx4 v[16:19], v11, s[4:7], s58 offen
  s_add_u32 s58, s58, 4096
  buffer_store_dwordx4 v[20:23], v11, s[4:7], s58 offen
  s_add_u32 s58, s58, 4096
  buffer_store_dwordx4 v[24:27], v11, s[4:7], s58 offen
  s_add_u32 s58, s58, 4096
  buffer_store_dwordx4 v[28:31], v11, s[4:7], s58 offen
  s_add_u32 s58, s58, 4096
  buffer_store_dwordx4 v[32:35], v11, s[4:7], s58 offen
  v_mov_b32 v12, 0
  v_mov_b32 v13, 0
  v_mov_b32 v14, 0
  v_mov_b32 v15, 0
  v_lshlrev_b32 v5, 16, v16
  v_and_b32 v6, 0xffff0000, v16
  v_add_f32 v12, v12, v5
  v_fmac_f32 v13, v5, v5
  v_add_f32 v14, v14, v6
  v_fmac_f32 v15, v6, v6
  v_lshlrev_b32 v5, 16, v17
  v_and_b32 v6, 0xffff0000, v17
  v_add_f32 v12, v12, v5
  v_fmac_f32 v13, v5, v5
  v_add_f32 v14, v14, v6
  v_fmac_f32 v15, v6, v6
  v_lshlrev_b32 v5, 16, v18
  v_and_b32 v6, 0xffff0000, v18
  v_add_f32 v12, v12, v5
  v_fmac_f32 v13, v5, v5
  v_add_f32 v14, v14, v6
  v_fmac_f32 v15, v6, v6
  v_lshlrev_b32 v5, 16, v19
  v_and_b32 v6, 0xffff0000, v19
  v_add_f32 v12, v12, v5
  v_fmac_f32 v13, v5, v5
  v_add_f32 v14, v14, v6
  v_fmac_f32 v15, v6, v6
  v_lshlrev_b32 v5, 16, v20
  v_and_b32 v6, 0xffff0000, v20
  v_add_f32 v12, v12, v5
  v_fmac_f32 v13, v5, v5
  v_add_f32 v14, v14, v6
  v_fmac_f32 v15, v6, v6
  v_lshlrev_b32 v5, 16, v21
  v_and_b32 v6, 0xffff0000, v21
  v_add_f32 v12, v12, v5
  v_fmac_f32 v13, v5, v5
  v_add_f32 v14, v14, v6
  v_fmac_f32 v15, v6, v6
  v_lshlrev_b32 v5, 16, v22
  v_and_b32 v6, 0xffff0000, v22
  v_add_f32 v12, v12, v5
  v_fmac_f32 v13, v5, v5
  v_add_f32 v14, v14, v6
  v_fmac_f32 v15, v6, v6
  v_lshlrev_b32 v5, 16, v23
  v_and_b32 v6, 0xffff0000, v23
  v_add_f32 v12, v12, v5
  v_fmac_f32 v13, v5, v5
  v_add_f32 v14, v14, v6
  v_fmac_f32 v15, v6, v6
  v_lshlrev_b32 v5, 16, v24
  v_and_b32 v6, 0xffff0000, v24
  v_add_f32 v12, v12, v5
  v_fmac_f32 v13, v5, v5
  v_add_f32 v14, v14, v6
  v_fmac_f32 v15, v6, v6
  v_lshlrev_b32 v5, 16, v25
  v_and_b32 v6, 0xffff0000, v25
  v_add_f32 v12, v12, v5
  v_fmac_f32 v13, v5, v5
  v_add_f32 v14, v14, v6
  v_fmac_f32 v15, v6, v6
  v_lshlrev_b32 v5, 16, v26
  v_and_b32 v6, 0xffff0000, v26
  v_add_f32 v12, v12, v5
  v_fmac_f32 v13, v5, v5
  v_add_f32 v14, v14, v6
  v_fmac_f32 v15, v6, v6
  v_lshlrev_b32 v5, 16, v27
  v_and_b32 v6, 0xffff0000, v27
  v_add_f32 v12, v12, v5
  v_fmac_f32 v13, v5, v5
  v_add_f32 v14, v14, v6
  v_fmac_f32 v15, v6, v6
  v_lshlrev_b32 v5, 16, v28
  v_and_b32 v6, 0xffff0000, v28
  v_add_f32 v12, v12, v5
  v_fmac_f32 v13, v5, v5
  v_add_f32 v14, v14, v6
  v_fmac_f32 v15, v6, v6
  v_lshlrev_b32 v5, 16, v29
  v_and_b32 v6, 0xffff0000, v29
  v_add_f32 v12, v12, v5
  v_fmac_f32 v13, v5, v5
  v_add_f32 v14, v14, v6
  v_fmac_f32 v15, v6, v6
  v_lshlrev_b32 v5, 16, v30
  v_and_b32 v6, 0xffff0000, v30
  v_add_f32 v12, v12, v5
  v_fmac_f32 v13, v5, v5
  v_add_f32 v14, v14, v6
  v_fmac_f32 v15, v6, v6
  v_lshlrev_b32 v5, 16, v31
  v_and_b32 v6, 0xffff0000, v31
  v_add_f32 v12, v12, v5
  v_fmac_f32 v13, v5, v5
  v_add_f32 v14, v14, v6
  v_fmac_f32 v15, v6, v6
  v_lshlrev_b32 v5, 16, v32
  v_and_b32 v6, 0xffff0000, v32
  v_add_f32 v12, v12, v5
  v_fmac_f32 v13, v5, v5
  v_add_f32 v14, v14, v6
  v_fmac_f32 v15, v6, v6
  v_lshlrev_b32 v5, 16, v33
  v_and_b32 v6, 0xffff0000, v33
  v_add_f32 v12, v12, v5
  v_fmac_f32 v13, v5, v5
  v_add_f32 v14, v14, v6
  v_fmac_f32 v15, v6, v6
  v_lshlrev_b32 v5, 16, v34
  v_and_b32 v6, 0xffff0000, v34
  v_add_f32 v12, v12, v5
  v_fmac_f32 v13, v5, v5
  v_add_f32 v14, v14, v6
  v_fmac_f32 v15, v6, v6
  v_lshlrev_b32 v5, 16, v35
  v_and_b32 v6, 0xffff0000, v35
  v_add_f32 v12, v12, v5
  v_fmac_f32 v13, v5, v5
  v_add_f32 v14, v14, v6
  v_fmac_f32 v15, v6, v6
  v_add_f32 v12, v12, v14
  v_add_f32 v13, v13, v15
  s_nop 0
  v_add_f32_dpp v12, v12, v12 row_ror:8 row_mask:0xf bank_mask:0xf
  v_add_f32_dpp v13, v13, v13 row_ror:8 row_mask:0xf bank_mask:0xf
  s_nop 0
  v_add_f32_dpp v12, v12, v12 row_ror:4 row_mask:0xf bank_mask:0xf
  v_add_f32_dpp v13, v13, v13 row_ror:4 row_mask:0xf bank_mask:0xf
  s_nop 0
  v_add_f32_dpp v12, v12, v12 row_ror:2 row_mask:0xf bank_mask:0xf
  v_add_f32_dpp v13, v13, v13 row_ror:2 row_mask:0xf bank_mask:0xf
  s_nop 0
  v_add_f32_dpp v12, v12, v12 row_ror:1 row_mask:0xf bank_mask:0xf
  v_add_f32_dpp v13, v13, v13 row_ror:1 row_mask:0xf bank_mask:0xf
  v_cmp_eq_u32 vcc, 0, v3
  s_nop 1
  v_cndmask_b32 v36, 0, v12, vcc
  v_cndmask_b32 v37, 0, v13, vcc
  v_mov_b32 v38, 0
  v_mov_b32 v39, 0
  v_lshlrev_b32 v5, 6, v9
  v_lshl_add_u32 v5, v3, 4, v5
  s_mov_b32 s58, 0x3000000
  v_cmp_gt_u32 vcc, 4, v3
  s_nop 2
  s_and_b64 exec, exec, vcc
  buffer_store_dwordx4 v[36:39], v5, s[4:7], s58 offen
P_end:
  s_endpgm
.section .rodata,"a"
.p2align 6
.amdhsa_kernel interleave_layers__sliding_local_dilated__sliding_block__prompt_kernel
  .amdhsa_next_free_vgpr 512
  .amdhsa_next_free_sgpr 102
  .amdhsa_accum_offset 256
  .amdhsa_group_segment_fixed_size 0
  .amdhsa_kernarg_size 72
  .amdhsa_user_sgpr_count 2
  .amdhsa_user_sgpr_kernarg_segment_ptr 1
  .amdhsa_system_sgpr_workgroup_id_x 1
.end_amdhsa_kernel
.p2align 6
.amdhsa_kernel prep_kernel
  .amdhsa_next_free_vgpr 64
  .amdhsa_next_free_sgpr 102
  .amdhsa_accum_offset 64
  .amdhsa_group_segment_fixed_size 0
  .amdhsa_kernarg_size 72
  .amdhsa_user_sgpr_count 2
  .amdhsa_user_sgpr_kernarg_segment_ptr 1
  .amdhsa_system_sgpr_workgroup_id_x 1
.end_amdhsa_kernel
```
